```python
import torch

def _softmax(x, axis=-1):
    return torch.softmax(x, dim=axis)

def _gelu(x):
    return torch.nn.functional.gelu(x, approximate='tanh')

def _silu(x):
    return torch.nn.functional.silu(x)

def _sigmoid(x):
    return torch.sigmoid(x)

def _layernorm(x, axis=-1, eps=1e-05):
    m = x.mean(dim=axis, keepdim=True)
    v = x.var(dim=axis, keepdim=True, unbiased=False)
    return (x - m) / torch.sqrt(v + eps)

def _scatter_add(tgt, idx, src, axis=0):
    return tgt.clone().index_add_(axis, idx, src)

def _segment_sum(src, seg, n):
    out = torch.zeros((n,) + src.shape[1:], dtype=src.dtype)
    return out.index_add_(0, seg, src)

def _pad(x, pw):
    flat = tuple((v for pair in reversed(pw) for v in pair))
    return torch.nn.functional.pad(x, flat)
kernel_name = 'parallel_sum__memory_aug_recurrent_mem_tr__moe_arch_mod__prompt'

def setup_inputs():

    _w = lambda a: (lambda t: t.to(torch.bfloat16) if t.is_floating_point() else t)(torch.as_tensor(a))

    def _A_setup():
        B, S, Dm = (1, 2048, 640)
        H, Dh = (32, 128)
        M, seg = (8, 32)
        seg = min(seg, S)
        S = S // seg * seg
        return {'x': _w((lambda *s: torch.randn(*s, dtype=torch.bfloat16) * 0.05)(B, S, Dm)), 'mem0': _w((lambda *s: torch.randn(*s, dtype=torch.bfloat16) * 1.6)(B, M, Dm)), 'Wq': _w((lambda *s: torch.randn(*s, dtype=torch.bfloat16) * 0.8)(Dm, H, Dh) * Dm ** (-0.5)), 'Wk': _w((lambda *s: torch.randn(*s, dtype=torch.bfloat16) * 0.8)(Dm, H, Dh) * Dm ** (-0.5)), 'Wv': _w((lambda *s: torch.randn(*s, dtype=torch.bfloat16) * 1.6)(Dm, H, Dh) * Dm ** (-0.5)), 'Wo': _w((lambda *s: torch.randn(*s, dtype=torch.bfloat16) * 1.6)(H, Dh, Dm) * (H * Dh) ** (-0.5)), 'seg_len': seg}
    _A_in = _A_setup()

    def _B_setup():
        B, S, D, F, C = (1, 2048, 640, 1728, 8)
        return {'x': _w((lambda *s: torch.randn(*s, dtype=torch.bfloat16) * 0.05)(B, S, D)), 'w_r': _w((lambda *s: torch.randn(*s, dtype=torch.bfloat16) * 0.05)(D)), 'w_gate': _w((lambda *s: torch.randn(*s, dtype=torch.bfloat16) * 0.05)(D, F)), 'w_up': _w((lambda *s: torch.randn(*s, dtype=torch.bfloat16) * 0.05)(D, F)), 'w_down': _w((lambda *s: torch.randn(*s, dtype=torch.bfloat16) * 0.05)(F, D))}
    _B_in = _B_setup()
    return {'A_x': _A_in['x'], 'A_mem0': _A_in['mem0'], 'A_Wq': _A_in['Wq'], 'A_Wk': _A_in['Wk'], 'A_Wv': _A_in['Wv'], 'A_Wo': _A_in['Wo'], 'A_seg_len': _A_in['seg_len'], 'B_x': _B_in['x'], 'B_w_r': _B_in['w_r'], 'B_w_gate': _B_in['w_gate'], 'B_w_up': _B_in['w_up'], 'B_w_down': _B_in['w_down']}

def reference(A_x, A_mem0, A_Wq, A_Wk, A_Wv, A_Wo, A_seg_len, B_x, B_w_r, B_w_gate, B_w_up, B_w_down):

    def _A_ref(x, mem0, Wq, Wk, Wv, Wo, seg_len):
        B, S, Dm = x.shape
        H, Dh = (Wq.shape[1], Wq.shape[2])
        M = mem0.shape[1]
        scale = Dh ** (-0.5)
        n_seg = S // seg_len
        L = M + seg_len
        idx = torch.arange(L)
        mask = (idx[:, None] < M) | (idx[:, None] >= idx[None, :])
        mem = mem0
        outs = []
        for s in range(n_seg):
            xs = x[:, s * seg_len:(s + 1) * seg_len, :].clone()
            h = torch.concatenate([mem, xs], axis=1)
            q = torch.einsum('btd,dhe->bhte', h, Wq)
            k = torch.einsum('btd,dhe->bhte', h, Wk)
            v = torch.einsum('btd,dhe->bhte', h, Wv)
            scores = torch.einsum('bhqe,bhke->bhqk', q, k) * scale
            scores = torch.where(mask[None, None], scores, -1000000000.0)
            p = _softmax(scores, axis=-1)
            o = torch.einsum('bhqk,bhke->bhqe', p, v)
            o = torch.einsum('bhte,hed->btd', o, Wo)
            mem = o[:, :M, :].clone()
            outs.append(o[:, M:, :])
        return torch.concatenate(outs, axis=1)

    def _B_ref(x, w_r, w_gate, w_up, w_down):
        B, S, D = x.shape
        C = 8
        r = x @ w_r
        idx = torch.argsort(-r, axis=-1)[:, :C]
        idx_e = (lambda x, n, axis: torch.repeat_interleave(x, n, dim=axis))(idx.reshape(B, C, 1), D, axis=2)
        x_sel = (lambda x, i, axis: torch.take_along_dim(x, i, dim=axis))(x, idx_e, axis=1)
        g = _silu(x_sel @ w_gate)
        u = x_sel @ w_up
        y = g * u @ w_down
        r_sel = _sigmoid((lambda x, i, axis: torch.take_along_dim(x, i, dim=axis))(r, idx, axis=1))
        y = y * r_sel.reshape(B, C, 1)
        b_off = (torch.arange(B) * S).reshape(B, 1)
        flat_idx = (idx + b_off).reshape(B * C)
        zero = (x * 0.0).reshape(B * S, D)
        upd = _scatter_add(zero, flat_idx, y.reshape(B * C, D), axis=0)
        return x + upd.reshape(B, S, D)
    x = A_x
    xn = _layernorm(x, axis=-1)
    return x + _A_ref(xn, A_mem0, A_Wq, A_Wk, A_Wv, A_Wo, A_seg_len) + _B_ref(xn, B_w_r, B_w_gate, B_w_up, B_w_down)
```

```asm
; @launch kernel=k1_kernel grid=(537,1,1) block=(256,1,1) lds=16384
; @launch kernel=k3_kernel grid=(1563,1,1) block=(256,1,1) lds=65536
; @launch kernel=k4_kernel grid=(256,1,1) block=(256,1,1) lds=155648
; @launch kernel=k5a_kernel grid=(522,1,1) block=(256,1,1) lds=0
; @launch kernel=k5b_kernel grid=(256,1,1) block=(256,1,1) lds=81920
.amdgcn_target "amdgcn-amd-amdhsa--gfx950"
.text
.globl k1_kernel
.p2align 8
.type k1_kernel,@function
k1_kernel:
    s_load_dwordx2 s[4:5], s[0:1], 112
    s_cmp_ge_u32 s2, 537
    s_cbranch_scc1 K1_END
    v_lshrrev_b32 v1, 6, v0
    v_and_b32 v2, 63, v0
    v_readfirstlane_b32 s3, v1
    s_mov_b32 s6, 268435456
    s_mov_b32 s7, 0x00020000
    s_cmp_ge_u32 s2, 128
    s_cbranch_scc1 K1_NOT_LN
    s_load_dwordx2 s[8:9], s[0:1], 0
    s_load_dwordx2 s[12:13], s[0:1], 64
    s_mov_b32 s10, 2621440
    s_mov_b32 s11, 0x00020000
    s_mov_b32 s14, 1280
    s_mov_b32 s15, 0x00020000
    s_lshl_b32 s16, s2, 4
    s_lshl_b32 s17, s3, 2
    s_add_u32 s16, s16, s17
    v_lshrrev_b32 v3, 4, v2
    v_add_u32 v3, s16, v3
    v_and_b32 v4, 15, v2
    v_mul_u32_u24 v5, 1280, v3
    v_lshl_add_u32 v5, v4, 4, v5
    v_lshlrev_b32 v6, 4, v4
    s_waitcnt lgkmcnt(0)
    buffer_load_dwordx4 v[8:11], v5, s[8:11], 0 offen offset:0
    buffer_load_dwordx4 v[12:15], v5, s[8:11], 0 offen offset:256
    buffer_load_dwordx4 v[16:19], v5, s[8:11], 0 offen offset:512
    buffer_load_dwordx4 v[20:23], v5, s[8:11], 0 offen offset:768
    buffer_load_dwordx4 v[24:27], v5, s[8:11], 0 offen offset:1024
    buffer_load_dwordx4 v[28:31], v6, s[12:15], 0 offen offset:0
    buffer_load_dwordx4 v[32:35], v6, s[12:15], 0 offen offset:256
    buffer_load_dwordx4 v[36:39], v6, s[12:15], 0 offen offset:512
    buffer_load_dwordx4 v[40:43], v6, s[12:15], 0 offen offset:768
    buffer_load_dwordx4 v[44:47], v6, s[12:15], 0 offen offset:1024
    s_waitcnt vmcnt(5)
    v_lshlrev_b32 v48, 16, v8
    v_and_b32 v49, 0xffff0000, v8
    v_lshlrev_b32 v50, 16, v9
    v_and_b32 v51, 0xffff0000, v9
    v_lshlrev_b32 v52, 16, v10
    v_and_b32 v53, 0xffff0000, v10
    v_lshlrev_b32 v54, 16, v11
    v_and_b32 v55, 0xffff0000, v11
    v_lshlrev_b32 v56, 16, v12
    v_and_b32 v57, 0xffff0000, v12
    v_lshlrev_b32 v58, 16, v13
    v_and_b32 v59, 0xffff0000, v13
    v_lshlrev_b32 v60, 16, v14
    v_and_b32 v61, 0xffff0000, v14
    v_lshlrev_b32 v62, 16, v15
    v_and_b32 v63, 0xffff0000, v15
    v_lshlrev_b32 v64, 16, v16
    v_and_b32 v65, 0xffff0000, v16
    v_lshlrev_b32 v66, 16, v17
    v_and_b32 v67, 0xffff0000, v17
    v_lshlrev_b32 v68, 16, v18
    v_and_b32 v69, 0xffff0000, v18
    v_lshlrev_b32 v70, 16, v19
    v_and_b32 v71, 0xffff0000, v19
    v_lshlrev_b32 v72, 16, v20
    v_and_b32 v73, 0xffff0000, v20
    v_lshlrev_b32 v74, 16, v21
    v_and_b32 v75, 0xffff0000, v21
    v_lshlrev_b32 v76, 16, v22
    v_and_b32 v77, 0xffff0000, v22
    v_lshlrev_b32 v78, 16, v23
    v_and_b32 v79, 0xffff0000, v23
    v_lshlrev_b32 v80, 16, v24
    v_and_b32 v81, 0xffff0000, v24
    v_lshlrev_b32 v82, 16, v25
    v_and_b32 v83, 0xffff0000, v25
    v_lshlrev_b32 v84, 16, v26
    v_and_b32 v85, 0xffff0000, v26
    v_lshlrev_b32 v86, 16, v27
    v_and_b32 v87, 0xffff0000, v27
    v_add_f32 v88, v48, v49
    v_add_f32 v88, v88, v50
    v_add_f32 v88, v88, v51
    v_add_f32 v88, v88, v52
    v_add_f32 v88, v88, v53
    v_add_f32 v88, v88, v54
    v_add_f32 v88, v88, v55
    v_add_f32 v88, v88, v56
    v_add_f32 v88, v88, v57
    v_add_f32 v88, v88, v58
    v_add_f32 v88, v88, v59
    v_add_f32 v88, v88, v60
    v_add_f32 v88, v88, v61
    v_add_f32 v88, v88, v62
    v_add_f32 v88, v88, v63
    v_add_f32 v88, v88, v64
    v_add_f32 v88, v88, v65
    v_add_f32 v88, v88, v66
    v_add_f32 v88, v88, v67
    v_add_f32 v88, v88, v68
    v_add_f32 v88, v88, v69
    v_add_f32 v88, v88, v70
    v_add_f32 v88, v88, v71
    v_add_f32 v88, v88, v72
    v_add_f32 v88, v88, v73
    v_add_f32 v88, v88, v74
    v_add_f32 v88, v88, v75
    v_add_f32 v88, v88, v76
    v_add_f32 v88, v88, v77
    v_add_f32 v88, v88, v78
    v_add_f32 v88, v88, v79
    v_add_f32 v88, v88, v80
    v_add_f32 v88, v88, v81
    v_add_f32 v88, v88, v82
    v_add_f32 v88, v88, v83
    v_add_f32 v88, v88, v84
    v_add_f32 v88, v88, v85
    v_add_f32 v88, v88, v86
    v_add_f32 v88, v88, v87
    ds_swizzle_b32 v89, v88 offset:0x41f
    s_waitcnt lgkmcnt(0)
    v_add_f32 v88, v88, v89
    ds_swizzle_b32 v89, v88 offset:0x81f
    s_waitcnt lgkmcnt(0)
    v_add_f32 v88, v88, v89
    ds_swizzle_b32 v89, v88 offset:0x101f
    s_waitcnt lgkmcnt(0)
    v_add_f32 v88, v88, v89
    ds_swizzle_b32 v89, v88 offset:0x201f
    s_waitcnt lgkmcnt(0)
    v_add_f32 v88, v88, v89
    s_mov_b32 s18, 0x3acccccd
    v_mul_f32 v88, s18, v88
    v_sub_f32 v90, v48, v88
    v_mul_f32 v91, v90, v90
    v_sub_f32 v90, v49, v88
    v_fmac_f32 v91, v90, v90
    v_sub_f32 v90, v50, v88
    v_fmac_f32 v91, v90, v90
    v_sub_f32 v90, v51, v88
    v_fmac_f32 v91, v90, v90
    v_sub_f32 v90, v52, v88
    v_fmac_f32 v91, v90, v90
    v_sub_f32 v90, v53, v88
    v_fmac_f32 v91, v90, v90
    v_sub_f32 v90, v54, v88
    v_fmac_f32 v91, v90, v90
    v_sub_f32 v90, v55, v88
    v_fmac_f32 v91, v90, v90
    v_sub_f32 v90, v56, v88
    v_fmac_f32 v91, v90, v90
    v_sub_f32 v90, v57, v88
    v_fmac_f32 v91, v90, v90
    v_sub_f32 v90, v58, v88
    v_fmac_f32 v91, v90, v90
    v_sub_f32 v90, v59, v88
    v_fmac_f32 v91, v90, v90
    v_sub_f32 v90, v60, v88
    v_fmac_f32 v91, v90, v90
    v_sub_f32 v90, v61, v88
    v_fmac_f32 v91, v90, v90
    v_sub_f32 v90, v62, v88
    v_fmac_f32 v91, v90, v90
    v_sub_f32 v90, v63, v88
    v_fmac_f32 v91, v90, v90
    v_sub_f32 v90, v64, v88
    v_fmac_f32 v91, v90, v90
    v_sub_f32 v90, v65, v88
    v_fmac_f32 v91, v90, v90
    v_sub_f32 v90, v66, v88
    v_fmac_f32 v91, v90, v90
    v_sub_f32 v90, v67, v88
    v_fmac_f32 v91, v90, v90
    v_sub_f32 v90, v68, v88
    v_fmac_f32 v91, v90, v90
    v_sub_f32 v90, v69, v88
    v_fmac_f32 v91, v90, v90
    v_sub_f32 v90, v70, v88
    v_fmac_f32 v91, v90, v90
    v_sub_f32 v90, v71, v88
    v_fmac_f32 v91, v90, v90
    v_sub_f32 v90, v72, v88
    v_fmac_f32 v91, v90, v90
    v_sub_f32 v90, v73, v88
    v_fmac_f32 v91, v90, v90
    v_sub_f32 v90, v74, v88
    v_fmac_f32 v91, v90, v90
    v_sub_f32 v90, v75, v88
    v_fmac_f32 v91, v90, v90
    v_sub_f32 v90, v76, v88
    v_fmac_f32 v91, v90, v90
    v_sub_f32 v90, v77, v88
    v_fmac_f32 v91, v90, v90
    v_sub_f32 v90, v78, v88
    v_fmac_f32 v91, v90, v90
    v_sub_f32 v90, v79, v88
    v_fmac_f32 v91, v90, v90
    v_sub_f32 v90, v80, v88
    v_fmac_f32 v91, v90, v90
    v_sub_f32 v90, v81, v88
    v_fmac_f32 v91, v90, v90
    v_sub_f32 v90, v82, v88
    v_fmac_f32 v91, v90, v90
    v_sub_f32 v90, v83, v88
    v_fmac_f32 v91, v90, v90
    v_sub_f32 v90, v84, v88
    v_fmac_f32 v91, v90, v90
    v_sub_f32 v90, v85, v88
    v_fmac_f32 v91, v90, v90
    v_sub_f32 v90, v86, v88
    v_fmac_f32 v91, v90, v90
    v_sub_f32 v90, v87, v88
    v_fmac_f32 v91, v90, v90
    ds_swizzle_b32 v89, v91 offset:0x41f
    s_waitcnt lgkmcnt(0)
    v_add_f32 v91, v91, v89
    ds_swizzle_b32 v89, v91 offset:0x81f
    s_waitcnt lgkmcnt(0)
    v_add_f32 v91, v91, v89
    ds_swizzle_b32 v89, v91 offset:0x101f
    s_waitcnt lgkmcnt(0)
    v_add_f32 v91, v91, v89
    ds_swizzle_b32 v89, v91 offset:0x201f
    s_waitcnt lgkmcnt(0)
    v_add_f32 v91, v91, v89
    v_mul_f32 v91, s18, v91
    v_cvt_pk_bf16_f32 v88, v88, v88
    v_and_b32 v88, 0xffff0000, v88
    v_cvt_pk_bf16_f32 v91, v91, v91
    v_and_b32 v91, 0xffff0000, v91
    v_add_f32 v91, 0x3727c5ac, v91
    v_cvt_pk_bf16_f32 v91, v91, v91
    v_and_b32 v91, 0xffff0000, v91
    v_sqrt_f32 v91, v91
    s_nop 0
    v_cvt_pk_bf16_f32 v91, v91, v91
    v_and_b32 v91, 0xffff0000, v91
    v_rcp_f32 v92, v91
    v_sub_f32 v48, v48, v88
    v_sub_f32 v49, v49, v88
    v_sub_f32 v50, v50, v88
    v_sub_f32 v51, v51, v88
    v_sub_f32 v52, v52, v88
    v_sub_f32 v53, v53, v88
    v_sub_f32 v54, v54, v88
    v_sub_f32 v55, v55, v88
    v_sub_f32 v56, v56, v88
    v_sub_f32 v57, v57, v88
    v_sub_f32 v58, v58, v88
    v_sub_f32 v59, v59, v88
    v_sub_f32 v60, v60, v88
    v_sub_f32 v61, v61, v88
    v_sub_f32 v62, v62, v88
    v_sub_f32 v63, v63, v88
    v_sub_f32 v64, v64, v88
    v_sub_f32 v65, v65, v88
    v_sub_f32 v66, v66, v88
    v_sub_f32 v67, v67, v88
    v_sub_f32 v68, v68, v88
    v_sub_f32 v69, v69, v88
    v_sub_f32 v70, v70, v88
    v_sub_f32 v71, v71, v88
    v_sub_f32 v72, v72, v88
    v_sub_f32 v73, v73, v88
    v_sub_f32 v74, v74, v88
    v_sub_f32 v75, v75, v88
    v_sub_f32 v76, v76, v88
    v_sub_f32 v77, v77, v88
    v_sub_f32 v78, v78, v88
    v_sub_f32 v79, v79, v88
    v_sub_f32 v80, v80, v88
    v_sub_f32 v81, v81, v88
    v_sub_f32 v82, v82, v88
    v_sub_f32 v83, v83, v88
    v_sub_f32 v84, v84, v88
    v_sub_f32 v85, v85, v88
    v_sub_f32 v86, v86, v88
    v_sub_f32 v87, v87, v88
    v_cvt_pk_bf16_f32 v90, v48, v49
    v_lshlrev_b32 v48, 16, v90
    v_and_b32 v49, 0xffff0000, v90
    v_cvt_pk_bf16_f32 v90, v50, v51
    v_lshlrev_b32 v50, 16, v90
    v_and_b32 v51, 0xffff0000, v90
    v_cvt_pk_bf16_f32 v90, v52, v53
    v_lshlrev_b32 v52, 16, v90
    v_and_b32 v53, 0xffff0000, v90
    v_cvt_pk_bf16_f32 v90, v54, v55
    v_lshlrev_b32 v54, 16, v90
    v_and_b32 v55, 0xffff0000, v90
    v_cvt_pk_bf16_f32 v90, v56, v57
    v_lshlrev_b32 v56, 16, v90
    v_and_b32 v57, 0xffff0000, v90
    v_cvt_pk_bf16_f32 v90, v58, v59
    v_lshlrev_b32 v58, 16, v90
    v_and_b32 v59, 0xffff0000, v90
    v_cvt_pk_bf16_f32 v90, v60, v61
    v_lshlrev_b32 v60, 16, v90
    v_and_b32 v61, 0xffff0000, v90
    v_cvt_pk_bf16_f32 v90, v62, v63
    v_lshlrev_b32 v62, 16, v90
    v_and_b32 v63, 0xffff0000, v90
    v_cvt_pk_bf16_f32 v90, v64, v65
    v_lshlrev_b32 v64, 16, v90
    v_and_b32 v65, 0xffff0000, v90
    v_cvt_pk_bf16_f32 v90, v66, v67
    v_lshlrev_b32 v66, 16, v90
    v_and_b32 v67, 0xffff0000, v90
    v_cvt_pk_bf16_f32 v90, v68, v69
    v_lshlrev_b32 v68, 16, v90
    v_and_b32 v69, 0xffff0000, v90
    v_cvt_pk_bf16_f32 v90, v70, v71
    v_lshlrev_b32 v70, 16, v90
    v_and_b32 v71, 0xffff0000, v90
    v_cvt_pk_bf16_f32 v90, v72, v73
    v_lshlrev_b32 v72, 16, v90
    v_and_b32 v73, 0xffff0000, v90
    v_cvt_pk_bf16_f32 v90, v74, v75
    v_lshlrev_b32 v74, 16, v90
    v_and_b32 v75, 0xffff0000, v90
    v_cvt_pk_bf16_f32 v90, v76, v77
    v_lshlrev_b32 v76, 16, v90
    v_and_b32 v77, 0xffff0000, v90
    v_cvt_pk_bf16_f32 v90, v78, v79
    v_lshlrev_b32 v78, 16, v90
    v_and_b32 v79, 0xffff0000, v90
    v_cvt_pk_bf16_f32 v90, v80, v81
    v_lshlrev_b32 v80, 16, v90
    v_and_b32 v81, 0xffff0000, v90
    v_cvt_pk_bf16_f32 v90, v82, v83
    v_lshlrev_b32 v82, 16, v90
    v_and_b32 v83, 0xffff0000, v90
    v_cvt_pk_bf16_f32 v90, v84, v85
    v_lshlrev_b32 v84, 16, v90
    v_and_b32 v85, 0xffff0000, v90
    v_cvt_pk_bf16_f32 v90, v86, v87
    v_lshlrev_b32 v86, 16, v90
    v_and_b32 v87, 0xffff0000, v90
    v_mul_f32 v90, v48, v92
    v_fma_f32 v93, -v90, v91, v48
    v_fma_f32 v48, v93, v92, v90
    v_mul_f32 v90, v49, v92
    v_fma_f32 v93, -v90, v91, v49
    v_fma_f32 v49, v93, v92, v90
    v_mul_f32 v90, v50, v92
    v_fma_f32 v93, -v90, v91, v50
    v_fma_f32 v50, v93, v92, v90
    v_mul_f32 v90, v51, v92
    v_fma_f32 v93, -v90, v91, v51
    v_fma_f32 v51, v93, v92, v90
    v_mul_f32 v90, v52, v92
    v_fma_f32 v93, -v90, v91, v52
    v_fma_f32 v52, v93, v92, v90
    v_mul_f32 v90, v53, v92
    v_fma_f32 v93, -v90, v91, v53
    v_fma_f32 v53, v93, v92, v90
    v_mul_f32 v90, v54, v92
    v_fma_f32 v93, -v90, v91, v54
    v_fma_f32 v54, v93, v92, v90
    v_mul_f32 v90, v55, v92
    v_fma_f32 v93, -v90, v91, v55
    v_fma_f32 v55, v93, v92, v90
    v_mul_f32 v90, v56, v92
    v_fma_f32 v93, -v90, v91, v56
    v_fma_f32 v56, v93, v92, v90
    v_mul_f32 v90, v57, v92
    v_fma_f32 v93, -v90, v91, v57
    v_fma_f32 v57, v93, v92, v90
    v_mul_f32 v90, v58, v92
    v_fma_f32 v93, -v90, v91, v58
    v_fma_f32 v58, v93, v92, v90
    v_mul_f32 v90, v59, v92
    v_fma_f32 v93, -v90, v91, v59
    v_fma_f32 v59, v93, v92, v90
    v_mul_f32 v90, v60, v92
    v_fma_f32 v93, -v90, v91, v60
    v_fma_f32 v60, v93, v92, v90
    v_mul_f32 v90, v61, v92
    v_fma_f32 v93, -v90, v91, v61
    v_fma_f32 v61, v93, v92, v90
    v_mul_f32 v90, v62, v92
    v_fma_f32 v93, -v90, v91, v62
    v_fma_f32 v62, v93, v92, v90
    v_mul_f32 v90, v63, v92
    v_fma_f32 v93, -v90, v91, v63
    v_fma_f32 v63, v93, v92, v90
    v_mul_f32 v90, v64, v92
    v_fma_f32 v93, -v90, v91, v64
    v_fma_f32 v64, v93, v92, v90
    v_mul_f32 v90, v65, v92
    v_fma_f32 v93, -v90, v91, v65
    v_fma_f32 v65, v93, v92, v90
    v_mul_f32 v90, v66, v92
    v_fma_f32 v93, -v90, v91, v66
    v_fma_f32 v66, v93, v92, v90
    v_mul_f32 v90, v67, v92
    v_fma_f32 v93, -v90, v91, v67
    v_fma_f32 v67, v93, v92, v90
    v_mul_f32 v90, v68, v92
    v_fma_f32 v93, -v90, v91, v68
    v_fma_f32 v68, v93, v92, v90
    v_mul_f32 v90, v69, v92
    v_fma_f32 v93, -v90, v91, v69
    v_fma_f32 v69, v93, v92, v90
    v_mul_f32 v90, v70, v92
    v_fma_f32 v93, -v90, v91, v70
    v_fma_f32 v70, v93, v92, v90
    v_mul_f32 v90, v71, v92
    v_fma_f32 v93, -v90, v91, v71
    v_fma_f32 v71, v93, v92, v90
    v_mul_f32 v90, v72, v92
    v_fma_f32 v93, -v90, v91, v72
    v_fma_f32 v72, v93, v92, v90
    v_mul_f32 v90, v73, v92
    v_fma_f32 v93, -v90, v91, v73
    v_fma_f32 v73, v93, v92, v90
    v_mul_f32 v90, v74, v92
    v_fma_f32 v93, -v90, v91, v74
    v_fma_f32 v74, v93, v92, v90
    v_mul_f32 v90, v75, v92
    v_fma_f32 v93, -v90, v91, v75
    v_fma_f32 v75, v93, v92, v90
    v_mul_f32 v90, v76, v92
    v_fma_f32 v93, -v90, v91, v76
    v_fma_f32 v76, v93, v92, v90
    v_mul_f32 v90, v77, v92
    v_fma_f32 v93, -v90, v91, v77
    v_fma_f32 v77, v93, v92, v90
    v_mul_f32 v90, v78, v92
    v_fma_f32 v93, -v90, v91, v78
    v_fma_f32 v78, v93, v92, v90
    v_mul_f32 v90, v79, v92
    v_fma_f32 v93, -v90, v91, v79
    v_fma_f32 v79, v93, v92, v90
    v_mul_f32 v90, v80, v92
    v_fma_f32 v93, -v90, v91, v80
    v_fma_f32 v80, v93, v92, v90
    v_mul_f32 v90, v81, v92
    v_fma_f32 v93, -v90, v91, v81
    v_fma_f32 v81, v93, v92, v90
    v_mul_f32 v90, v82, v92
    v_fma_f32 v93, -v90, v91, v82
    v_fma_f32 v82, v93, v92, v90
    v_mul_f32 v90, v83, v92
    v_fma_f32 v93, -v90, v91, v83
    v_fma_f32 v83, v93, v92, v90
    v_mul_f32 v90, v84, v92
    v_fma_f32 v93, -v90, v91, v84
    v_fma_f32 v84, v93, v92, v90
    v_mul_f32 v90, v85, v92
    v_fma_f32 v93, -v90, v91, v85
    v_fma_f32 v85, v93, v92, v90
    v_mul_f32 v90, v86, v92
    v_fma_f32 v93, -v90, v91, v86
    v_fma_f32 v86, v93, v92, v90
    v_mul_f32 v90, v87, v92
    v_fma_f32 v93, -v90, v91, v87
    v_fma_f32 v87, v93, v92, v90
    v_cvt_pk_bf16_f32 v8, v48, v49
    v_cvt_pk_bf16_f32 v9, v50, v51
    v_cvt_pk_bf16_f32 v10, v52, v53
    v_cvt_pk_bf16_f32 v11, v54, v55
    v_cvt_pk_bf16_f32 v12, v56, v57
    v_cvt_pk_bf16_f32 v13, v58, v59
    v_cvt_pk_bf16_f32 v14, v60, v61
    v_cvt_pk_bf16_f32 v15, v62, v63
    v_cvt_pk_bf16_f32 v16, v64, v65
    v_cvt_pk_bf16_f32 v17, v66, v67
    v_cvt_pk_bf16_f32 v18, v68, v69
    v_cvt_pk_bf16_f32 v19, v70, v71
    v_cvt_pk_bf16_f32 v20, v72, v73
    v_cvt_pk_bf16_f32 v21, v74, v75
    v_cvt_pk_bf16_f32 v22, v76, v77
    v_cvt_pk_bf16_f32 v23, v78, v79
    v_cvt_pk_bf16_f32 v24, v80, v81
    v_cvt_pk_bf16_f32 v25, v82, v83
    v_cvt_pk_bf16_f32 v26, v84, v85
    v_cvt_pk_bf16_f32 v27, v86, v87
    v_lshlrev_b32 v48, 16, v8
    v_and_b32 v49, 0xffff0000, v8
    v_lshlrev_b32 v50, 16, v9
    v_and_b32 v51, 0xffff0000, v9
    v_lshlrev_b32 v52, 16, v10
    v_and_b32 v53, 0xffff0000, v10
    v_lshlrev_b32 v54, 16, v11
    v_and_b32 v55, 0xffff0000, v11
    v_lshlrev_b32 v56, 16, v12
    v_and_b32 v57, 0xffff0000, v12
    v_lshlrev_b32 v58, 16, v13
    v_and_b32 v59, 0xffff0000, v13
    v_lshlrev_b32 v60, 16, v14
    v_and_b32 v61, 0xffff0000, v14
    v_lshlrev_b32 v62, 16, v15
    v_and_b32 v63, 0xffff0000, v15
    v_lshlrev_b32 v64, 16, v16
    v_and_b32 v65, 0xffff0000, v16
    v_lshlrev_b32 v66, 16, v17
    v_and_b32 v67, 0xffff0000, v17
    v_lshlrev_b32 v68, 16, v18
    v_and_b32 v69, 0xffff0000, v18
    v_lshlrev_b32 v70, 16, v19
    v_and_b32 v71, 0xffff0000, v19
    v_lshlrev_b32 v72, 16, v20
    v_and_b32 v73, 0xffff0000, v20
    v_lshlrev_b32 v74, 16, v21
    v_and_b32 v75, 0xffff0000, v21
    v_lshlrev_b32 v76, 16, v22
    v_and_b32 v77, 0xffff0000, v22
    v_lshlrev_b32 v78, 16, v23
    v_and_b32 v79, 0xffff0000, v23
    v_lshlrev_b32 v80, 16, v24
    v_and_b32 v81, 0xffff0000, v24
    v_lshlrev_b32 v82, 16, v25
    v_and_b32 v83, 0xffff0000, v25
    v_lshlrev_b32 v84, 16, v26
    v_and_b32 v85, 0xffff0000, v26
    v_lshlrev_b32 v86, 16, v27
    v_and_b32 v87, 0xffff0000, v27
    buffer_store_dwordx4 v[8:11], v5, s[4:7], 0 offen offset:0
    buffer_store_dwordx4 v[12:15], v5, s[4:7], 0 offen offset:256
    buffer_store_dwordx4 v[16:19], v5, s[4:7], 0 offen offset:512
    buffer_store_dwordx4 v[20:23], v5, s[4:7], 0 offen offset:768
    buffer_store_dwordx4 v[24:27], v5, s[4:7], 0 offen offset:1024
    v_lshrrev_b32 v94, 4, v3
    v_mul_u32_u24 v94, 20480, v94
    v_lshrrev_b32 v95, 2, v4
    v_lshl_add_u32 v94, v95, 10, v94
    v_and_b32 v95, 3, v4
    v_lshl_add_u32 v94, v95, 8, v94
    v_and_b32 v95, 15, v3
    v_lshl_add_u32 v94, v95, 4, v94
    s_mov_b32 s19, 2621440
    buffer_store_dwordx4 v[8:11], v94, s[4:7], s19 offen
    s_mov_b32 s19, 2625536
    buffer_store_dwordx4 v[12:15], v94, s[4:7], s19 offen
    s_mov_b32 s19, 2629632
    buffer_store_dwordx4 v[16:19], v94, s[4:7], s19 offen
    s_mov_b32 s19, 2633728
    buffer_store_dwordx4 v[20:23], v94, s[4:7], s19 offen
    s_mov_b32 s19, 2637824
    buffer_store_dwordx4 v[24:27], v94, s[4:7], s19 offen
    s_waitcnt vmcnt(10)
    v_mov_b32 v88, 0
    v_lshlrev_b32 v90, 16, v28
    v_and_b32 v93, 0xffff0000, v28
    v_fmac_f32 v88, v90, v48
    v_fmac_f32 v88, v93, v49
    v_lshlrev_b32 v90, 16, v29
    v_and_b32 v93, 0xffff0000, v29
    v_fmac_f32 v88, v90, v50
    v_fmac_f32 v88, v93, v51
    v_lshlrev_b32 v90, 16, v30
    v_and_b32 v93, 0xffff0000, v30
    v_fmac_f32 v88, v90, v52
    v_fmac_f32 v88, v93, v53
    v_lshlrev_b32 v90, 16, v31
    v_and_b32 v93, 0xffff0000, v31
    v_fmac_f32 v88, v90, v54
    v_fmac_f32 v88, v93, v55
    v_lshlrev_b32 v90, 16, v32
    v_and_b32 v93, 0xffff0000, v32
    v_fmac_f32 v88, v90, v56
    v_fmac_f32 v88, v93, v57
    v_lshlrev_b32 v90, 16, v33
    v_and_b32 v93, 0xffff0000, v33
    v_fmac_f32 v88, v90, v58
    v_fmac_f32 v88, v93, v59
    v_lshlrev_b32 v90, 16, v34
    v_and_b32 v93, 0xffff0000, v34
    v_fmac_f32 v88, v90, v60
    v_fmac_f32 v88, v93, v61
    v_lshlrev_b32 v90, 16, v35
    v_and_b32 v93, 0xffff0000, v35
    v_fmac_f32 v88, v90, v62
    v_fmac_f32 v88, v93, v63
    v_lshlrev_b32 v90, 16, v36
    v_and_b32 v93, 0xffff0000, v36
    v_fmac_f32 v88, v90, v64
    v_fmac_f32 v88, v93, v65
    v_lshlrev_b32 v90, 16, v37
    v_and_b32 v93, 0xffff0000, v37
    v_fmac_f32 v88, v90, v66
    v_fmac_f32 v88, v93, v67
    v_lshlrev_b32 v90, 16, v38
    v_and_b32 v93, 0xffff0000, v38
    v_fmac_f32 v88, v90, v68
    v_fmac_f32 v88, v93, v69
    v_lshlrev_b32 v90, 16, v39
    v_and_b32 v93, 0xffff0000, v39
    v_fmac_f32 v88, v90, v70
    v_fmac_f32 v88, v93, v71
    v_lshlrev_b32 v90, 16, v40
    v_and_b32 v93, 0xffff0000, v40
    v_fmac_f32 v88, v90, v72
    v_fmac_f32 v88, v93, v73
    v_lshlrev_b32 v90, 16, v41
    v_and_b32 v93, 0xffff0000, v41
    v_fmac_f32 v88, v90, v74
    v_fmac_f32 v88, v93, v75
    v_lshlrev_b32 v90, 16, v42
    v_and_b32 v93, 0xffff0000, v42
    v_fmac_f32 v88, v90, v76
    v_fmac_f32 v88, v93, v77
    v_lshlrev_b32 v90, 16, v43
    v_and_b32 v93, 0xffff0000, v43
    v_fmac_f32 v88, v90, v78
    v_fmac_f32 v88, v93, v79
    v_lshlrev_b32 v90, 16, v44
    v_and_b32 v93, 0xffff0000, v44
    v_fmac_f32 v88, v90, v80
    v_fmac_f32 v88, v93, v81
    v_lshlrev_b32 v90, 16, v45
    v_and_b32 v93, 0xffff0000, v45
    v_fmac_f32 v88, v90, v82
    v_fmac_f32 v88, v93, v83
    v_lshlrev_b32 v90, 16, v46
    v_and_b32 v93, 0xffff0000, v46
    v_fmac_f32 v88, v90, v84
    v_fmac_f32 v88, v93, v85
    v_lshlrev_b32 v90, 16, v47
    v_and_b32 v93, 0xffff0000, v47
    v_fmac_f32 v88, v90, v86
    v_fmac_f32 v88, v93, v87
    ds_swizzle_b32 v89, v88 offset:0x41f
    s_waitcnt lgkmcnt(0)
    v_add_f32 v88, v88, v89
    ds_swizzle_b32 v89, v88 offset:0x81f
    s_waitcnt lgkmcnt(0)
    v_add_f32 v88, v88, v89
    ds_swizzle_b32 v89, v88 offset:0x101f
    s_waitcnt lgkmcnt(0)
    v_add_f32 v88, v88, v89
    ds_swizzle_b32 v89, v88 offset:0x201f
    s_waitcnt lgkmcnt(0)
    v_add_f32 v88, v88, v89
    v_cvt_pk_bf16_f32 v88, v88, v88
    v_and_b32 v88, 0xffff0000, v88
    v_lshlrev_b32 v94, 2, v3
    v_cmp_eq_u32 vcc, 0, v4
    s_and_saveexec_b64 s[20:21], vcc
    s_mov_b32 s19, 5242880
    buffer_store_dword v88, v94, s[4:7], s19 offen
    s_mov_b64 exec, s[20:21]
    s_branch K1_END
K1_NOT_LN:
    s_cmp_ge_u32 s2, 477
    s_cbranch_scc1 K1_FILL
    s_sub_u32 s16, s2, 128
    s_lshl_b32 s16, s16, 2
    s_add_u32 s16, s16, s3
    s_cmp_lt_u32 s16, 768
    s_cbranch_scc0 K1_P1
    s_lshr_b32 s17, s16, 8
    s_lshl_b32 s20, s17, 3
    s_add_u32 s20, s20, 16
    s_mov_b32 s21, 8192
    s_mov_b32 s22, 5242880
    s_lshr_b32 s23, s16, 2
    s_and_b32 s23, s23, 63
    s_and_b32 s24, s16, 3
    s_mul_i32 s24, s24, 5
    s_mov_b32 s25, 5
    s_mov_b32 s26, 0
    s_mul_i32 s27, s17, 5242880
    s_add_u32 s27, s27, 6291456
    s_mov_b32 s28, 20
    s_branch K1_PGO
K1_P1:
    s_cmp_lt_u32 s16, 1088
    s_cbranch_scc0 K1_P2
    s_sub_u32 s17, s16, 768
    s_mov_b32 s20, 40
    s_mov_b32 s21, 1280
    s_mov_b32 s22, 5242880
    s_lshr_b32 s23, s17, 5
    s_and_b32 s24, s17, 31
    s_lshl_b32 s24, s24, 2
    s_mov_b32 s25, 4
    s_mov_b32 s26, 1
    s_mov_b32 s27, 22020096
    s_mov_b32 s28, 128
    s_branch K1_PGO
K1_P2:
    s_cmp_lt_u32 s16, 1304
    s_cbranch_scc0 K1_P3
    s_sub_u32 s17, s16, 1088
    s_and_b32 s24, s17, 3
    s_mul_i32 s24, s24, 5
    s_lshr_b32 s17, s17, 2
    s_cmp_ge_u32 s17, 27
    s_cselect_b32 s18, 27, 0
    s_mov_b32 s20, 72
    s_mov_b32 s27, 27262976
    s_cselect_b32 s19, 8, 0
    s_add_u32 s20, s20, s19
    s_cmp_ge_u32 s17, 27
    s_cselect_b32 s19, 2621440, 0
    s_add_u32 s27, s27, s19
    s_sub_u32 s23, s17, s18
    s_mov_b32 s21, 3456
    s_mov_b32 s22, 2211840
    s_mov_b32 s25, 5
    s_mov_b32 s26, 0
    s_mov_b32 s28, 20
    s_branch K1_PGO
K1_P3:
    s_sub_u32 s17, s16, 1304
    s_cmp_ge_u32 s17, 90
    s_cbranch_scc1 K1_END
    s_mov_b32 s20, 88
    s_mov_b32 s21, 1280
    s_mov_b32 s22, 2211840
    s_mul_i32 s23, s17, 7282
    s_lshr_b32 s23, s23, 16
    s_mul_i32 s24, s23, 9
    s_sub_u32 s24, s17, s24
    s_mul_i32 s24, s24, 6
    s_mov_b32 s25, 6
    s_mov_b32 s26, 0
    s_mov_b32 s27, 32505856
    s_mov_b32 s28, 54
K1_PGO:
    s_load_dwordx2 s[8:9], s[0:1], s20
    s_mov_b32 s10, s22
    s_mov_b32 s11, 0x00020000
    v_lshrrev_b32 v3, 3, v2
    v_mul_lo_u32 v3, v3, s21
    v_and_b32 v4, 7, v2
    v_lshl_add_u32 v3, v4, 4, v3
    s_lshl_b32 s17, s23, 7
    v_add_u32 v3, s17, v3
    s_lshl_b32 s31, s21, 3
    s_lshl_b32 s17, s3, 12
    v_lshlrev_b32 v5, 4, v2
    v_add_u32 v5, s17, v5
    v_lshrrev_b32 v6, 4, v2
    s_cmp_eq_u32 s26, 1
    s_cselect_b32 s18, 2, 3
    s_cselect_b32 s19, 16, 4
    s_lshl_b32 s19, s19, 7
    v_lshlrev_b32 v6, s18, v6
    v_and_b32 v7, 15, v2
    v_lshrrev_b32 v8, 2, v7
    v_add_u32 v6, v6, v8
    v_lshlrev_b32 v6, 7, v6
    v_and_b32 v7, 3, v7
    v_lshl_add_u32 v6, v7, 3, v6
    v_add_u32 v6, s17, v6
    v_add_u32 v7, s19, v6
    v_lshlrev_b32 v16, 4, v2
    s_lshl_b32 s17, s23, 2
    s_mul_i32 s17, s17, s28
    s_add_u32 s17, s17, s24
    s_lshl_b32 s17, s17, 10
    s_add_u32 s27, s27, s17
    s_lshl_b32 s28, s28, 10
    s_mul_i32 s29, s24, s21
    s_lshl_b32 s29, s29, 5
    s_waitcnt lgkmcnt(0)
    buffer_load_dwordx4 v[20:23], v3, s[8:11], s29 offen
    s_add_u32 s29, s29, s31
    buffer_load_dwordx4 v[24:27], v3, s[8:11], s29 offen
    s_add_u32 s29, s29, s31
    buffer_load_dwordx4 v[28:31], v3, s[8:11], s29 offen
    s_add_u32 s29, s29, s31
    buffer_load_dwordx4 v[32:35], v3, s[8:11], s29 offen
    s_add_u32 s29, s29, s31
K1_PLOOP:
    s_waitcnt vmcnt(0)
    ds_write_b128 v5, v[20:23] offset:0
    ds_write_b128 v5, v[24:27] offset:1024
    ds_write_b128 v5, v[28:31] offset:2048
    ds_write_b128 v5, v[32:35] offset:3072
    s_waitcnt lgkmcnt(0)
    s_sub_u32 s25, s25, 1
    s_cmp_eq_u32 s25, 0
    s_cbranch_scc1 K1_PNOGL
    buffer_load_dwordx4 v[20:23], v3, s[8:11], s29 offen
    s_add_u32 s29, s29, s31
    buffer_load_dwordx4 v[24:27], v3, s[8:11], s29 offen
    s_add_u32 s29, s29, s31
    buffer_load_dwordx4 v[28:31], v3, s[8:11], s29 offen
    s_add_u32 s29, s29, s31
    buffer_load_dwordx4 v[32:35], v3, s[8:11], s29 offen
    s_add_u32 s29, s29, s31
K1_PNOGL:
    ds_read_b64_tr_b16 v[40:41], v6 offset:0
    ds_read_b64_tr_b16 v[42:43], v7 offset:0
    ds_read_b64_tr_b16 v[44:45], v6 offset:32
    ds_read_b64_tr_b16 v[46:47], v7 offset:32
    ds_read_b64_tr_b16 v[48:49], v6 offset:64
    ds_read_b64_tr_b16 v[50:51], v7 offset:64
    ds_read_b64_tr_b16 v[52:53], v6 offset:96
    ds_read_b64_tr_b16 v[54:55], v7 offset:96
    s_waitcnt lgkmcnt(0)
    s_mov_b32 s17, s27
    buffer_store_dwordx4 v[40:43], v16, s[4:7], s17 offen
    s_add_u32 s17, s17, s28
    buffer_store_dwordx4 v[44:47], v16, s[4:7], s17 offen
    s_add_u32 s17, s17, s28
    buffer_store_dwordx4 v[48:51], v16, s[4:7], s17 offen
    s_add_u32 s17, s17, s28
    buffer_store_dwordx4 v[52:55], v16, s[4:7], s17 offen
    s_add_u32 s17, s17, s28
    s_add_u32 s27, s27, 1024
    s_cmp_lg_u32 s25, 0
    s_cbranch_scc1 K1_PLOOP
    s_branch K1_END
K1_FILL:
    s_sub_u32 s16, s2, 477
    s_lshl_b32 s16, s16, 16
    s_add_u32 s16, s16, 119537664
    v_lshlrev_b32 v3, 4, v0
    v_mov_b32 v4, 0
    v_mov_b32 v5, 0
    v_mov_b32 v6, 0
    v_mov_b32 v7, 0
    s_waitcnt lgkmcnt(0)
    buffer_store_dwordx4 v[4:7], v3, s[4:7], s16 offen
    s_add_u32 s16, s16, 4096
    buffer_store_dwordx4 v[4:7], v3, s[4:7], s16 offen
    s_add_u32 s16, s16, 4096
    buffer_store_dwordx4 v[4:7], v3, s[4:7], s16 offen
    s_add_u32 s16, s16, 4096
    buffer_store_dwordx4 v[4:7], v3, s[4:7], s16 offen
    s_add_u32 s16, s16, 4096
    buffer_store_dwordx4 v[4:7], v3, s[4:7], s16 offen
    s_add_u32 s16, s16, 4096
    buffer_store_dwordx4 v[4:7], v3, s[4:7], s16 offen
    s_add_u32 s16, s16, 4096
    buffer_store_dwordx4 v[4:7], v3, s[4:7], s16 offen
    s_add_u32 s16, s16, 4096
    buffer_store_dwordx4 v[4:7], v3, s[4:7], s16 offen
    s_add_u32 s16, s16, 4096
    buffer_store_dwordx4 v[4:7], v3, s[4:7], s16 offen
    s_add_u32 s16, s16, 4096
    buffer_store_dwordx4 v[4:7], v3, s[4:7], s16 offen
    s_add_u32 s16, s16, 4096
    buffer_store_dwordx4 v[4:7], v3, s[4:7], s16 offen
    s_add_u32 s16, s16, 4096
    buffer_store_dwordx4 v[4:7], v3, s[4:7], s16 offen
    s_add_u32 s16, s16, 4096
    buffer_store_dwordx4 v[4:7], v3, s[4:7], s16 offen
    s_add_u32 s16, s16, 4096
    buffer_store_dwordx4 v[4:7], v3, s[4:7], s16 offen
    s_add_u32 s16, s16, 4096
    buffer_store_dwordx4 v[4:7], v3, s[4:7], s16 offen
    s_add_u32 s16, s16, 4096
    buffer_store_dwordx4 v[4:7], v3, s[4:7], s16 offen
K1_END:
    s_endpgm
.text
.globl k3_kernel
.p2align 8
.type k3_kernel,@function
k3_kernel:
    s_load_dwordx2 s[4:5], s[0:1], 112
    s_cmp_ge_u32 s2, 1563
    s_cbranch_scc1 K3_END
    s_cmp_lt_u32 s2, 1536
    s_cbranch_scc1 K3_GEMM
    s_sub_u32 s2, s2, 1536
    v_lshrrev_b32 v1, 6, v0
    s_nop 0
    v_readfirstlane_b32 s3, v1
    v_and_b32 v2, 63, v0
    s_mov_b32 s6, 268435456
    s_mov_b32 s7, 0x00020000
    s_waitcnt lgkmcnt(0)
    v_lshlrev_b32 v3, 2, v2
    s_mov_b32 s19, 5242880
    buffer_load_dword v64, v3, s[4:7], s19 offen offset:0
    buffer_load_dword v65, v3, s[4:7], s19 offen offset:256
    buffer_load_dword v66, v3, s[4:7], s19 offen offset:512
    buffer_load_dword v67, v3, s[4:7], s19 offen offset:768
    buffer_load_dword v68, v3, s[4:7], s19 offen offset:1024
    buffer_load_dword v69, v3, s[4:7], s19 offen offset:1280
    buffer_load_dword v70, v3, s[4:7], s19 offen offset:1536
    buffer_load_dword v71, v3, s[4:7], s19 offen offset:1792
    buffer_load_dword v72, v3, s[4:7], s19 offen offset:2048
    buffer_load_dword v73, v3, s[4:7], s19 offen offset:2304
    buffer_load_dword v74, v3, s[4:7], s19 offen offset:2560
    buffer_load_dword v75, v3, s[4:7], s19 offen offset:2816
    buffer_load_dword v76, v3, s[4:7], s19 offen offset:3072
    buffer_load_dword v77, v3, s[4:7], s19 offen offset:3328
    buffer_load_dword v78, v3, s[4:7], s19 offen offset:3584
    buffer_load_dword v79, v3, s[4:7], s19 offen offset:3840
    s_add_u32 s19, s19, 4096
    buffer_load_dword v80, v3, s[4:7], s19 offen offset:0
    buffer_load_dword v81, v3, s[4:7], s19 offen offset:256
    buffer_load_dword v82, v3, s[4:7], s19 offen offset:512
    buffer_load_dword v83, v3, s[4:7], s19 offen offset:768
    buffer_load_dword v84, v3, s[4:7], s19 offen offset:1024
    buffer_load_dword v85, v3, s[4:7], s19 offen offset:1280
    buffer_load_dword v86, v3, s[4:7], s19 offen offset:1536
    buffer_load_dword v87, v3, s[4:7], s19 offen offset:1792
    buffer_load_dword v88, v3, s[4:7], s19 offen offset:2048
    buffer_load_dword v89, v3, s[4:7], s19 offen offset:2304
    buffer_load_dword v90, v3, s[4:7], s19 offen offset:2560
    buffer_load_dword v91, v3, s[4:7], s19 offen offset:2816
    buffer_load_dword v92, v3, s[4:7], s19 offen offset:3072
    buffer_load_dword v93, v3, s[4:7], s19 offen offset:3328
    buffer_load_dword v94, v3, s[4:7], s19 offen offset:3584
    buffer_load_dword v95, v3, s[4:7], s19 offen offset:3840
    s_waitcnt vmcnt(0)
    v_ashrrev_i32 v4, 31, v64
    v_or_b32 v4, 0x80000000, v4
    v_xor_b32 v64, v64, v4
    v_and_b32 v64, 0xffff0000, v64
    v_sub_u32 v4, 65535, v2
    v_or_b32 v64, v64, v4
    v_ashrrev_i32 v4, 31, v65
    v_or_b32 v4, 0x80000000, v4
    v_xor_b32 v65, v65, v4
    v_and_b32 v65, 0xffff0000, v65
    v_sub_u32 v4, 65471, v2
    v_or_b32 v65, v65, v4
    v_ashrrev_i32 v4, 31, v66
    v_or_b32 v4, 0x80000000, v4
    v_xor_b32 v66, v66, v4
    v_and_b32 v66, 0xffff0000, v66
    v_sub_u32 v4, 65407, v2
    v_or_b32 v66, v66, v4
    v_ashrrev_i32 v4, 31, v67
    v_or_b32 v4, 0x80000000, v4
    v_xor_b32 v67, v67, v4
    v_and_b32 v67, 0xffff0000, v67
    v_sub_u32 v4, 65343, v2
    v_or_b32 v67, v67, v4
    v_ashrrev_i32 v4, 31, v68
    v_or_b32 v4, 0x80000000, v4
    v_xor_b32 v68, v68, v4
    v_and_b32 v68, 0xffff0000, v68
    v_sub_u32 v4, 65279, v2
    v_or_b32 v68, v68, v4
    v_ashrrev_i32 v4, 31, v69
    v_or_b32 v4, 0x80000000, v4
    v_xor_b32 v69, v69, v4
    v_and_b32 v69, 0xffff0000, v69
    v_sub_u32 v4, 65215, v2
    v_or_b32 v69, v69, v4
    v_ashrrev_i32 v4, 31, v70
    v_or_b32 v4, 0x80000000, v4
    v_xor_b32 v70, v70, v4
    v_and_b32 v70, 0xffff0000, v70
    v_sub_u32 v4, 65151, v2
    v_or_b32 v70, v70, v4
    v_ashrrev_i32 v4, 31, v71
    v_or_b32 v4, 0x80000000, v4
    v_xor_b32 v71, v71, v4
    v_and_b32 v71, 0xffff0000, v71
    v_sub_u32 v4, 65087, v2
    v_or_b32 v71, v71, v4
    v_ashrrev_i32 v4, 31, v72
    v_or_b32 v4, 0x80000000, v4
    v_xor_b32 v72, v72, v4
    v_and_b32 v72, 0xffff0000, v72
    v_sub_u32 v4, 65023, v2
    v_or_b32 v72, v72, v4
    v_ashrrev_i32 v4, 31, v73
    v_or_b32 v4, 0x80000000, v4
    v_xor_b32 v73, v73, v4
    v_and_b32 v73, 0xffff0000, v73
    v_sub_u32 v4, 64959, v2
    v_or_b32 v73, v73, v4
    v_ashrrev_i32 v4, 31, v74
    v_or_b32 v4, 0x80000000, v4
    v_xor_b32 v74, v74, v4
    v_and_b32 v74, 0xffff0000, v74
    v_sub_u32 v4, 64895, v2
    v_or_b32 v74, v74, v4
    v_ashrrev_i32 v4, 31, v75
    v_or_b32 v4, 0x80000000, v4
    v_xor_b32 v75, v75, v4
    v_and_b32 v75, 0xffff0000, v75
    v_sub_u32 v4, 64831, v2
    v_or_b32 v75, v75, v4
    v_ashrrev_i32 v4, 31, v76
    v_or_b32 v4, 0x80000000, v4
    v_xor_b32 v76, v76, v4
    v_and_b32 v76, 0xffff0000, v76
    v_sub_u32 v4, 64767, v2
    v_or_b32 v76, v76, v4
    v_ashrrev_i32 v4, 31, v77
    v_or_b32 v4, 0x80000000, v4
    v_xor_b32 v77, v77, v4
    v_and_b32 v77, 0xffff0000, v77
    v_sub_u32 v4, 64703, v2
    v_or_b32 v77, v77, v4
    v_ashrrev_i32 v4, 31, v78
    v_or_b32 v4, 0x80000000, v4
    v_xor_b32 v78, v78, v4
    v_and_b32 v78, 0xffff0000, v78
    v_sub_u32 v4, 64639, v2
    v_or_b32 v78, v78, v4
    v_ashrrev_i32 v4, 31, v79
    v_or_b32 v4, 0x80000000, v4
    v_xor_b32 v79, v79, v4
    v_and_b32 v79, 0xffff0000, v79
    v_sub_u32 v4, 64575, v2
    v_or_b32 v79, v79, v4
    v_ashrrev_i32 v4, 31, v80
    v_or_b32 v4, 0x80000000, v4
    v_xor_b32 v80, v80, v4
    v_and_b32 v80, 0xffff0000, v80
    v_sub_u32 v4, 64511, v2
    v_or_b32 v80, v80, v4
    v_ashrrev_i32 v4, 31, v81
    v_or_b32 v4, 0x80000000, v4
    v_xor_b32 v81, v81, v4
    v_and_b32 v81, 0xffff0000, v81
    v_sub_u32 v4, 64447, v2
    v_or_b32 v81, v81, v4
    v_ashrrev_i32 v4, 31, v82
    v_or_b32 v4, 0x80000000, v4
    v_xor_b32 v82, v82, v4
    v_and_b32 v82, 0xffff0000, v82
    v_sub_u32 v4, 64383, v2
    v_or_b32 v82, v82, v4
    v_ashrrev_i32 v4, 31, v83
    v_or_b32 v4, 0x80000000, v4
    v_xor_b32 v83, v83, v4
    v_and_b32 v83, 0xffff0000, v83
    v_sub_u32 v4, 64319, v2
    v_or_b32 v83, v83, v4
    v_ashrrev_i32 v4, 31, v84
    v_or_b32 v4, 0x80000000, v4
    v_xor_b32 v84, v84, v4
    v_and_b32 v84, 0xffff0000, v84
    v_sub_u32 v4, 64255, v2
    v_or_b32 v84, v84, v4
    v_ashrrev_i32 v4, 31, v85
    v_or_b32 v4, 0x80000000, v4
    v_xor_b32 v85, v85, v4
    v_and_b32 v85, 0xffff0000, v85
    v_sub_u32 v4, 64191, v2
    v_or_b32 v85, v85, v4
    v_ashrrev_i32 v4, 31, v86
    v_or_b32 v4, 0x80000000, v4
    v_xor_b32 v86, v86, v4
    v_and_b32 v86, 0xffff0000, v86
    v_sub_u32 v4, 64127, v2
    v_or_b32 v86, v86, v4
    v_ashrrev_i32 v4, 31, v87
    v_or_b32 v4, 0x80000000, v4
    v_xor_b32 v87, v87, v4
    v_and_b32 v87, 0xffff0000, v87
    v_sub_u32 v4, 64063, v2
    v_or_b32 v87, v87, v4
    v_ashrrev_i32 v4, 31, v88
    v_or_b32 v4, 0x80000000, v4
    v_xor_b32 v88, v88, v4
    v_and_b32 v88, 0xffff0000, v88
    v_sub_u32 v4, 63999, v2
    v_or_b32 v88, v88, v4
    v_ashrrev_i32 v4, 31, v89
    v_or_b32 v4, 0x80000000, v4
    v_xor_b32 v89, v89, v4
    v_and_b32 v89, 0xffff0000, v89
    v_sub_u32 v4, 63935, v2
    v_or_b32 v89, v89, v4
    v_ashrrev_i32 v4, 31, v90
    v_or_b32 v4, 0x80000000, v4
    v_xor_b32 v90, v90, v4
    v_and_b32 v90, 0xffff0000, v90
    v_sub_u32 v4, 63871, v2
    v_or_b32 v90, v90, v4
    v_ashrrev_i32 v4, 31, v91
    v_or_b32 v4, 0x80000000, v4
    v_xor_b32 v91, v91, v4
    v_and_b32 v91, 0xffff0000, v91
    v_sub_u32 v4, 63807, v2
    v_or_b32 v91, v91, v4
    v_ashrrev_i32 v4, 31, v92
    v_or_b32 v4, 0x80000000, v4
    v_xor_b32 v92, v92, v4
    v_and_b32 v92, 0xffff0000, v92
    v_sub_u32 v4, 63743, v2
    v_or_b32 v92, v92, v4
    v_ashrrev_i32 v4, 31, v93
    v_or_b32 v4, 0x80000000, v4
    v_xor_b32 v93, v93, v4
    v_and_b32 v93, 0xffff0000, v93
    v_sub_u32 v4, 63679, v2
    v_or_b32 v93, v93, v4
    v_ashrrev_i32 v4, 31, v94
    v_or_b32 v4, 0x80000000, v4
    v_xor_b32 v94, v94, v4
    v_and_b32 v94, 0xffff0000, v94
    v_sub_u32 v4, 63615, v2
    v_or_b32 v94, v94, v4
    v_ashrrev_i32 v4, 31, v95
    v_or_b32 v4, 0x80000000, v4
    v_xor_b32 v95, v95, v4
    v_and_b32 v95, 0xffff0000, v95
    v_sub_u32 v4, 63551, v2
    v_or_b32 v95, v95, v4
    v_max3_u32 v4, v64, v65, v66
    v_max3_u32 v4, v4, v67, v68
    v_max3_u32 v4, v4, v69, v70
    v_max3_u32 v4, v4, v71, v72
    v_max3_u32 v4, v4, v73, v74
    v_max3_u32 v4, v4, v75, v76
    v_max3_u32 v4, v4, v77, v78
    v_max3_u32 v4, v4, v79, v80
    v_max3_u32 v4, v4, v81, v82
    v_max3_u32 v4, v4, v83, v84
    v_max3_u32 v4, v4, v85, v86
    v_max3_u32 v4, v4, v87, v88
    v_max3_u32 v4, v4, v89, v90
    v_max3_u32 v4, v4, v91, v92
    v_max3_u32 v4, v4, v93, v94
    v_max_u32 v4, v4, v95
    ds_swizzle_b32 v5, v4 offset:0x41f
    s_waitcnt lgkmcnt(0)
    v_max_u32 v4, v4, v5
    ds_swizzle_b32 v5, v4 offset:0x81f
    s_waitcnt lgkmcnt(0)
    v_max_u32 v4, v4, v5
    ds_swizzle_b32 v5, v4 offset:0x101f
    s_waitcnt lgkmcnt(0)
    v_max_u32 v4, v4, v5
    ds_swizzle_b32 v5, v4 offset:0x201f
    s_waitcnt lgkmcnt(0)
    v_max_u32 v4, v4, v5
    ds_swizzle_b32 v5, v4 offset:0x401f
    s_waitcnt lgkmcnt(0)
    v_max_u32 v4, v4, v5
    v_mov_b32 v5, v4
    s_nop 1
    v_permlane32_swap_b32 v4, v5
    v_max_u32 v4, v4, v5
    s_nop 0
    v_readfirstlane_b32 s50, v4
    v_cmp_ne_u32 vcc, v4, v64
    s_nop 1
    v_cndmask_b32 v64, 0, v64, vcc
    v_cmp_ne_u32 vcc, v4, v65
    s_nop 1
    v_cndmask_b32 v65, 0, v65, vcc
    v_cmp_ne_u32 vcc, v4, v66
    s_nop 1
    v_cndmask_b32 v66, 0, v66, vcc
    v_cmp_ne_u32 vcc, v4, v67
    s_nop 1
    v_cndmask_b32 v67, 0, v67, vcc
    v_cmp_ne_u32 vcc, v4, v68
    s_nop 1
    v_cndmask_b32 v68, 0, v68, vcc
    v_cmp_ne_u32 vcc, v4, v69
    s_nop 1
    v_cndmask_b32 v69, 0, v69, vcc
    v_cmp_ne_u32 vcc, v4, v70
    s_nop 1
    v_cndmask_b32 v70, 0, v70, vcc
    v_cmp_ne_u32 vcc, v4, v71
    s_nop 1
    v_cndmask_b32 v71, 0, v71, vcc
    v_cmp_ne_u32 vcc, v4, v72
    s_nop 1
    v_cndmask_b32 v72, 0, v72, vcc
    v_cmp_ne_u32 vcc, v4, v73
    s_nop 1
    v_cndmask_b32 v73, 0, v73, vcc
    v_cmp_ne_u32 vcc, v4, v74
    s_nop 1
    v_cndmask_b32 v74, 0, v74, vcc
    v_cmp_ne_u32 vcc, v4, v75
    s_nop 1
    v_cndmask_b32 v75, 0, v75, vcc
    v_cmp_ne_u32 vcc, v4, v76
    s_nop 1
    v_cndmask_b32 v76, 0, v76, vcc
    v_cmp_ne_u32 vcc, v4, v77
    s_nop 1
    v_cndmask_b32 v77, 0, v77, vcc
    v_cmp_ne_u32 vcc, v4, v78
    s_nop 1
    v_cndmask_b32 v78, 0, v78, vcc
    v_cmp_ne_u32 vcc, v4, v79
    s_nop 1
    v_cndmask_b32 v79, 0, v79, vcc
    v_cmp_ne_u32 vcc, v4, v80
    s_nop 1
    v_cndmask_b32 v80, 0, v80, vcc
    v_cmp_ne_u32 vcc, v4, v81
    s_nop 1
    v_cndmask_b32 v81, 0, v81, vcc
    v_cmp_ne_u32 vcc, v4, v82
    s_nop 1
    v_cndmask_b32 v82, 0, v82, vcc
    v_cmp_ne_u32 vcc, v4, v83
    s_nop 1
    v_cndmask_b32 v83, 0, v83, vcc
    v_cmp_ne_u32 vcc, v4, v84
    s_nop 1
    v_cndmask_b32 v84, 0, v84, vcc
    v_cmp_ne_u32 vcc, v4, v85
    s_nop 1
    v_cndmask_b32 v85, 0, v85, vcc
    v_cmp_ne_u32 vcc, v4, v86
    s_nop 1
    v_cndmask_b32 v86, 0, v86, vcc
    v_cmp_ne_u32 vcc, v4, v87
    s_nop 1
    v_cndmask_b32 v87, 0, v87, vcc
    v_cmp_ne_u32 vcc, v4, v88
    s_nop 1
    v_cndmask_b32 v88, 0, v88, vcc
    v_cmp_ne_u32 vcc, v4, v89
    s_nop 1
    v_cndmask_b32 v89, 0, v89, vcc
    v_cmp_ne_u32 vcc, v4, v90
    s_nop 1
    v_cndmask_b32 v90, 0, v90, vcc
    v_cmp_ne_u32 vcc, v4, v91
    s_nop 1
    v_cndmask_b32 v91, 0, v91, vcc
    v_cmp_ne_u32 vcc, v4, v92
    s_nop 1
    v_cndmask_b32 v92, 0, v92, vcc
    v_cmp_ne_u32 vcc, v4, v93
    s_nop 1
    v_cndmask_b32 v93, 0, v93, vcc
    v_cmp_ne_u32 vcc, v4, v94
    s_nop 1
    v_cndmask_b32 v94, 0, v94, vcc
    v_cmp_ne_u32 vcc, v4, v95
    s_nop 1
    v_cndmask_b32 v95, 0, v95, vcc
    v_max3_u32 v4, v64, v65, v66
    v_max3_u32 v4, v4, v67, v68
    v_max3_u32 v4, v4, v69, v70
    v_max3_u32 v4, v4, v71, v72
    v_max3_u32 v4, v4, v73, v74
    v_max3_u32 v4, v4, v75, v76
    v_max3_u32 v4, v4, v77, v78
    v_max3_u32 v4, v4, v79, v80
    v_max3_u32 v4, v4, v81, v82
    v_max3_u32 v4, v4, v83, v84
    v_max3_u32 v4, v4, v85, v86
    v_max3_u32 v4, v4, v87, v88
    v_max3_u32 v4, v4, v89, v90
    v_max3_u32 v4, v4, v91, v92
    v_max3_u32 v4, v4, v93, v94
    v_max_u32 v4, v4, v95
    ds_swizzle_b32 v5, v4 offset:0x41f
    s_waitcnt lgkmcnt(0)
    v_max_u32 v4, v4, v5
    ds_swizzle_b32 v5, v4 offset:0x81f
    s_waitcnt lgkmcnt(0)
    v_max_u32 v4, v4, v5
    ds_swizzle_b32 v5, v4 offset:0x101f
    s_waitcnt lgkmcnt(0)
    v_max_u32 v4, v4, v5
    ds_swizzle_b32 v5, v4 offset:0x201f
    s_waitcnt lgkmcnt(0)
    v_max_u32 v4, v4, v5
    ds_swizzle_b32 v5, v4 offset:0x401f
    s_waitcnt lgkmcnt(0)
    v_max_u32 v4, v4, v5
    v_mov_b32 v5, v4
    s_nop 1
    v_permlane32_swap_b32 v4, v5
    v_max_u32 v4, v4, v5
    s_nop 0
    v_readfirstlane_b32 s51, v4
    v_cmp_ne_u32 vcc, v4, v64
    s_nop 1
    v_cndmask_b32 v64, 0, v64, vcc
    v_cmp_ne_u32 vcc, v4, v65
    s_nop 1
    v_cndmask_b32 v65, 0, v65, vcc
    v_cmp_ne_u32 vcc, v4, v66
    s_nop 1
    v_cndmask_b32 v66, 0, v66, vcc
    v_cmp_ne_u32 vcc, v4, v67
    s_nop 1
    v_cndmask_b32 v67, 0, v67, vcc
    v_cmp_ne_u32 vcc, v4, v68
    s_nop 1
    v_cndmask_b32 v68, 0, v68, vcc
    v_cmp_ne_u32 vcc, v4, v69
    s_nop 1
    v_cndmask_b32 v69, 0, v69, vcc
    v_cmp_ne_u32 vcc, v4, v70
    s_nop 1
    v_cndmask_b32 v70, 0, v70, vcc
    v_cmp_ne_u32 vcc, v4, v71
    s_nop 1
    v_cndmask_b32 v71, 0, v71, vcc
    v_cmp_ne_u32 vcc, v4, v72
    s_nop 1
    v_cndmask_b32 v72, 0, v72, vcc
    v_cmp_ne_u32 vcc, v4, v73
    s_nop 1
    v_cndmask_b32 v73, 0, v73, vcc
    v_cmp_ne_u32 vcc, v4, v74
    s_nop 1
    v_cndmask_b32 v74, 0, v74, vcc
    v_cmp_ne_u32 vcc, v4, v75
    s_nop 1
    v_cndmask_b32 v75, 0, v75, vcc
    v_cmp_ne_u32 vcc, v4, v76
    s_nop 1
    v_cndmask_b32 v76, 0, v76, vcc
    v_cmp_ne_u32 vcc, v4, v77
    s_nop 1
    v_cndmask_b32 v77, 0, v77, vcc
    v_cmp_ne_u32 vcc, v4, v78
    s_nop 1
    v_cndmask_b32 v78, 0, v78, vcc
    v_cmp_ne_u32 vcc, v4, v79
    s_nop 1
    v_cndmask_b32 v79, 0, v79, vcc
    v_cmp_ne_u32 vcc, v4, v80
    s_nop 1
    v_cndmask_b32 v80, 0, v80, vcc
    v_cmp_ne_u32 vcc, v4, v81
    s_nop 1
    v_cndmask_b32 v81, 0, v81, vcc
    v_cmp_ne_u32 vcc, v4, v82
    s_nop 1
    v_cndmask_b32 v82, 0, v82, vcc
    v_cmp_ne_u32 vcc, v4, v83
    s_nop 1
    v_cndmask_b32 v83, 0, v83, vcc
    v_cmp_ne_u32 vcc, v4, v84
    s_nop 1
    v_cndmask_b32 v84, 0, v84, vcc
    v_cmp_ne_u32 vcc, v4, v85
    s_nop 1
    v_cndmask_b32 v85, 0, v85, vcc
    v_cmp_ne_u32 vcc, v4, v86
    s_nop 1
    v_cndmask_b32 v86, 0, v86, vcc
    v_cmp_ne_u32 vcc, v4, v87
    s_nop 1
    v_cndmask_b32 v87, 0, v87, vcc
    v_cmp_ne_u32 vcc, v4, v88
    s_nop 1
    v_cndmask_b32 v88, 0, v88, vcc
    v_cmp_ne_u32 vcc, v4, v89
    s_nop 1
    v_cndmask_b32 v89, 0, v89, vcc
    v_cmp_ne_u32 vcc, v4, v90
    s_nop 1
    v_cndmask_b32 v90, 0, v90, vcc
    v_cmp_ne_u32 vcc, v4, v91
    s_nop 1
    v_cndmask_b32 v91, 0, v91, vcc
    v_cmp_ne_u32 vcc, v4, v92
    s_nop 1
    v_cndmask_b32 v92, 0, v92, vcc
    v_cmp_ne_u32 vcc, v4, v93
    s_nop 1
    v_cndmask_b32 v93, 0, v93, vcc
    v_cmp_ne_u32 vcc, v4, v94
    s_nop 1
    v_cndmask_b32 v94, 0, v94, vcc
    v_cmp_ne_u32 vcc, v4, v95
    s_nop 1
    v_cndmask_b32 v95, 0, v95, vcc
    v_max3_u32 v4, v64, v65, v66
    v_max3_u32 v4, v4, v67, v68
    v_max3_u32 v4, v4, v69, v70
    v_max3_u32 v4, v4, v71, v72
    v_max3_u32 v4, v4, v73, v74
    v_max3_u32 v4, v4, v75, v76
    v_max3_u32 v4, v4, v77, v78
    v_max3_u32 v4, v4, v79, v80
    v_max3_u32 v4, v4, v81, v82
    v_max3_u32 v4, v4, v83, v84
    v_max3_u32 v4, v4, v85, v86
    v_max3_u32 v4, v4, v87, v88
    v_max3_u32 v4, v4, v89, v90
    v_max3_u32 v4, v4, v91, v92
    v_max3_u32 v4, v4, v93, v94
    v_max_u32 v4, v4, v95
    ds_swizzle_b32 v5, v4 offset:0x41f
    s_waitcnt lgkmcnt(0)
    v_max_u32 v4, v4, v5
    ds_swizzle_b32 v5, v4 offset:0x81f
    s_waitcnt lgkmcnt(0)
    v_max_u32 v4, v4, v5
    ds_swizzle_b32 v5, v4 offset:0x101f
    s_waitcnt lgkmcnt(0)
    v_max_u32 v4, v4, v5
    ds_swizzle_b32 v5, v4 offset:0x201f
    s_waitcnt lgkmcnt(0)
    v_max_u32 v4, v4, v5
    ds_swizzle_b32 v5, v4 offset:0x401f
    s_waitcnt lgkmcnt(0)
    v_max_u32 v4, v4, v5
    v_mov_b32 v5, v4
    s_nop 1
    v_permlane32_swap_b32 v4, v5
    v_max_u32 v4, v4, v5
    s_nop 0
    v_readfirstlane_b32 s52, v4
    v_cmp_ne_u32 vcc, v4, v64
    s_nop 1
    v_cndmask_b32 v64, 0, v64, vcc
    v_cmp_ne_u32 vcc, v4, v65
    s_nop 1
    v_cndmask_b32 v65, 0, v65, vcc
    v_cmp_ne_u32 vcc, v4, v66
    s_nop 1
    v_cndmask_b32 v66, 0, v66, vcc
    v_cmp_ne_u32 vcc, v4, v67
    s_nop 1
    v_cndmask_b32 v67, 0, v67, vcc
    v_cmp_ne_u32 vcc, v4, v68
    s_nop 1
    v_cndmask_b32 v68, 0, v68, vcc
    v_cmp_ne_u32 vcc, v4, v69
    s_nop 1
    v_cndmask_b32 v69, 0, v69, vcc
    v_cmp_ne_u32 vcc, v4, v70
    s_nop 1
    v_cndmask_b32 v70, 0, v70, vcc
    v_cmp_ne_u32 vcc, v4, v71
    s_nop 1
    v_cndmask_b32 v71, 0, v71, vcc
    v_cmp_ne_u32 vcc, v4, v72
    s_nop 1
    v_cndmask_b32 v72, 0, v72, vcc
    v_cmp_ne_u32 vcc, v4, v73
    s_nop 1
    v_cndmask_b32 v73, 0, v73, vcc
    v_cmp_ne_u32 vcc, v4, v74
    s_nop 1
    v_cndmask_b32 v74, 0, v74, vcc
    v_cmp_ne_u32 vcc, v4, v75
    s_nop 1
    v_cndmask_b32 v75, 0, v75, vcc
    v_cmp_ne_u32 vcc, v4, v76
    s_nop 1
    v_cndmask_b32 v76, 0, v76, vcc
    v_cmp_ne_u32 vcc, v4, v77
    s_nop 1
    v_cndmask_b32 v77, 0, v77, vcc
    v_cmp_ne_u32 vcc, v4, v78
    s_nop 1
    v_cndmask_b32 v78, 0, v78, vcc
    v_cmp_ne_u32 vcc, v4, v79
    s_nop 1
    v_cndmask_b32 v79, 0, v79, vcc
    v_cmp_ne_u32 vcc, v4, v80
    s_nop 1
    v_cndmask_b32 v80, 0, v80, vcc
    v_cmp_ne_u32 vcc, v4, v81
    s_nop 1
    v_cndmask_b32 v81, 0, v81, vcc
    v_cmp_ne_u32 vcc, v4, v82
    s_nop 1
    v_cndmask_b32 v82, 0, v82, vcc
    v_cmp_ne_u32 vcc, v4, v83
    s_nop 1
    v_cndmask_b32 v83, 0, v83, vcc
    v_cmp_ne_u32 vcc, v4, v84
    s_nop 1
    v_cndmask_b32 v84, 0, v84, vcc
    v_cmp_ne_u32 vcc, v4, v85
    s_nop 1
    v_cndmask_b32 v85, 0, v85, vcc
    v_cmp_ne_u32 vcc, v4, v86
    s_nop 1
    v_cndmask_b32 v86, 0, v86, vcc
    v_cmp_ne_u32 vcc, v4, v87
    s_nop 1
    v_cndmask_b32 v87, 0, v87, vcc
    v_cmp_ne_u32 vcc, v4, v88
    s_nop 1
    v_cndmask_b32 v88, 0, v88, vcc
    v_cmp_ne_u32 vcc, v4, v89
    s_nop 1
    v_cndmask_b32 v89, 0, v89, vcc
    v_cmp_ne_u32 vcc, v4, v90
    s_nop 1
    v_cndmask_b32 v90, 0, v90, vcc
    v_cmp_ne_u32 vcc, v4, v91
    s_nop 1
    v_cndmask_b32 v91, 0, v91, vcc
    v_cmp_ne_u32 vcc, v4, v92
    s_nop 1
    v_cndmask_b32 v92, 0, v92, vcc
    v_cmp_ne_u32 vcc, v4, v93
    s_nop 1
    v_cndmask_b32 v93, 0, v93, vcc
    v_cmp_ne_u32 vcc, v4, v94
    s_nop 1
    v_cndmask_b32 v94, 0, v94, vcc
    v_cmp_ne_u32 vcc, v4, v95
    s_nop 1
    v_cndmask_b32 v95, 0, v95, vcc
    v_max3_u32 v4, v64, v65, v66
    v_max3_u32 v4, v4, v67, v68
    v_max3_u32 v4, v4, v69, v70
    v_max3_u32 v4, v4, v71, v72
    v_max3_u32 v4, v4, v73, v74
    v_max3_u32 v4, v4, v75, v76
    v_max3_u32 v4, v4, v77, v78
    v_max3_u32 v4, v4, v79, v80
    v_max3_u32 v4, v4, v81, v82
    v_max3_u32 v4, v4, v83, v84
    v_max3_u32 v4, v4, v85, v86
    v_max3_u32 v4, v4, v87, v88
    v_max3_u32 v4, v4, v89, v90
    v_max3_u32 v4, v4, v91, v92
    v_max3_u32 v4, v4, v93, v94
    v_max_u32 v4, v4, v95
    ds_swizzle_b32 v5, v4 offset:0x41f
    s_waitcnt lgkmcnt(0)
    v_max_u32 v4, v4, v5
    ds_swizzle_b32 v5, v4 offset:0x81f
    s_waitcnt lgkmcnt(0)
    v_max_u32 v4, v4, v5
    ds_swizzle_b32 v5, v4 offset:0x101f
    s_waitcnt lgkmcnt(0)
    v_max_u32 v4, v4, v5
    ds_swizzle_b32 v5, v4 offset:0x201f
    s_waitcnt lgkmcnt(0)
    v_max_u32 v4, v4, v5
    ds_swizzle_b32 v5, v4 offset:0x401f
    s_waitcnt lgkmcnt(0)
    v_max_u32 v4, v4, v5
    v_mov_b32 v5, v4
    s_nop 1
    v_permlane32_swap_b32 v4, v5
    v_max_u32 v4, v4, v5
    s_nop 0
    v_readfirstlane_b32 s53, v4
    v_cmp_ne_u32 vcc, v4, v64
    s_nop 1
    v_cndmask_b32 v64, 0, v64, vcc
    v_cmp_ne_u32 vcc, v4, v65
    s_nop 1
    v_cndmask_b32 v65, 0, v65, vcc
    v_cmp_ne_u32 vcc, v4, v66
    s_nop 1
    v_cndmask_b32 v66, 0, v66, vcc
    v_cmp_ne_u32 vcc, v4, v67
    s_nop 1
    v_cndmask_b32 v67, 0, v67, vcc
    v_cmp_ne_u32 vcc, v4, v68
    s_nop 1
    v_cndmask_b32 v68, 0, v68, vcc
    v_cmp_ne_u32 vcc, v4, v69
    s_nop 1
    v_cndmask_b32 v69, 0, v69, vcc
    v_cmp_ne_u32 vcc, v4, v70
    s_nop 1
    v_cndmask_b32 v70, 0, v70, vcc
    v_cmp_ne_u32 vcc, v4, v71
    s_nop 1
    v_cndmask_b32 v71, 0, v71, vcc
    v_cmp_ne_u32 vcc, v4, v72
    s_nop 1
    v_cndmask_b32 v72, 0, v72, vcc
    v_cmp_ne_u32 vcc, v4, v73
    s_nop 1
    v_cndmask_b32 v73, 0, v73, vcc
    v_cmp_ne_u32 vcc, v4, v74
    s_nop 1
    v_cndmask_b32 v74, 0, v74, vcc
    v_cmp_ne_u32 vcc, v4, v75
    s_nop 1
    v_cndmask_b32 v75, 0, v75, vcc
    v_cmp_ne_u32 vcc, v4, v76
    s_nop 1
    v_cndmask_b32 v76, 0, v76, vcc
    v_cmp_ne_u32 vcc, v4, v77
    s_nop 1
    v_cndmask_b32 v77, 0, v77, vcc
    v_cmp_ne_u32 vcc, v4, v78
    s_nop 1
    v_cndmask_b32 v78, 0, v78, vcc
    v_cmp_ne_u32 vcc, v4, v79
    s_nop 1
    v_cndmask_b32 v79, 0, v79, vcc
    v_cmp_ne_u32 vcc, v4, v80
    s_nop 1
    v_cndmask_b32 v80, 0, v80, vcc
    v_cmp_ne_u32 vcc, v4, v81
    s_nop 1
    v_cndmask_b32 v81, 0, v81, vcc
    v_cmp_ne_u32 vcc, v4, v82
    s_nop 1
    v_cndmask_b32 v82, 0, v82, vcc
    v_cmp_ne_u32 vcc, v4, v83
    s_nop 1
    v_cndmask_b32 v83, 0, v83, vcc
    v_cmp_ne_u32 vcc, v4, v84
    s_nop 1
    v_cndmask_b32 v84, 0, v84, vcc
    v_cmp_ne_u32 vcc, v4, v85
    s_nop 1
    v_cndmask_b32 v85, 0, v85, vcc
    v_cmp_ne_u32 vcc, v4, v86
    s_nop 1
    v_cndmask_b32 v86, 0, v86, vcc
    v_cmp_ne_u32 vcc, v4, v87
    s_nop 1
    v_cndmask_b32 v87, 0, v87, vcc
    v_cmp_ne_u32 vcc, v4, v88
    s_nop 1
    v_cndmask_b32 v88, 0, v88, vcc
    v_cmp_ne_u32 vcc, v4, v89
    s_nop 1
    v_cndmask_b32 v89, 0, v89, vcc
    v_cmp_ne_u32 vcc, v4, v90
    s_nop 1
    v_cndmask_b32 v90, 0, v90, vcc
    v_cmp_ne_u32 vcc, v4, v91
    s_nop 1
    v_cndmask_b32 v91, 0, v91, vcc
    v_cmp_ne_u32 vcc, v4, v92
    s_nop 1
    v_cndmask_b32 v92, 0, v92, vcc
    v_cmp_ne_u32 vcc, v4, v93
    s_nop 1
    v_cndmask_b32 v93, 0, v93, vcc
    v_cmp_ne_u32 vcc, v4, v94
    s_nop 1
    v_cndmask_b32 v94, 0, v94, vcc
    v_cmp_ne_u32 vcc, v4, v95
    s_nop 1
    v_cndmask_b32 v95, 0, v95, vcc
    v_max3_u32 v4, v64, v65, v66
    v_max3_u32 v4, v4, v67, v68
    v_max3_u32 v4, v4, v69, v70
    v_max3_u32 v4, v4, v71, v72
    v_max3_u32 v4, v4, v73, v74
    v_max3_u32 v4, v4, v75, v76
    v_max3_u32 v4, v4, v77, v78
    v_max3_u32 v4, v4, v79, v80
    v_max3_u32 v4, v4, v81, v82
    v_max3_u32 v4, v4, v83, v84
    v_max3_u32 v4, v4, v85, v86
    v_max3_u32 v4, v4, v87, v88
    v_max3_u32 v4, v4, v89, v90
    v_max3_u32 v4, v4, v91, v92
    v_max3_u32 v4, v4, v93, v94
    v_max_u32 v4, v4, v95
    ds_swizzle_b32 v5, v4 offset:0x41f
    s_waitcnt lgkmcnt(0)
    v_max_u32 v4, v4, v5
    ds_swizzle_b32 v5, v4 offset:0x81f
    s_waitcnt lgkmcnt(0)
    v_max_u32 v4, v4, v5
    ds_swizzle_b32 v5, v4 offset:0x101f
    s_waitcnt lgkmcnt(0)
    v_max_u32 v4, v4, v5
    ds_swizzle_b32 v5, v4 offset:0x201f
    s_waitcnt lgkmcnt(0)
    v_max_u32 v4, v4, v5
    ds_swizzle_b32 v5, v4 offset:0x401f
    s_waitcnt lgkmcnt(0)
    v_max_u32 v4, v4, v5
    v_mov_b32 v5, v4
    s_nop 1
    v_permlane32_swap_b32 v4, v5
    v_max_u32 v4, v4, v5
    s_nop 0
    v_readfirstlane_b32 s54, v4
    v_cmp_ne_u32 vcc, v4, v64
    s_nop 1
    v_cndmask_b32 v64, 0, v64, vcc
    v_cmp_ne_u32 vcc, v4, v65
    s_nop 1
    v_cndmask_b32 v65, 0, v65, vcc
    v_cmp_ne_u32 vcc, v4, v66
    s_nop 1
    v_cndmask_b32 v66, 0, v66, vcc
    v_cmp_ne_u32 vcc, v4, v67
    s_nop 1
    v_cndmask_b32 v67, 0, v67, vcc
    v_cmp_ne_u32 vcc, v4, v68
    s_nop 1
    v_cndmask_b32 v68, 0, v68, vcc
    v_cmp_ne_u32 vcc, v4, v69
    s_nop 1
    v_cndmask_b32 v69, 0, v69, vcc
    v_cmp_ne_u32 vcc, v4, v70
    s_nop 1
    v_cndmask_b32 v70, 0, v70, vcc
    v_cmp_ne_u32 vcc, v4, v71
    s_nop 1
    v_cndmask_b32 v71, 0, v71, vcc
    v_cmp_ne_u32 vcc, v4, v72
    s_nop 1
    v_cndmask_b32 v72, 0, v72, vcc
    v_cmp_ne_u32 vcc, v4, v73
    s_nop 1
    v_cndmask_b32 v73, 0, v73, vcc
    v_cmp_ne_u32 vcc, v4, v74
    s_nop 1
    v_cndmask_b32 v74, 0, v74, vcc
    v_cmp_ne_u32 vcc, v4, v75
    s_nop 1
    v_cndmask_b32 v75, 0, v75, vcc
    v_cmp_ne_u32 vcc, v4, v76
    s_nop 1
    v_cndmask_b32 v76, 0, v76, vcc
    v_cmp_ne_u32 vcc, v4, v77
    s_nop 1
    v_cndmask_b32 v77, 0, v77, vcc
    v_cmp_ne_u32 vcc, v4, v78
    s_nop 1
    v_cndmask_b32 v78, 0, v78, vcc
    v_cmp_ne_u32 vcc, v4, v79
    s_nop 1
    v_cndmask_b32 v79, 0, v79, vcc
    v_cmp_ne_u32 vcc, v4, v80
    s_nop 1
    v_cndmask_b32 v80, 0, v80, vcc
    v_cmp_ne_u32 vcc, v4, v81
    s_nop 1
    v_cndmask_b32 v81, 0, v81, vcc
    v_cmp_ne_u32 vcc, v4, v82
    s_nop 1
    v_cndmask_b32 v82, 0, v82, vcc
    v_cmp_ne_u32 vcc, v4, v83
    s_nop 1
    v_cndmask_b32 v83, 0, v83, vcc
    v_cmp_ne_u32 vcc, v4, v84
    s_nop 1
    v_cndmask_b32 v84, 0, v84, vcc
    v_cmp_ne_u32 vcc, v4, v85
    s_nop 1
    v_cndmask_b32 v85, 0, v85, vcc
    v_cmp_ne_u32 vcc, v4, v86
    s_nop 1
    v_cndmask_b32 v86, 0, v86, vcc
    v_cmp_ne_u32 vcc, v4, v87
    s_nop 1
    v_cndmask_b32 v87, 0, v87, vcc
    v_cmp_ne_u32 vcc, v4, v88
    s_nop 1
    v_cndmask_b32 v88, 0, v88, vcc
    v_cmp_ne_u32 vcc, v4, v89
    s_nop 1
    v_cndmask_b32 v89, 0, v89, vcc
    v_cmp_ne_u32 vcc, v4, v90
    s_nop 1
    v_cndmask_b32 v90, 0, v90, vcc
    v_cmp_ne_u32 vcc, v4, v91
    s_nop 1
    v_cndmask_b32 v91, 0, v91, vcc
    v_cmp_ne_u32 vcc, v4, v92
    s_nop 1
    v_cndmask_b32 v92, 0, v92, vcc
    v_cmp_ne_u32 vcc, v4, v93
    s_nop 1
    v_cndmask_b32 v93, 0, v93, vcc
    v_cmp_ne_u32 vcc, v4, v94
    s_nop 1
    v_cndmask_b32 v94, 0, v94, vcc
    v_cmp_ne_u32 vcc, v4, v95
    s_nop 1
    v_cndmask_b32 v95, 0, v95, vcc
    v_max3_u32 v4, v64, v65, v66
    v_max3_u32 v4, v4, v67, v68
    v_max3_u32 v4, v4, v69, v70
    v_max3_u32 v4, v4, v71, v72
    v_max3_u32 v4, v4, v73, v74
    v_max3_u32 v4, v4, v75, v76
    v_max3_u32 v4, v4, v77, v78
    v_max3_u32 v4, v4, v79, v80
    v_max3_u32 v4, v4, v81, v82
    v_max3_u32 v4, v4, v83, v84
    v_max3_u32 v4, v4, v85, v86
    v_max3_u32 v4, v4, v87, v88
    v_max3_u32 v4, v4, v89, v90
    v_max3_u32 v4, v4, v91, v92
    v_max3_u32 v4, v4, v93, v94
    v_max_u32 v4, v4, v95
    ds_swizzle_b32 v5, v4 offset:0x41f
    s_waitcnt lgkmcnt(0)
    v_max_u32 v4, v4, v5
    ds_swizzle_b32 v5, v4 offset:0x81f
    s_waitcnt lgkmcnt(0)
    v_max_u32 v4, v4, v5
    ds_swizzle_b32 v5, v4 offset:0x101f
    s_waitcnt lgkmcnt(0)
    v_max_u32 v4, v4, v5
    ds_swizzle_b32 v5, v4 offset:0x201f
    s_waitcnt lgkmcnt(0)
    v_max_u32 v4, v4, v5
    ds_swizzle_b32 v5, v4 offset:0x401f
    s_waitcnt lgkmcnt(0)
    v_max_u32 v4, v4, v5
    v_mov_b32 v5, v4
    s_nop 1
    v_permlane32_swap_b32 v4, v5
    v_max_u32 v4, v4, v5
    s_nop 0
    v_readfirstlane_b32 s55, v4
    v_cmp_ne_u32 vcc, v4, v64
    s_nop 1
    v_cndmask_b32 v64, 0, v64, vcc
    v_cmp_ne_u32 vcc, v4, v65
    s_nop 1
    v_cndmask_b32 v65, 0, v65, vcc
    v_cmp_ne_u32 vcc, v4, v66
    s_nop 1
    v_cndmask_b32 v66, 0, v66, vcc
    v_cmp_ne_u32 vcc, v4, v67
    s_nop 1
    v_cndmask_b32 v67, 0, v67, vcc
    v_cmp_ne_u32 vcc, v4, v68
    s_nop 1
    v_cndmask_b32 v68, 0, v68, vcc
    v_cmp_ne_u32 vcc, v4, v69
    s_nop 1
    v_cndmask_b32 v69, 0, v69, vcc
    v_cmp_ne_u32 vcc, v4, v70
    s_nop 1
    v_cndmask_b32 v70, 0, v70, vcc
    v_cmp_ne_u32 vcc, v4, v71
    s_nop 1
    v_cndmask_b32 v71, 0, v71, vcc
    v_cmp_ne_u32 vcc, v4, v72
    s_nop 1
    v_cndmask_b32 v72, 0, v72, vcc
    v_cmp_ne_u32 vcc, v4, v73
    s_nop 1
    v_cndmask_b32 v73, 0, v73, vcc
    v_cmp_ne_u32 vcc, v4, v74
    s_nop 1
    v_cndmask_b32 v74, 0, v74, vcc
    v_cmp_ne_u32 vcc, v4, v75
    s_nop 1
    v_cndmask_b32 v75, 0, v75, vcc
    v_cmp_ne_u32 vcc, v4, v76
    s_nop 1
    v_cndmask_b32 v76, 0, v76, vcc
    v_cmp_ne_u32 vcc, v4, v77
    s_nop 1
    v_cndmask_b32 v77, 0, v77, vcc
    v_cmp_ne_u32 vcc, v4, v78
    s_nop 1
    v_cndmask_b32 v78, 0, v78, vcc
    v_cmp_ne_u32 vcc, v4, v79
    s_nop 1
    v_cndmask_b32 v79, 0, v79, vcc
    v_cmp_ne_u32 vcc, v4, v80
    s_nop 1
    v_cndmask_b32 v80, 0, v80, vcc
    v_cmp_ne_u32 vcc, v4, v81
    s_nop 1
    v_cndmask_b32 v81, 0, v81, vcc
    v_cmp_ne_u32 vcc, v4, v82
    s_nop 1
    v_cndmask_b32 v82, 0, v82, vcc
    v_cmp_ne_u32 vcc, v4, v83
    s_nop 1
    v_cndmask_b32 v83, 0, v83, vcc
    v_cmp_ne_u32 vcc, v4, v84
    s_nop 1
    v_cndmask_b32 v84, 0, v84, vcc
    v_cmp_ne_u32 vcc, v4, v85
    s_nop 1
    v_cndmask_b32 v85, 0, v85, vcc
    v_cmp_ne_u32 vcc, v4, v86
    s_nop 1
    v_cndmask_b32 v86, 0, v86, vcc
    v_cmp_ne_u32 vcc, v4, v87
    s_nop 1
    v_cndmask_b32 v87, 0, v87, vcc
    v_cmp_ne_u32 vcc, v4, v88
    s_nop 1
    v_cndmask_b32 v88, 0, v88, vcc
    v_cmp_ne_u32 vcc, v4, v89
    s_nop 1
    v_cndmask_b32 v89, 0, v89, vcc
    v_cmp_ne_u32 vcc, v4, v90
    s_nop 1
    v_cndmask_b32 v90, 0, v90, vcc
    v_cmp_ne_u32 vcc, v4, v91
    s_nop 1
    v_cndmask_b32 v91, 0, v91, vcc
    v_cmp_ne_u32 vcc, v4, v92
    s_nop 1
    v_cndmask_b32 v92, 0, v92, vcc
    v_cmp_ne_u32 vcc, v4, v93
    s_nop 1
    v_cndmask_b32 v93, 0, v93, vcc
    v_cmp_ne_u32 vcc, v4, v94
    s_nop 1
    v_cndmask_b32 v94, 0, v94, vcc
    v_cmp_ne_u32 vcc, v4, v95
    s_nop 1
    v_cndmask_b32 v95, 0, v95, vcc
    v_max3_u32 v4, v64, v65, v66
    v_max3_u32 v4, v4, v67, v68
    v_max3_u32 v4, v4, v69, v70
    v_max3_u32 v4, v4, v71, v72
    v_max3_u32 v4, v4, v73, v74
    v_max3_u32 v4, v4, v75, v76
    v_max3_u32 v4, v4, v77, v78
    v_max3_u32 v4, v4, v79, v80
    v_max3_u32 v4, v4, v81, v82
    v_max3_u32 v4, v4, v83, v84
    v_max3_u32 v4, v4, v85, v86
    v_max3_u32 v4, v4, v87, v88
    v_max3_u32 v4, v4, v89, v90
    v_max3_u32 v4, v4, v91, v92
    v_max3_u32 v4, v4, v93, v94
    v_max_u32 v4, v4, v95
    ds_swizzle_b32 v5, v4 offset:0x41f
    s_waitcnt lgkmcnt(0)
    v_max_u32 v4, v4, v5
    ds_swizzle_b32 v5, v4 offset:0x81f
    s_waitcnt lgkmcnt(0)
    v_max_u32 v4, v4, v5
    ds_swizzle_b32 v5, v4 offset:0x101f
    s_waitcnt lgkmcnt(0)
    v_max_u32 v4, v4, v5
    ds_swizzle_b32 v5, v4 offset:0x201f
    s_waitcnt lgkmcnt(0)
    v_max_u32 v4, v4, v5
    ds_swizzle_b32 v5, v4 offset:0x401f
    s_waitcnt lgkmcnt(0)
    v_max_u32 v4, v4, v5
    v_mov_b32 v5, v4
    s_nop 1
    v_permlane32_swap_b32 v4, v5
    v_max_u32 v4, v4, v5
    s_nop 0
    v_readfirstlane_b32 s56, v4
    v_cmp_ne_u32 vcc, v4, v64
    s_nop 1
    v_cndmask_b32 v64, 0, v64, vcc
    v_cmp_ne_u32 vcc, v4, v65
    s_nop 1
    v_cndmask_b32 v65, 0, v65, vcc
    v_cmp_ne_u32 vcc, v4, v66
    s_nop 1
    v_cndmask_b32 v66, 0, v66, vcc
    v_cmp_ne_u32 vcc, v4, v67
    s_nop 1
    v_cndmask_b32 v67, 0, v67, vcc
    v_cmp_ne_u32 vcc, v4, v68
    s_nop 1
    v_cndmask_b32 v68, 0, v68, vcc
    v_cmp_ne_u32 vcc, v4, v69
    s_nop 1
    v_cndmask_b32 v69, 0, v69, vcc
    v_cmp_ne_u32 vcc, v4, v70
    s_nop 1
    v_cndmask_b32 v70, 0, v70, vcc
    v_cmp_ne_u32 vcc, v4, v71
    s_nop 1
    v_cndmask_b32 v71, 0, v71, vcc
    v_cmp_ne_u32 vcc, v4, v72
    s_nop 1
    v_cndmask_b32 v72, 0, v72, vcc
    v_cmp_ne_u32 vcc, v4, v73
    s_nop 1
    v_cndmask_b32 v73, 0, v73, vcc
    v_cmp_ne_u32 vcc, v4, v74
    s_nop 1
    v_cndmask_b32 v74, 0, v74, vcc
    v_cmp_ne_u32 vcc, v4, v75
    s_nop 1
    v_cndmask_b32 v75, 0, v75, vcc
    v_cmp_ne_u32 vcc, v4, v76
    s_nop 1
    v_cndmask_b32 v76, 0, v76, vcc
    v_cmp_ne_u32 vcc, v4, v77
    s_nop 1
    v_cndmask_b32 v77, 0, v77, vcc
    v_cmp_ne_u32 vcc, v4, v78
    s_nop 1
    v_cndmask_b32 v78, 0, v78, vcc
    v_cmp_ne_u32 vcc, v4, v79
    s_nop 1
    v_cndmask_b32 v79, 0, v79, vcc
    v_cmp_ne_u32 vcc, v4, v80
    s_nop 1
    v_cndmask_b32 v80, 0, v80, vcc
    v_cmp_ne_u32 vcc, v4, v81
    s_nop 1
    v_cndmask_b32 v81, 0, v81, vcc
    v_cmp_ne_u32 vcc, v4, v82
    s_nop 1
    v_cndmask_b32 v82, 0, v82, vcc
    v_cmp_ne_u32 vcc, v4, v83
    s_nop 1
    v_cndmask_b32 v83, 0, v83, vcc
    v_cmp_ne_u32 vcc, v4, v84
    s_nop 1
    v_cndmask_b32 v84, 0, v84, vcc
    v_cmp_ne_u32 vcc, v4, v85
    s_nop 1
    v_cndmask_b32 v85, 0, v85, vcc
    v_cmp_ne_u32 vcc, v4, v86
    s_nop 1
    v_cndmask_b32 v86, 0, v86, vcc
    v_cmp_ne_u32 vcc, v4, v87
    s_nop 1
    v_cndmask_b32 v87, 0, v87, vcc
    v_cmp_ne_u32 vcc, v4, v88
    s_nop 1
    v_cndmask_b32 v88, 0, v88, vcc
    v_cmp_ne_u32 vcc, v4, v89
    s_nop 1
    v_cndmask_b32 v89, 0, v89, vcc
    v_cmp_ne_u32 vcc, v4, v90
    s_nop 1
    v_cndmask_b32 v90, 0, v90, vcc
    v_cmp_ne_u32 vcc, v4, v91
    s_nop 1
    v_cndmask_b32 v91, 0, v91, vcc
    v_cmp_ne_u32 vcc, v4, v92
    s_nop 1
    v_cndmask_b32 v92, 0, v92, vcc
    v_cmp_ne_u32 vcc, v4, v93
    s_nop 1
    v_cndmask_b32 v93, 0, v93, vcc
    v_cmp_ne_u32 vcc, v4, v94
    s_nop 1
    v_cndmask_b32 v94, 0, v94, vcc
    v_cmp_ne_u32 vcc, v4, v95
    s_nop 1
    v_cndmask_b32 v95, 0, v95, vcc
    v_max3_u32 v4, v64, v65, v66
    v_max3_u32 v4, v4, v67, v68
    v_max3_u32 v4, v4, v69, v70
    v_max3_u32 v4, v4, v71, v72
    v_max3_u32 v4, v4, v73, v74
    v_max3_u32 v4, v4, v75, v76
    v_max3_u32 v4, v4, v77, v78
    v_max3_u32 v4, v4, v79, v80
    v_max3_u32 v4, v4, v81, v82
    v_max3_u32 v4, v4, v83, v84
    v_max3_u32 v4, v4, v85, v86
    v_max3_u32 v4, v4, v87, v88
    v_max3_u32 v4, v4, v89, v90
    v_max3_u32 v4, v4, v91, v92
    v_max3_u32 v4, v4, v93, v94
    v_max_u32 v4, v4, v95
    ds_swizzle_b32 v5, v4 offset:0x41f
    s_waitcnt lgkmcnt(0)
    v_max_u32 v4, v4, v5
    ds_swizzle_b32 v5, v4 offset:0x81f
    s_waitcnt lgkmcnt(0)
    v_max_u32 v4, v4, v5
    ds_swizzle_b32 v5, v4 offset:0x101f
    s_waitcnt lgkmcnt(0)
    v_max_u32 v4, v4, v5
    ds_swizzle_b32 v5, v4 offset:0x201f
    s_waitcnt lgkmcnt(0)
    v_max_u32 v4, v4, v5
    ds_swizzle_b32 v5, v4 offset:0x401f
    s_waitcnt lgkmcnt(0)
    v_max_u32 v4, v4, v5
    v_mov_b32 v5, v4
    s_nop 1
    v_permlane32_swap_b32 v4, v5
    v_max_u32 v4, v4, v5
    s_nop 0
    v_readfirstlane_b32 s57, v4
    v_cmp_ne_u32 vcc, v4, v64
    s_nop 1
    v_cndmask_b32 v64, 0, v64, vcc
    v_cmp_ne_u32 vcc, v4, v65
    s_nop 1
    v_cndmask_b32 v65, 0, v65, vcc
    v_cmp_ne_u32 vcc, v4, v66
    s_nop 1
    v_cndmask_b32 v66, 0, v66, vcc
    v_cmp_ne_u32 vcc, v4, v67
    s_nop 1
    v_cndmask_b32 v67, 0, v67, vcc
    v_cmp_ne_u32 vcc, v4, v68
    s_nop 1
    v_cndmask_b32 v68, 0, v68, vcc
    v_cmp_ne_u32 vcc, v4, v69
    s_nop 1
    v_cndmask_b32 v69, 0, v69, vcc
    v_cmp_ne_u32 vcc, v4, v70
    s_nop 1
    v_cndmask_b32 v70, 0, v70, vcc
    v_cmp_ne_u32 vcc, v4, v71
    s_nop 1
    v_cndmask_b32 v71, 0, v71, vcc
    v_cmp_ne_u32 vcc, v4, v72
    s_nop 1
    v_cndmask_b32 v72, 0, v72, vcc
    v_cmp_ne_u32 vcc, v4, v73
    s_nop 1
    v_cndmask_b32 v73, 0, v73, vcc
    v_cmp_ne_u32 vcc, v4, v74
    s_nop 1
    v_cndmask_b32 v74, 0, v74, vcc
    v_cmp_ne_u32 vcc, v4, v75
    s_nop 1
    v_cndmask_b32 v75, 0, v75, vcc
    v_cmp_ne_u32 vcc, v4, v76
    s_nop 1
    v_cndmask_b32 v76, 0, v76, vcc
    v_cmp_ne_u32 vcc, v4, v77
    s_nop 1
    v_cndmask_b32 v77, 0, v77, vcc
    v_cmp_ne_u32 vcc, v4, v78
    s_nop 1
    v_cndmask_b32 v78, 0, v78, vcc
    v_cmp_ne_u32 vcc, v4, v79
    s_nop 1
    v_cndmask_b32 v79, 0, v79, vcc
    v_cmp_ne_u32 vcc, v4, v80
    s_nop 1
    v_cndmask_b32 v80, 0, v80, vcc
    v_cmp_ne_u32 vcc, v4, v81
    s_nop 1
    v_cndmask_b32 v81, 0, v81, vcc
    v_cmp_ne_u32 vcc, v4, v82
    s_nop 1
    v_cndmask_b32 v82, 0, v82, vcc
    v_cmp_ne_u32 vcc, v4, v83
    s_nop 1
    v_cndmask_b32 v83, 0, v83, vcc
    v_cmp_ne_u32 vcc, v4, v84
    s_nop 1
    v_cndmask_b32 v84, 0, v84, vcc
    v_cmp_ne_u32 vcc, v4, v85
    s_nop 1
    v_cndmask_b32 v85, 0, v85, vcc
    v_cmp_ne_u32 vcc, v4, v86
    s_nop 1
    v_cndmask_b32 v86, 0, v86, vcc
    v_cmp_ne_u32 vcc, v4, v87
    s_nop 1
    v_cndmask_b32 v87, 0, v87, vcc
    v_cmp_ne_u32 vcc, v4, v88
    s_nop 1
    v_cndmask_b32 v88, 0, v88, vcc
    v_cmp_ne_u32 vcc, v4, v89
    s_nop 1
    v_cndmask_b32 v89, 0, v89, vcc
    v_cmp_ne_u32 vcc, v4, v90
    s_nop 1
    v_cndmask_b32 v90, 0, v90, vcc
    v_cmp_ne_u32 vcc, v4, v91
    s_nop 1
    v_cndmask_b32 v91, 0, v91, vcc
    v_cmp_ne_u32 vcc, v4, v92
    s_nop 1
    v_cndmask_b32 v92, 0, v92, vcc
    v_cmp_ne_u32 vcc, v4, v93
    s_nop 1
    v_cndmask_b32 v93, 0, v93, vcc
    v_cmp_ne_u32 vcc, v4, v94
    s_nop 1
    v_cndmask_b32 v94, 0, v94, vcc
    v_cmp_ne_u32 vcc, v4, v95
    s_nop 1
    v_cndmask_b32 v95, 0, v95, vcc
    s_and_b32 s60, s50, 0xffff0000
    s_xor_b32 s20, s60, 0x80000000
    s_xor_b32 s21, s60, 0xffff0000
    s_bitcmp1_b32 s60, 31
    s_cselect_b32 s60, s20, s21
    s_and_b32 s50, s50, 0xffff
    s_sub_u32 s50, 0xffff, s50
    s_and_b32 s61, s51, 0xffff0000
    s_xor_b32 s20, s61, 0x80000000
    s_xor_b32 s21, s61, 0xffff0000
    s_bitcmp1_b32 s61, 31
    s_cselect_b32 s61, s20, s21
    s_and_b32 s51, s51, 0xffff
    s_sub_u32 s51, 0xffff, s51
    s_and_b32 s62, s52, 0xffff0000
    s_xor_b32 s20, s62, 0x80000000
    s_xor_b32 s21, s62, 0xffff0000
    s_bitcmp1_b32 s62, 31
    s_cselect_b32 s62, s20, s21
    s_and_b32 s52, s52, 0xffff
    s_sub_u32 s52, 0xffff, s52
    s_and_b32 s63, s53, 0xffff0000
    s_xor_b32 s20, s63, 0x80000000
    s_xor_b32 s21, s63, 0xffff0000
    s_bitcmp1_b32 s63, 31
    s_cselect_b32 s63, s20, s21
    s_and_b32 s53, s53, 0xffff
    s_sub_u32 s53, 0xffff, s53
    s_and_b32 s64, s54, 0xffff0000
    s_xor_b32 s20, s64, 0x80000000
    s_xor_b32 s21, s64, 0xffff0000
    s_bitcmp1_b32 s64, 31
    s_cselect_b32 s64, s20, s21
    s_and_b32 s54, s54, 0xffff
    s_sub_u32 s54, 0xffff, s54
    s_and_b32 s65, s55, 0xffff0000
    s_xor_b32 s20, s65, 0x80000000
    s_xor_b32 s21, s65, 0xffff0000
    s_bitcmp1_b32 s65, 31
    s_cselect_b32 s65, s20, s21
    s_and_b32 s55, s55, 0xffff
    s_sub_u32 s55, 0xffff, s55
    s_and_b32 s66, s56, 0xffff0000
    s_xor_b32 s20, s66, 0x80000000
    s_xor_b32 s21, s66, 0xffff0000
    s_bitcmp1_b32 s66, 31
    s_cselect_b32 s66, s20, s21
    s_and_b32 s56, s56, 0xffff
    s_sub_u32 s56, 0xffff, s56
    s_and_b32 s67, s57, 0xffff0000
    s_xor_b32 s20, s67, 0x80000000
    s_xor_b32 s21, s67, 0xffff0000
    s_bitcmp1_b32 s67, 31
    s_cselect_b32 s67, s20, s21
    s_and_b32 s57, s57, 0xffff
    s_sub_u32 s57, 0xffff, s57
    s_or_b32 s19, s2, s3
    s_cmp_lg_u32 s19, 0
    s_cbranch_scc1 K2A_NOIDX
    v_writelane_b32 v4, s50, 0
    v_writelane_b32 v4, s60, 8
    v_writelane_b32 v4, s51, 1
    v_writelane_b32 v4, s61, 9
    v_writelane_b32 v4, s52, 2
    v_writelane_b32 v4, s62, 10
    v_writelane_b32 v4, s53, 3
    v_writelane_b32 v4, s63, 11
    v_writelane_b32 v4, s54, 4
    v_writelane_b32 v4, s64, 12
    v_writelane_b32 v4, s55, 5
    v_writelane_b32 v4, s65, 13
    v_writelane_b32 v4, s56, 6
    v_writelane_b32 v4, s66, 14
    v_writelane_b32 v4, s57, 7
    v_writelane_b32 v4, s67, 15
    v_lshlrev_b32 v5, 2, v2
    s_mov_b64 exec, 0xffff
    s_mov_b32 s19, 5308416
    buffer_store_dword v4, v5, s[4:7], s19 offen
    s_mov_b64 exec, -1
K2A_NOIDX:
    v_and_b32 v4, 7, v2
    v_mov_b32 v5, 0
    s_mul_i32 s19, s50, 1280
    v_cmp_eq_u32 vcc, 0, v4
    v_mov_b32 v6, s19
    s_nop 0
    v_cndmask_b32 v5, v5, v6, vcc
    s_mul_i32 s19, s51, 1280
    v_cmp_eq_u32 vcc, 1, v4
    v_mov_b32 v6, s19
    s_nop 0
    v_cndmask_b32 v5, v5, v6, vcc
    s_mul_i32 s19, s52, 1280
    v_cmp_eq_u32 vcc, 2, v4
    v_mov_b32 v6, s19
    s_nop 0
    v_cndmask_b32 v5, v5, v6, vcc
    s_mul_i32 s19, s53, 1280
    v_cmp_eq_u32 vcc, 3, v4
    v_mov_b32 v6, s19
    s_nop 0
    v_cndmask_b32 v5, v5, v6, vcc
    s_mul_i32 s19, s54, 1280
    v_cmp_eq_u32 vcc, 4, v4
    v_mov_b32 v6, s19
    s_nop 0
    v_cndmask_b32 v5, v5, v6, vcc
    s_mul_i32 s19, s55, 1280
    v_cmp_eq_u32 vcc, 5, v4
    v_mov_b32 v6, s19
    s_nop 0
    v_cndmask_b32 v5, v5, v6, vcc
    s_mul_i32 s19, s56, 1280
    v_cmp_eq_u32 vcc, 6, v4
    v_mov_b32 v6, s19
    s_nop 0
    v_cndmask_b32 v5, v5, v6, vcc
    s_mul_i32 s19, s57, 1280
    v_cmp_eq_u32 vcc, 7, v4
    v_mov_b32 v6, s19
    s_nop 0
    v_cndmask_b32 v5, v5, v6, vcc
    v_lshrrev_b32 v6, 4, v2
    v_lshl_add_u32 v5, v6, 4, v5
    s_mov_b32 s19, 0
    buffer_load_dwordx4 v[96:99], v5, s[4:7], s19 offen offset:0
    buffer_load_dwordx4 v[100:103], v5, s[4:7], s19 offen offset:64
    buffer_load_dwordx4 v[104:107], v5, s[4:7], s19 offen offset:128
    buffer_load_dwordx4 v[108:111], v5, s[4:7], s19 offen offset:192
    buffer_load_dwordx4 v[112:115], v5, s[4:7], s19 offen offset:256
    buffer_load_dwordx4 v[116:119], v5, s[4:7], s19 offen offset:320
    buffer_load_dwordx4 v[120:123], v5, s[4:7], s19 offen offset:384
    buffer_load_dwordx4 v[124:127], v5, s[4:7], s19 offen offset:448
    buffer_load_dwordx4 v[128:131], v5, s[4:7], s19 offen offset:512
    buffer_load_dwordx4 v[132:135], v5, s[4:7], s19 offen offset:576
    buffer_load_dwordx4 v[136:139], v5, s[4:7], s19 offen offset:640
    buffer_load_dwordx4 v[140:143], v5, s[4:7], s19 offen offset:704
    buffer_load_dwordx4 v[144:147], v5, s[4:7], s19 offen offset:768
    buffer_load_dwordx4 v[148:151], v5, s[4:7], s19 offen offset:832
    buffer_load_dwordx4 v[152:155], v5, s[4:7], s19 offen offset:896
    buffer_load_dwordx4 v[156:159], v5, s[4:7], s19 offen offset:960
    buffer_load_dwordx4 v[160:163], v5, s[4:7], s19 offen offset:1024
    buffer_load_dwordx4 v[164:167], v5, s[4:7], s19 offen offset:1088
    buffer_load_dwordx4 v[168:171], v5, s[4:7], s19 offen offset:1152
    buffer_load_dwordx4 v[172:175], v5, s[4:7], s19 offen offset:1216
    s_lshl_b32 s20, s2, 2
    s_add_u32 s20, s20, s3
    s_mul_i32 s21, s20, 20480
    v_lshlrev_b32 v1, 4, v2
    s_add_u32 s22, s21, 27262976
    buffer_load_dwordx4 v[16:19], v1, s[4:7], s22 offen
    s_add_u32 s22, s21, 29884416
    buffer_load_dwordx4 v[20:23], v1, s[4:7], s22 offen
    s_add_u32 s22, s21, 27264000
    buffer_load_dwordx4 v[24:27], v1, s[4:7], s22 offen
    s_add_u32 s22, s21, 29885440
    buffer_load_dwordx4 v[28:31], v1, s[4:7], s22 offen
    s_add_u32 s22, s21, 27265024
    buffer_load_dwordx4 v[32:35], v1, s[4:7], s22 offen
    s_add_u32 s22, s21, 29886464
    buffer_load_dwordx4 v[36:39], v1, s[4:7], s22 offen
    s_add_u32 s22, s21, 27266048
    buffer_load_dwordx4 v[40:43], v1, s[4:7], s22 offen
    s_add_u32 s22, s21, 29887488
    buffer_load_dwordx4 v[44:47], v1, s[4:7], s22 offen
    s_add_u32 s22, s21, 27267072
    buffer_load_dwordx4 v[48:51], v1, s[4:7], s22 offen
    s_add_u32 s22, s21, 29888512
    buffer_load_dwordx4 v[52:55], v1, s[4:7], s22 offen
    s_add_u32 s22, s21, 27268096
    buffer_load_dwordx4 v[56:59], v1, s[4:7], s22 offen
    s_add_u32 s22, s21, 29889536
    buffer_load_dwordx4 v[60:63], v1, s[4:7], s22 offen
    s_add_u32 s22, s21, 27269120
    buffer_load_dwordx4 v[64:67], v1, s[4:7], s22 offen
    s_add_u32 s22, s21, 29890560
    buffer_load_dwordx4 v[68:71], v1, s[4:7], s22 offen
    s_add_u32 s22, s21, 27270144
    buffer_load_dwordx4 v[72:75], v1, s[4:7], s22 offen
    s_add_u32 s22, s21, 29891584
    buffer_load_dwordx4 v[76:79], v1, s[4:7], s22 offen
    s_add_u32 s22, s21, 27271168
    buffer_load_dwordx4 v[80:83], v1, s[4:7], s22 offen
    s_add_u32 s22, s21, 29892608
    buffer_load_dwordx4 v[84:87], v1, s[4:7], s22 offen
    s_add_u32 s22, s21, 27272192
    buffer_load_dwordx4 v[88:91], v1, s[4:7], s22 offen
    s_add_u32 s22, s21, 29893632
    buffer_load_dwordx4 v[92:95], v1, s[4:7], s22 offen
    s_waitcnt vmcnt(0)
    v_mfma_f32_16x16x32_bf16 v[8:11], v[96:99], v[16:19], 0
    v_mfma_f32_16x16x32_bf16 v[12:15], v[96:99], v[20:23], 0
    v_mfma_f32_16x16x32_bf16 v[8:11], v[100:103], v[24:27], v[8:11]
    v_mfma_f32_16x16x32_bf16 v[12:15], v[100:103], v[28:31], v[12:15]
    v_mfma_f32_16x16x32_bf16 v[8:11], v[104:107], v[32:35], v[8:11]
    v_mfma_f32_16x16x32_bf16 v[12:15], v[104:107], v[36:39], v[12:15]
    v_mfma_f32_16x16x32_bf16 v[8:11], v[108:111], v[40:43], v[8:11]
    v_mfma_f32_16x16x32_bf16 v[12:15], v[108:111], v[44:47], v[12:15]
    v_mfma_f32_16x16x32_bf16 v[8:11], v[112:115], v[48:51], v[8:11]
    v_mfma_f32_16x16x32_bf16 v[12:15], v[112:115], v[52:55], v[12:15]
    v_mfma_f32_16x16x32_bf16 v[8:11], v[116:119], v[56:59], v[8:11]
    v_mfma_f32_16x16x32_bf16 v[12:15], v[116:119], v[60:63], v[12:15]
    v_mfma_f32_16x16x32_bf16 v[8:11], v[120:123], v[64:67], v[8:11]
    v_mfma_f32_16x16x32_bf16 v[12:15], v[120:123], v[68:71], v[12:15]
    v_mfma_f32_16x16x32_bf16 v[8:11], v[124:127], v[72:75], v[8:11]
    v_mfma_f32_16x16x32_bf16 v[12:15], v[124:127], v[76:79], v[12:15]
    v_mfma_f32_16x16x32_bf16 v[8:11], v[128:131], v[80:83], v[8:11]
    v_mfma_f32_16x16x32_bf16 v[12:15], v[128:131], v[84:87], v[12:15]
    v_mfma_f32_16x16x32_bf16 v[8:11], v[132:135], v[88:91], v[8:11]
    v_mfma_f32_16x16x32_bf16 v[12:15], v[132:135], v[92:95], v[12:15]
    s_nop 7
    s_add_u32 s22, s21, 27273216
    buffer_load_dwordx4 v[16:19], v1, s[4:7], s22 offen
    s_add_u32 s22, s21, 29894656
    buffer_load_dwordx4 v[20:23], v1, s[4:7], s22 offen
    s_add_u32 s22, s21, 27274240
    buffer_load_dwordx4 v[24:27], v1, s[4:7], s22 offen
    s_add_u32 s22, s21, 29895680
    buffer_load_dwordx4 v[28:31], v1, s[4:7], s22 offen
    s_add_u32 s22, s21, 27275264
    buffer_load_dwordx4 v[32:35], v1, s[4:7], s22 offen
    s_add_u32 s22, s21, 29896704
    buffer_load_dwordx4 v[36:39], v1, s[4:7], s22 offen
    s_add_u32 s22, s21, 27276288
    buffer_load_dwordx4 v[40:43], v1, s[4:7], s22 offen
    s_add_u32 s22, s21, 29897728
    buffer_load_dwordx4 v[44:47], v1, s[4:7], s22 offen
    s_add_u32 s22, s21, 27277312
    buffer_load_dwordx4 v[48:51], v1, s[4:7], s22 offen
    s_add_u32 s22, s21, 29898752
    buffer_load_dwordx4 v[52:55], v1, s[4:7], s22 offen
    s_add_u32 s22, s21, 27278336
    buffer_load_dwordx4 v[56:59], v1, s[4:7], s22 offen
    s_add_u32 s22, s21, 29899776
    buffer_load_dwordx4 v[60:63], v1, s[4:7], s22 offen
    s_add_u32 s22, s21, 27279360
    buffer_load_dwordx4 v[64:67], v1, s[4:7], s22 offen
    s_add_u32 s22, s21, 29900800
    buffer_load_dwordx4 v[68:71], v1, s[4:7], s22 offen
    s_add_u32 s22, s21, 27280384
    buffer_load_dwordx4 v[72:75], v1, s[4:7], s22 offen
    s_add_u32 s22, s21, 29901824
    buffer_load_dwordx4 v[76:79], v1, s[4:7], s22 offen
    s_add_u32 s22, s21, 27281408
    buffer_load_dwordx4 v[80:83], v1, s[4:7], s22 offen
    s_add_u32 s22, s21, 29902848
    buffer_load_dwordx4 v[84:87], v1, s[4:7], s22 offen
    s_add_u32 s22, s21, 27282432
    buffer_load_dwordx4 v[88:91], v1, s[4:7], s22 offen
    s_add_u32 s22, s21, 29903872
    buffer_load_dwordx4 v[92:95], v1, s[4:7], s22 offen
    s_waitcnt vmcnt(0)
    v_mfma_f32_16x16x32_bf16 v[8:11], v[136:139], v[16:19], v[8:11]
    v_mfma_f32_16x16x32_bf16 v[12:15], v[136:139], v[20:23], v[12:15]
    v_mfma_f32_16x16x32_bf16 v[8:11], v[140:143], v[24:27], v[8:11]
    v_mfma_f32_16x16x32_bf16 v[12:15], v[140:143], v[28:31], v[12:15]
    v_mfma_f32_16x16x32_bf16 v[8:11], v[144:147], v[32:35], v[8:11]
    v_mfma_f32_16x16x32_bf16 v[12:15], v[144:147], v[36:39], v[12:15]
    v_mfma_f32_16x16x32_bf16 v[8:11], v[148:151], v[40:43], v[8:11]
    v_mfma_f32_16x16x32_bf16 v[12:15], v[148:151], v[44:47], v[12:15]
    v_mfma_f32_16x16x32_bf16 v[8:11], v[152:155], v[48:51], v[8:11]
    v_mfma_f32_16x16x32_bf16 v[12:15], v[152:155], v[52:55], v[12:15]
    v_mfma_f32_16x16x32_bf16 v[8:11], v[156:159], v[56:59], v[8:11]
    v_mfma_f32_16x16x32_bf16 v[12:15], v[156:159], v[60:63], v[12:15]
    v_mfma_f32_16x16x32_bf16 v[8:11], v[160:163], v[64:67], v[8:11]
    v_mfma_f32_16x16x32_bf16 v[12:15], v[160:163], v[68:71], v[12:15]
    v_mfma_f32_16x16x32_bf16 v[8:11], v[164:167], v[72:75], v[8:11]
    v_mfma_f32_16x16x32_bf16 v[12:15], v[164:167], v[76:79], v[12:15]
    v_mfma_f32_16x16x32_bf16 v[8:11], v[168:171], v[80:83], v[8:11]
    v_mfma_f32_16x16x32_bf16 v[12:15], v[168:171], v[84:87], v[12:15]
    v_mfma_f32_16x16x32_bf16 v[8:11], v[172:175], v[88:91], v[8:11]
    v_mfma_f32_16x16x32_bf16 v[12:15], v[172:175], v[92:95], v[12:15]
    s_nop 7
    s_mov_b32 s19, 0xbfb8aa3b
    v_cvt_pk_bf16_f32 v8, v8, v8
    v_and_b32 v8, 0xffff0000, v8
    v_cvt_pk_bf16_f32 v12, v12, v12
    v_and_b32 v12, 0xffff0000, v12
    v_mul_f32 v16, s19, v8
    v_exp_f32 v16, v16
    s_nop 0
    v_add_f32 v16, 1.0, v16
    v_rcp_f32 v16, v16
    s_nop 0
    v_mul_f32 v8, v8, v16
    v_cvt_pk_bf16_f32 v8, v8, v8
    v_and_b32 v8, 0xffff0000, v8
    v_mul_f32 v8, v8, v12
    v_cvt_pk_bf16_f32 v8, v8, v8
    v_cvt_pk_bf16_f32 v9, v9, v9
    v_and_b32 v9, 0xffff0000, v9
    v_cvt_pk_bf16_f32 v13, v13, v13
    v_and_b32 v13, 0xffff0000, v13
    v_mul_f32 v16, s19, v9
    v_exp_f32 v16, v16
    s_nop 0
    v_add_f32 v16, 1.0, v16
    v_rcp_f32 v16, v16
    s_nop 0
    v_mul_f32 v9, v9, v16
    v_cvt_pk_bf16_f32 v9, v9, v9
    v_and_b32 v9, 0xffff0000, v9
    v_mul_f32 v9, v9, v13
    v_cvt_pk_bf16_f32 v9, v9, v9
    v_cvt_pk_bf16_f32 v10, v10, v10
    v_and_b32 v10, 0xffff0000, v10
    v_cvt_pk_bf16_f32 v14, v14, v14
    v_and_b32 v14, 0xffff0000, v14
    v_mul_f32 v16, s19, v10
    v_exp_f32 v16, v16
    s_nop 0
    v_add_f32 v16, 1.0, v16
    v_rcp_f32 v16, v16
    s_nop 0
    v_mul_f32 v10, v10, v16
    v_cvt_pk_bf16_f32 v10, v10, v10
    v_and_b32 v10, 0xffff0000, v10
    v_mul_f32 v10, v10, v14
    v_cvt_pk_bf16_f32 v10, v10, v10
    v_cvt_pk_bf16_f32 v11, v11, v11
    v_and_b32 v11, 0xffff0000, v11
    v_cvt_pk_bf16_f32 v15, v15, v15
    v_and_b32 v15, 0xffff0000, v15
    v_mul_f32 v16, s19, v11
    v_exp_f32 v16, v16
    s_nop 0
    v_add_f32 v16, 1.0, v16
    v_rcp_f32 v16, v16
    s_nop 0
    v_mul_f32 v11, v11, v16
    v_cvt_pk_bf16_f32 v11, v11, v11
    v_and_b32 v11, 0xffff0000, v11
    v_mul_f32 v11, v11, v15
    v_cvt_pk_bf16_f32 v11, v11, v11
    v_lshrrev_b32 v4, 4, v2
    v_mul_u32_u24 v4, 13824, v4
    v_and_b32 v5, 15, v2
    v_lshl_add_u32 v4, v5, 1, v4
    s_lshl_b32 s21, s20, 5
    s_add_u32 s21, s21, 5373952
    s_mov_b64 exec, 0xffffffff
    s_add_u32 s22, s21, 0
    buffer_store_short v8, v4, s[4:7], s22 offen
    s_add_u32 s22, s21, 3456
    buffer_store_short v9, v4, s[4:7], s22 offen
    s_add_u32 s22, s21, 6912
    buffer_store_short v10, v4, s[4:7], s22 offen
    s_add_u32 s22, s21, 10368
    buffer_store_short v11, v4, s[4:7], s22 offen
    s_mov_b64 exec, -1
    s_branch K3_END
K3_GEMM:
    v_lshrrev_b32 v1, 6, v0
    v_and_b32 v2, 63, v0
    v_readfirstlane_b32 s3, v1
    s_mov_b32 s6, 268435456
    s_mov_b32 s7, 0x00020000
    s_and_b32 s16, s2, 7
    s_lshr_b32 s17, s2, 3
    s_and_b32 s18, s17, 15
    s_lshr_b32 s17, s17, 4
    s_lshl_b32 s17, s17, 3
    s_add_u32 s19, s17, s16
    v_lshlrev_b32 v3, 4, v2
    s_cmp_lt_u32 s3, 2
    s_cselect_b32 s20, s18, s19
    s_cselect_b32 s21, 0, 2
    s_sub_u32 s21, s3, s21
    s_lshl_b32 s20, s20, 3
    s_lshl_b32 s21, s21, 2
    s_add_u32 s20, s20, s21
    s_mul_i32 s20, s20, 20480
    s_mov_b32 s22, 2621440
    s_mov_b32 s23, 6291456
    s_cmp_lt_u32 s3, 2
    s_cselect_b32 s22, s22, s23
    s_add_u32 s20, s20, s22
    s_lshl_b32 s21, s3, 12
    s_lshr_b32 s24, s3, 1
    s_and_b32 s25, s3, 1
    s_lshl_b32 s26, s24, 12
    v_add_u32 v4, s26, v3
    s_lshl_b32 s26, s25, 12
    s_add_u32 s26, s26, 8192
    v_add_u32 v5, s26, v3
    v_mov_b32 v64, 0
    v_mov_b32 v65, 0
    v_mov_b32 v66, 0
    v_mov_b32 v67, 0
    v_mov_b32 v68, 0
    v_mov_b32 v69, 0
    v_mov_b32 v70, 0
    v_mov_b32 v71, 0
    v_mov_b32 v72, 0
    v_mov_b32 v73, 0
    v_mov_b32 v74, 0
    v_mov_b32 v75, 0
    v_mov_b32 v76, 0
    v_mov_b32 v77, 0
    v_mov_b32 v78, 0
    v_mov_b32 v79, 0
    v_mov_b32 v80, 0
    v_mov_b32 v81, 0
    v_mov_b32 v82, 0
    v_mov_b32 v83, 0
    v_mov_b32 v84, 0
    v_mov_b32 v85, 0
    v_mov_b32 v86, 0
    v_mov_b32 v87, 0
    v_mov_b32 v88, 0
    v_mov_b32 v89, 0
    v_mov_b32 v90, 0
    v_mov_b32 v91, 0
    v_mov_b32 v92, 0
    v_mov_b32 v93, 0
    v_mov_b32 v94, 0
    v_mov_b32 v95, 0
    v_mov_b32 v96, 0
    v_mov_b32 v97, 0
    v_mov_b32 v98, 0
    v_mov_b32 v99, 0
    v_mov_b32 v100, 0
    v_mov_b32 v101, 0
    v_mov_b32 v102, 0
    v_mov_b32 v103, 0
    v_mov_b32 v104, 0
    v_mov_b32 v105, 0
    v_mov_b32 v106, 0
    v_mov_b32 v107, 0
    v_mov_b32 v108, 0
    v_mov_b32 v109, 0
    v_mov_b32 v110, 0
    v_mov_b32 v111, 0
    v_mov_b32 v112, 0
    v_mov_b32 v113, 0
    v_mov_b32 v114, 0
    v_mov_b32 v115, 0
    v_mov_b32 v116, 0
    v_mov_b32 v117, 0
    v_mov_b32 v118, 0
    v_mov_b32 v119, 0
    v_mov_b32 v120, 0
    v_mov_b32 v121, 0
    v_mov_b32 v122, 0
    v_mov_b32 v123, 0
    v_mov_b32 v124, 0
    v_mov_b32 v125, 0
    v_mov_b32 v126, 0
    v_mov_b32 v127, 0
    s_waitcnt lgkmcnt(0)
    s_add_u32 s27, s20, 0
    s_add_u32 m0, s21, 0
    s_nop 0
    buffer_load_dwordx4 v3, s[4:7], s27 offen lds
    s_add_u32 s27, s20, 20480
    s_add_u32 m0, s21, 1024
    s_nop 0
    buffer_load_dwordx4 v3, s[4:7], s27 offen lds
    s_add_u32 s27, s20, 40960
    s_add_u32 m0, s21, 2048
    s_nop 0
    buffer_load_dwordx4 v3, s[4:7], s27 offen lds
    s_add_u32 s27, s20, 61440
    s_add_u32 m0, s21, 3072
    s_nop 0
    buffer_load_dwordx4 v3, s[4:7], s27 offen lds
    s_add_u32 s27, s20, 1024
    s_add_u32 m0, s21, 16384
    s_nop 0
    buffer_load_dwordx4 v3, s[4:7], s27 offen lds
    s_add_u32 s27, s20, 21504
    s_add_u32 m0, s21, 17408
    s_nop 0
    buffer_load_dwordx4 v3, s[4:7], s27 offen lds
    s_add_u32 s27, s20, 41984
    s_add_u32 m0, s21, 18432
    s_nop 0
    buffer_load_dwordx4 v3, s[4:7], s27 offen lds
    s_add_u32 s27, s20, 62464
    s_add_u32 m0, s21, 19456
    s_nop 0
    buffer_load_dwordx4 v3, s[4:7], s27 offen lds
    s_add_u32 s27, s20, 2048
    s_add_u32 m0, s21, 32768
    s_nop 0
    buffer_load_dwordx4 v3, s[4:7], s27 offen lds
    s_add_u32 s27, s20, 22528
    s_add_u32 m0, s21, 33792
    s_nop 0
    buffer_load_dwordx4 v3, s[4:7], s27 offen lds
    s_add_u32 s27, s20, 43008
    s_add_u32 m0, s21, 34816
    s_nop 0
    buffer_load_dwordx4 v3, s[4:7], s27 offen lds
    s_add_u32 s27, s20, 63488
    s_add_u32 m0, s21, 35840
    s_nop 0
    buffer_load_dwordx4 v3, s[4:7], s27 offen lds
    s_cmp_ge_u32 s19, 64
    s_cbranch_scc1 K3_VPATH
    s_waitcnt vmcnt(8)
    s_barrier
    s_add_u32 s27, s20, 3072
    s_add_u32 m0, s21, 49152
    s_nop 0
    buffer_load_dwordx4 v3, s[4:7], s27 offen lds
    s_add_u32 s27, s20, 23552
    s_add_u32 m0, s21, 50176
    s_nop 0
    buffer_load_dwordx4 v3, s[4:7], s27 offen lds
    s_add_u32 s27, s20, 44032
    s_add_u32 m0, s21, 51200
    s_nop 0
    buffer_load_dwordx4 v3, s[4:7], s27 offen lds
    s_add_u32 s27, s20, 64512
    s_add_u32 m0, s21, 52224
    s_nop 0
    buffer_load_dwordx4 v3, s[4:7], s27 offen lds
    ds_read_b128 v[32:35], v4 offset:0
    ds_read_b128 v[36:39], v4 offset:1024
    ds_read_b128 v[40:43], v4 offset:2048
    ds_read_b128 v[44:47], v4 offset:3072
    ds_read_b128 v[48:51], v5 offset:0
    ds_read_b128 v[52:55], v5 offset:1024
    ds_read_b128 v[56:59], v5 offset:2048
    ds_read_b128 v[60:63], v5 offset:3072
    s_waitcnt lgkmcnt(3)
    v_mfma_f32_16x16x32_bf16 v[64:67], v[48:51], v[32:35], v[64:67]
    v_mfma_f32_16x16x32_bf16 v[68:71], v[48:51], v[36:39], v[68:71]
    v_mfma_f32_16x16x32_bf16 v[72:75], v[48:51], v[40:43], v[72:75]
    v_mfma_f32_16x16x32_bf16 v[76:79], v[48:51], v[44:47], v[76:79]
    s_waitcnt lgkmcnt(2)
    v_mfma_f32_16x16x32_bf16 v[80:83], v[52:55], v[32:35], v[80:83]
    v_mfma_f32_16x16x32_bf16 v[84:87], v[52:55], v[36:39], v[84:87]
    v_mfma_f32_16x16x32_bf16 v[88:91], v[52:55], v[40:43], v[88:91]
    v_mfma_f32_16x16x32_bf16 v[92:95], v[52:55], v[44:47], v[92:95]
    s_waitcnt lgkmcnt(1)
    v_mfma_f32_16x16x32_bf16 v[96:99], v[56:59], v[32:35], v[96:99]
    v_mfma_f32_16x16x32_bf16 v[100:103], v[56:59], v[36:39], v[100:103]
    v_mfma_f32_16x16x32_bf16 v[104:107], v[56:59], v[40:43], v[104:107]
    v_mfma_f32_16x16x32_bf16 v[108:111], v[56:59], v[44:47], v[108:111]
    s_waitcnt lgkmcnt(0)
    v_mfma_f32_16x16x32_bf16 v[112:115], v[60:63], v[32:35], v[112:115]
    v_mfma_f32_16x16x32_bf16 v[116:119], v[60:63], v[36:39], v[116:119]
    v_mfma_f32_16x16x32_bf16 v[120:123], v[60:63], v[40:43], v[120:123]
    v_mfma_f32_16x16x32_bf16 v[124:127], v[60:63], v[44:47], v[124:127]
    s_waitcnt vmcnt(8)
    s_barrier
    s_add_u32 s27, s20, 4096
    s_add_u32 m0, s21, 0
    s_nop 0
    buffer_load_dwordx4 v3, s[4:7], s27 offen lds
    s_add_u32 s27, s20, 24576
    s_add_u32 m0, s21, 1024
    s_nop 0
    buffer_load_dwordx4 v3, s[4:7], s27 offen lds
    s_add_u32 s27, s20, 45056
    s_add_u32 m0, s21, 2048
    s_nop 0
    buffer_load_dwordx4 v3, s[4:7], s27 offen lds
    s_add_u32 s27, s20, 65536
    s_add_u32 m0, s21, 3072
    s_nop 0
    buffer_load_dwordx4 v3, s[4:7], s27 offen lds
    ds_read_b128 v[32:35], v4 offset:16384
    ds_read_b128 v[36:39], v4 offset:17408
    ds_read_b128 v[40:43], v4 offset:18432
    ds_read_b128 v[44:47], v4 offset:19456
    ds_read_b128 v[48:51], v5 offset:16384
    ds_read_b128 v[52:55], v5 offset:17408
    ds_read_b128 v[56:59], v5 offset:18432
    ds_read_b128 v[60:63], v5 offset:19456
    s_waitcnt lgkmcnt(3)
    v_mfma_f32_16x16x32_bf16 v[64:67], v[48:51], v[32:35], v[64:67]
    v_mfma_f32_16x16x32_bf16 v[68:71], v[48:51], v[36:39], v[68:71]
    v_mfma_f32_16x16x32_bf16 v[72:75], v[48:51], v[40:43], v[72:75]
    v_mfma_f32_16x16x32_bf16 v[76:79], v[48:51], v[44:47], v[76:79]
    s_waitcnt lgkmcnt(2)
    v_mfma_f32_16x16x32_bf16 v[80:83], v[52:55], v[32:35], v[80:83]
    v_mfma_f32_16x16x32_bf16 v[84:87], v[52:55], v[36:39], v[84:87]
    v_mfma_f32_16x16x32_bf16 v[88:91], v[52:55], v[40:43], v[88:91]
    v_mfma_f32_16x16x32_bf16 v[92:95], v[52:55], v[44:47], v[92:95]
    s_waitcnt lgkmcnt(1)
    v_mfma_f32_16x16x32_bf16 v[96:99], v[56:59], v[32:35], v[96:99]
    v_mfma_f32_16x16x32_bf16 v[100:103], v[56:59], v[36:39], v[100:103]
    v_mfma_f32_16x16x32_bf16 v[104:107], v[56:59], v[40:43], v[104:107]
    v_mfma_f32_16x16x32_bf16 v[108:111], v[56:59], v[44:47], v[108:111]
    s_waitcnt lgkmcnt(0)
    v_mfma_f32_16x16x32_bf16 v[112:115], v[60:63], v[32:35], v[112:115]
    v_mfma_f32_16x16x32_bf16 v[116:119], v[60:63], v[36:39], v[116:119]
    v_mfma_f32_16x16x32_bf16 v[120:123], v[60:63], v[40:43], v[120:123]
    v_mfma_f32_16x16x32_bf16 v[124:127], v[60:63], v[44:47], v[124:127]
    s_waitcnt vmcnt(8)
    s_barrier
    s_add_u32 s27, s20, 5120
    s_add_u32 m0, s21, 16384
    s_nop 0
    buffer_load_dwordx4 v3, s[4:7], s27 offen lds
    s_add_u32 s27, s20, 25600
    s_add_u32 m0, s21, 17408
    s_nop 0
    buffer_load_dwordx4 v3, s[4:7], s27 offen lds
    s_add_u32 s27, s20, 46080
    s_add_u32 m0, s21, 18432
    s_nop 0
    buffer_load_dwordx4 v3, s[4:7], s27 offen lds
    s_add_u32 s27, s20, 66560
    s_add_u32 m0, s21, 19456
    s_nop 0
    buffer_load_dwordx4 v3, s[4:7], s27 offen lds
    ds_read_b128 v[32:35], v4 offset:32768
    ds_read_b128 v[36:39], v4 offset:33792
    ds_read_b128 v[40:43], v4 offset:34816
    ds_read_b128 v[44:47], v4 offset:35840
    ds_read_b128 v[48:51], v5 offset:32768
    ds_read_b128 v[52:55], v5 offset:33792
    ds_read_b128 v[56:59], v5 offset:34816
    ds_read_b128 v[60:63], v5 offset:35840
    s_waitcnt lgkmcnt(3)
    v_mfma_f32_16x16x32_bf16 v[64:67], v[48:51], v[32:35], v[64:67]
    v_mfma_f32_16x16x32_bf16 v[68:71], v[48:51], v[36:39], v[68:71]
    v_mfma_f32_16x16x32_bf16 v[72:75], v[48:51], v[40:43], v[72:75]
    v_mfma_f32_16x16x32_bf16 v[76:79], v[48:51], v[44:47], v[76:79]
    s_waitcnt lgkmcnt(2)
    v_mfma_f32_16x16x32_bf16 v[80:83], v[52:55], v[32:35], v[80:83]
    v_mfma_f32_16x16x32_bf16 v[84:87], v[52:55], v[36:39], v[84:87]
    v_mfma_f32_16x16x32_bf16 v[88:91], v[52:55], v[40:43], v[88:91]
    v_mfma_f32_16x16x32_bf16 v[92:95], v[52:55], v[44:47], v[92:95]
    s_waitcnt lgkmcnt(1)
    v_mfma_f32_16x16x32_bf16 v[96:99], v[56:59], v[32:35], v[96:99]
    v_mfma_f32_16x16x32_bf16 v[100:103], v[56:59], v[36:39], v[100:103]
    v_mfma_f32_16x16x32_bf16 v[104:107], v[56:59], v[40:43], v[104:107]
    v_mfma_f32_16x16x32_bf16 v[108:111], v[56:59], v[44:47], v[108:111]
    s_waitcnt lgkmcnt(0)
    v_mfma_f32_16x16x32_bf16 v[112:115], v[60:63], v[32:35], v[112:115]
    v_mfma_f32_16x16x32_bf16 v[116:119], v[60:63], v[36:39], v[116:119]
    v_mfma_f32_16x16x32_bf16 v[120:123], v[60:63], v[40:43], v[120:123]
    v_mfma_f32_16x16x32_bf16 v[124:127], v[60:63], v[44:47], v[124:127]
    s_waitcnt vmcnt(8)
    s_barrier
    s_add_u32 s27, s20, 6144
    s_add_u32 m0, s21, 32768
    s_nop 0
    buffer_load_dwordx4 v3, s[4:7], s27 offen lds
    s_add_u32 s27, s20, 26624
    s_add_u32 m0, s21, 33792
    s_nop 0
    buffer_load_dwordx4 v3, s[4:7], s27 offen lds
    s_add_u32 s27, s20, 47104
    s_add_u32 m0, s21, 34816
    s_nop 0
    buffer_load_dwordx4 v3, s[4:7], s27 offen lds
    s_add_u32 s27, s20, 67584
    s_add_u32 m0, s21, 35840
    s_nop 0
    buffer_load_dwordx4 v3, s[4:7], s27 offen lds
    ds_read_b128 v[32:35], v4 offset:49152
    ds_read_b128 v[36:39], v4 offset:50176
    ds_read_b128 v[40:43], v4 offset:51200
    ds_read_b128 v[44:47], v4 offset:52224
    ds_read_b128 v[48:51], v5 offset:49152
    ds_read_b128 v[52:55], v5 offset:50176
    ds_read_b128 v[56:59], v5 offset:51200
    ds_read_b128 v[60:63], v5 offset:52224
    s_waitcnt lgkmcnt(3)
    v_mfma_f32_16x16x32_bf16 v[64:67], v[48:51], v[32:35], v[64:67]
    v_mfma_f32_16x16x32_bf16 v[68:71], v[48:51], v[36:39], v[68:71]
    v_mfma_f32_16x16x32_bf16 v[72:75], v[48:51], v[40:43], v[72:75]
    v_mfma_f32_16x16x32_bf16 v[76:79], v[48:51], v[44:47], v[76:79]
    s_waitcnt lgkmcnt(2)
    v_mfma_f32_16x16x32_bf16 v[80:83], v[52:55], v[32:35], v[80:83]
    v_mfma_f32_16x16x32_bf16 v[84:87], v[52:55], v[36:39], v[84:87]
    v_mfma_f32_16x16x32_bf16 v[88:91], v[52:55], v[40:43], v[88:91]
    v_mfma_f32_16x16x32_bf16 v[92:95], v[52:55], v[44:47], v[92:95]
    s_waitcnt lgkmcnt(1)
    v_mfma_f32_16x16x32_bf16 v[96:99], v[56:59], v[32:35], v[96:99]
    v_mfma_f32_16x16x32_bf16 v[100:103], v[56:59], v[36:39], v[100:103]
    v_mfma_f32_16x16x32_bf16 v[104:107], v[56:59], v[40:43], v[104:107]
    v_mfma_f32_16x16x32_bf16 v[108:111], v[56:59], v[44:47], v[108:111]
    s_waitcnt lgkmcnt(0)
    v_mfma_f32_16x16x32_bf16 v[112:115], v[60:63], v[32:35], v[112:115]
    v_mfma_f32_16x16x32_bf16 v[116:119], v[60:63], v[36:39], v[116:119]
    v_mfma_f32_16x16x32_bf16 v[120:123], v[60:63], v[40:43], v[120:123]
    v_mfma_f32_16x16x32_bf16 v[124:127], v[60:63], v[44:47], v[124:127]
    s_waitcnt vmcnt(8)
    s_barrier
    s_add_u32 s27, s20, 7168
    s_add_u32 m0, s21, 49152
    s_nop 0
    buffer_load_dwordx4 v3, s[4:7], s27 offen lds
    s_add_u32 s27, s20, 27648
    s_add_u32 m0, s21, 50176
    s_nop 0
    buffer_load_dwordx4 v3, s[4:7], s27 offen lds
    s_add_u32 s27, s20, 48128
    s_add_u32 m0, s21, 51200
    s_nop 0
    buffer_load_dwordx4 v3, s[4:7], s27 offen lds
    s_add_u32 s27, s20, 68608
    s_add_u32 m0, s21, 52224
    s_nop 0
    buffer_load_dwordx4 v3, s[4:7], s27 offen lds
    ds_read_b128 v[32:35], v4 offset:0
    ds_read_b128 v[36:39], v4 offset:1024
    ds_read_b128 v[40:43], v4 offset:2048
    ds_read_b128 v[44:47], v4 offset:3072
    ds_read_b128 v[48:51], v5 offset:0
    ds_read_b128 v[52:55], v5 offset:1024
    ds_read_b128 v[56:59], v5 offset:2048
    ds_read_b128 v[60:63], v5 offset:3072
    s_waitcnt lgkmcnt(3)
    v_mfma_f32_16x16x32_bf16 v[64:67], v[48:51], v[32:35], v[64:67]
    v_mfma_f32_16x16x32_bf16 v[68:71], v[48:51], v[36:39], v[68:71]
    v_mfma_f32_16x16x32_bf16 v[72:75], v[48:51], v[40:43], v[72:75]
    v_mfma_f32_16x16x32_bf16 v[76:79], v[48:51], v[44:47], v[76:79]
    s_waitcnt lgkmcnt(2)
    v_mfma_f32_16x16x32_bf16 v[80:83], v[52:55], v[32:35], v[80:83]
    v_mfma_f32_16x16x32_bf16 v[84:87], v[52:55], v[36:39], v[84:87]
    v_mfma_f32_16x16x32_bf16 v[88:91], v[52:55], v[40:43], v[88:91]
    v_mfma_f32_16x16x32_bf16 v[92:95], v[52:55], v[44:47], v[92:95]
    s_waitcnt lgkmcnt(1)
    v_mfma_f32_16x16x32_bf16 v[96:99], v[56:59], v[32:35], v[96:99]
    v_mfma_f32_16x16x32_bf16 v[100:103], v[56:59], v[36:39], v[100:103]
    v_mfma_f32_16x16x32_bf16 v[104:107], v[56:59], v[40:43], v[104:107]
    v_mfma_f32_16x16x32_bf16 v[108:111], v[56:59], v[44:47], v[108:111]
    s_waitcnt lgkmcnt(0)
    v_mfma_f32_16x16x32_bf16 v[112:115], v[60:63], v[32:35], v[112:115]
    v_mfma_f32_16x16x32_bf16 v[116:119], v[60:63], v[36:39], v[116:119]
    v_mfma_f32_16x16x32_bf16 v[120:123], v[60:63], v[40:43], v[120:123]
    v_mfma_f32_16x16x32_bf16 v[124:127], v[60:63], v[44:47], v[124:127]
    s_waitcnt vmcnt(8)
    s_barrier
    s_add_u32 s27, s20, 8192
    s_add_u32 m0, s21, 0
    s_nop 0
    buffer_load_dwordx4 v3, s[4:7], s27 offen lds
    s_add_u32 s27, s20, 28672
    s_add_u32 m0, s21, 1024
    s_nop 0
    buffer_load_dwordx4 v3, s[4:7], s27 offen lds
    s_add_u32 s27, s20, 49152
    s_add_u32 m0, s21, 2048
    s_nop 0
    buffer_load_dwordx4 v3, s[4:7], s27 offen lds
    s_add_u32 s27, s20, 69632
    s_add_u32 m0, s21, 3072
    s_nop 0
    buffer_load_dwordx4 v3, s[4:7], s27 offen lds
    ds_read_b128 v[32:35], v4 offset:16384
    ds_read_b128 v[36:39], v4 offset:17408
    ds_read_b128 v[40:43], v4 offset:18432
    ds_read_b128 v[44:47], v4 offset:19456
    ds_read_b128 v[48:51], v5 offset:16384
    ds_read_b128 v[52:55], v5 offset:17408
    ds_read_b128 v[56:59], v5 offset:18432
    ds_read_b128 v[60:63], v5 offset:19456
    s_waitcnt lgkmcnt(3)
    v_mfma_f32_16x16x32_bf16 v[64:67], v[48:51], v[32:35], v[64:67]
    v_mfma_f32_16x16x32_bf16 v[68:71], v[48:51], v[36:39], v[68:71]
    v_mfma_f32_16x16x32_bf16 v[72:75], v[48:51], v[40:43], v[72:75]
    v_mfma_f32_16x16x32_bf16 v[76:79], v[48:51], v[44:47], v[76:79]
    s_waitcnt lgkmcnt(2)
    v_mfma_f32_16x16x32_bf16 v[80:83], v[52:55], v[32:35], v[80:83]
    v_mfma_f32_16x16x32_bf16 v[84:87], v[52:55], v[36:39], v[84:87]
    v_mfma_f32_16x16x32_bf16 v[88:91], v[52:55], v[40:43], v[88:91]
    v_mfma_f32_16x16x32_bf16 v[92:95], v[52:55], v[44:47], v[92:95]
    s_waitcnt lgkmcnt(1)
    v_mfma_f32_16x16x32_bf16 v[96:99], v[56:59], v[32:35], v[96:99]
    v_mfma_f32_16x16x32_bf16 v[100:103], v[56:59], v[36:39], v[100:103]
    v_mfma_f32_16x16x32_bf16 v[104:107], v[56:59], v[40:43], v[104:107]
    v_mfma_f32_16x16x32_bf16 v[108:111], v[56:59], v[44:47], v[108:111]
    s_waitcnt lgkmcnt(0)
    v_mfma_f32_16x16x32_bf16 v[112:115], v[60:63], v[32:35], v[112:115]
    v_mfma_f32_16x16x32_bf16 v[116:119], v[60:63], v[36:39], v[116:119]
    v_mfma_f32_16x16x32_bf16 v[120:123], v[60:63], v[40:43], v[120:123]
    v_mfma_f32_16x16x32_bf16 v[124:127], v[60:63], v[44:47], v[124:127]
    s_waitcnt vmcnt(8)
    s_barrier
    s_add_u32 s27, s20, 9216
    s_add_u32 m0, s21, 16384
    s_nop 0
    buffer_load_dwordx4 v3, s[4:7], s27 offen lds
    s_add_u32 s27, s20, 29696
    s_add_u32 m0, s21, 17408
    s_nop 0
    buffer_load_dwordx4 v3, s[4:7], s27 offen lds
    s_add_u32 s27, s20, 50176
    s_add_u32 m0, s21, 18432
    s_nop 0
    buffer_load_dwordx4 v3, s[4:7], s27 offen lds
    s_add_u32 s27, s20, 70656
    s_add_u32 m0, s21, 19456
    s_nop 0
    buffer_load_dwordx4 v3, s[4:7], s27 offen lds
    ds_read_b128 v[32:35], v4 offset:32768
    ds_read_b128 v[36:39], v4 offset:33792
    ds_read_b128 v[40:43], v4 offset:34816
    ds_read_b128 v[44:47], v4 offset:35840
    ds_read_b128 v[48:51], v5 offset:32768
    ds_read_b128 v[52:55], v5 offset:33792
    ds_read_b128 v[56:59], v5 offset:34816
    ds_read_b128 v[60:63], v5 offset:35840
    s_waitcnt lgkmcnt(3)
    v_mfma_f32_16x16x32_bf16 v[64:67], v[48:51], v[32:35], v[64:67]
    v_mfma_f32_16x16x32_bf16 v[68:71], v[48:51], v[36:39], v[68:71]
    v_mfma_f32_16x16x32_bf16 v[72:75], v[48:51], v[40:43], v[72:75]
    v_mfma_f32_16x16x32_bf16 v[76:79], v[48:51], v[44:47], v[76:79]
    s_waitcnt lgkmcnt(2)
    v_mfma_f32_16x16x32_bf16 v[80:83], v[52:55], v[32:35], v[80:83]
    v_mfma_f32_16x16x32_bf16 v[84:87], v[52:55], v[36:39], v[84:87]
    v_mfma_f32_16x16x32_bf16 v[88:91], v[52:55], v[40:43], v[88:91]
    v_mfma_f32_16x16x32_bf16 v[92:95], v[52:55], v[44:47], v[92:95]
    s_waitcnt lgkmcnt(1)
    v_mfma_f32_16x16x32_bf16 v[96:99], v[56:59], v[32:35], v[96:99]
    v_mfma_f32_16x16x32_bf16 v[100:103], v[56:59], v[36:39], v[100:103]
    v_mfma_f32_16x16x32_bf16 v[104:107], v[56:59], v[40:43], v[104:107]
    v_mfma_f32_16x16x32_bf16 v[108:111], v[56:59], v[44:47], v[108:111]
    s_waitcnt lgkmcnt(0)
    v_mfma_f32_16x16x32_bf16 v[112:115], v[60:63], v[32:35], v[112:115]
    v_mfma_f32_16x16x32_bf16 v[116:119], v[60:63], v[36:39], v[116:119]
    v_mfma_f32_16x16x32_bf16 v[120:123], v[60:63], v[40:43], v[120:123]
    v_mfma_f32_16x16x32_bf16 v[124:127], v[60:63], v[44:47], v[124:127]
    s_waitcnt vmcnt(8)
    s_barrier
    s_add_u32 s27, s20, 10240
    s_add_u32 m0, s21, 32768
    s_nop 0
    buffer_load_dwordx4 v3, s[4:7], s27 offen lds
    s_add_u32 s27, s20, 30720
    s_add_u32 m0, s21, 33792
    s_nop 0
    buffer_load_dwordx4 v3, s[4:7], s27 offen lds
    s_add_u32 s27, s20, 51200
    s_add_u32 m0, s21, 34816
    s_nop 0
    buffer_load_dwordx4 v3, s[4:7], s27 offen lds
    s_add_u32 s27, s20, 71680
    s_add_u32 m0, s21, 35840
    s_nop 0
    buffer_load_dwordx4 v3, s[4:7], s27 offen lds
    ds_read_b128 v[32:35], v4 offset:49152
    ds_read_b128 v[36:39], v4 offset:50176
    ds_read_b128 v[40:43], v4 offset:51200
    ds_read_b128 v[44:47], v4 offset:52224
    ds_read_b128 v[48:51], v5 offset:49152
    ds_read_b128 v[52:55], v5 offset:50176
    ds_read_b128 v[56:59], v5 offset:51200
    ds_read_b128 v[60:63], v5 offset:52224
    s_waitcnt lgkmcnt(3)
    v_mfma_f32_16x16x32_bf16 v[64:67], v[48:51], v[32:35], v[64:67]
    v_mfma_f32_16x16x32_bf16 v[68:71], v[48:51], v[36:39], v[68:71]
    v_mfma_f32_16x16x32_bf16 v[72:75], v[48:51], v[40:43], v[72:75]
    v_mfma_f32_16x16x32_bf16 v[76:79], v[48:51], v[44:47], v[76:79]
    s_waitcnt lgkmcnt(2)
    v_mfma_f32_16x16x32_bf16 v[80:83], v[52:55], v[32:35], v[80:83]
    v_mfma_f32_16x16x32_bf16 v[84:87], v[52:55], v[36:39], v[84:87]
    v_mfma_f32_16x16x32_bf16 v[88:91], v[52:55], v[40:43], v[88:91]
    v_mfma_f32_16x16x32_bf16 v[92:95], v[52:55], v[44:47], v[92:95]
    s_waitcnt lgkmcnt(1)
    v_mfma_f32_16x16x32_bf16 v[96:99], v[56:59], v[32:35], v[96:99]
    v_mfma_f32_16x16x32_bf16 v[100:103], v[56:59], v[36:39], v[100:103]
    v_mfma_f32_16x16x32_bf16 v[104:107], v[56:59], v[40:43], v[104:107]
    v_mfma_f32_16x16x32_bf16 v[108:111], v[56:59], v[44:47], v[108:111]
    s_waitcnt lgkmcnt(0)
    v_mfma_f32_16x16x32_bf16 v[112:115], v[60:63], v[32:35], v[112:115]
    v_mfma_f32_16x16x32_bf16 v[116:119], v[60:63], v[36:39], v[116:119]
    v_mfma_f32_16x16x32_bf16 v[120:123], v[60:63], v[40:43], v[120:123]
    v_mfma_f32_16x16x32_bf16 v[124:127], v[60:63], v[44:47], v[124:127]
    s_waitcnt vmcnt(8)
    s_barrier
    s_add_u32 s27, s20, 11264
    s_add_u32 m0, s21, 49152
    s_nop 0
    buffer_load_dwordx4 v3, s[4:7], s27 offen lds
    s_add_u32 s27, s20, 31744
    s_add_u32 m0, s21, 50176
    s_nop 0
    buffer_load_dwordx4 v3, s[4:7], s27 offen lds
    s_add_u32 s27, s20, 52224
    s_add_u32 m0, s21, 51200
    s_nop 0
    buffer_load_dwordx4 v3, s[4:7], s27 offen lds
    s_add_u32 s27, s20, 72704
    s_add_u32 m0, s21, 52224
    s_nop 0
    buffer_load_dwordx4 v3, s[4:7], s27 offen lds
    ds_read_b128 v[32:35], v4 offset:0
    ds_read_b128 v[36:39], v4 offset:1024
    ds_read_b128 v[40:43], v4 offset:2048
    ds_read_b128 v[44:47], v4 offset:3072
    ds_read_b128 v[48:51], v5 offset:0
    ds_read_b128 v[52:55], v5 offset:1024
    ds_read_b128 v[56:59], v5 offset:2048
    ds_read_b128 v[60:63], v5 offset:3072
    s_waitcnt lgkmcnt(3)
    v_mfma_f32_16x16x32_bf16 v[64:67], v[48:51], v[32:35], v[64:67]
    v_mfma_f32_16x16x32_bf16 v[68:71], v[48:51], v[36:39], v[68:71]
    v_mfma_f32_16x16x32_bf16 v[72:75], v[48:51], v[40:43], v[72:75]
    v_mfma_f32_16x16x32_bf16 v[76:79], v[48:51], v[44:47], v[76:79]
    s_waitcnt lgkmcnt(2)
    v_mfma_f32_16x16x32_bf16 v[80:83], v[52:55], v[32:35], v[80:83]
    v_mfma_f32_16x16x32_bf16 v[84:87], v[52:55], v[36:39], v[84:87]
    v_mfma_f32_16x16x32_bf16 v[88:91], v[52:55], v[40:43], v[88:91]
    v_mfma_f32_16x16x32_bf16 v[92:95], v[52:55], v[44:47], v[92:95]
    s_waitcnt lgkmcnt(1)
    v_mfma_f32_16x16x32_bf16 v[96:99], v[56:59], v[32:35], v[96:99]
    v_mfma_f32_16x16x32_bf16 v[100:103], v[56:59], v[36:39], v[100:103]
    v_mfma_f32_16x16x32_bf16 v[104:107], v[56:59], v[40:43], v[104:107]
    v_mfma_f32_16x16x32_bf16 v[108:111], v[56:59], v[44:47], v[108:111]
    s_waitcnt lgkmcnt(0)
    v_mfma_f32_16x16x32_bf16 v[112:115], v[60:63], v[32:35], v[112:115]
    v_mfma_f32_16x16x32_bf16 v[116:119], v[60:63], v[36:39], v[116:119]
    v_mfma_f32_16x16x32_bf16 v[120:123], v[60:63], v[40:43], v[120:123]
    v_mfma_f32_16x16x32_bf16 v[124:127], v[60:63], v[44:47], v[124:127]
    s_waitcnt vmcnt(8)
    s_barrier
    s_add_u32 s27, s20, 12288
    s_add_u32 m0, s21, 0
    s_nop 0
    buffer_load_dwordx4 v3, s[4:7], s27 offen lds
    s_add_u32 s27, s20, 32768
    s_add_u32 m0, s21, 1024
    s_nop 0
    buffer_load_dwordx4 v3, s[4:7], s27 offen lds
    s_add_u32 s27, s20, 53248
    s_add_u32 m0, s21, 2048
    s_nop 0
    buffer_load_dwordx4 v3, s[4:7], s27 offen lds
    s_add_u32 s27, s20, 73728
    s_add_u32 m0, s21, 3072
    s_nop 0
    buffer_load_dwordx4 v3, s[4:7], s27 offen lds
    ds_read_b128 v[32:35], v4 offset:16384
    ds_read_b128 v[36:39], v4 offset:17408
    ds_read_b128 v[40:43], v4 offset:18432
    ds_read_b128 v[44:47], v4 offset:19456
    ds_read_b128 v[48:51], v5 offset:16384
    ds_read_b128 v[52:55], v5 offset:17408
    ds_read_b128 v[56:59], v5 offset:18432
    ds_read_b128 v[60:63], v5 offset:19456
    s_waitcnt lgkmcnt(3)
    v_mfma_f32_16x16x32_bf16 v[64:67], v[48:51], v[32:35], v[64:67]
    v_mfma_f32_16x16x32_bf16 v[68:71], v[48:51], v[36:39], v[68:71]
    v_mfma_f32_16x16x32_bf16 v[72:75], v[48:51], v[40:43], v[72:75]
    v_mfma_f32_16x16x32_bf16 v[76:79], v[48:51], v[44:47], v[76:79]
    s_waitcnt lgkmcnt(2)
    v_mfma_f32_16x16x32_bf16 v[80:83], v[52:55], v[32:35], v[80:83]
    v_mfma_f32_16x16x32_bf16 v[84:87], v[52:55], v[36:39], v[84:87]
    v_mfma_f32_16x16x32_bf16 v[88:91], v[52:55], v[40:43], v[88:91]
    v_mfma_f32_16x16x32_bf16 v[92:95], v[52:55], v[44:47], v[92:95]
    s_waitcnt lgkmcnt(1)
    v_mfma_f32_16x16x32_bf16 v[96:99], v[56:59], v[32:35], v[96:99]
    v_mfma_f32_16x16x32_bf16 v[100:103], v[56:59], v[36:39], v[100:103]
    v_mfma_f32_16x16x32_bf16 v[104:107], v[56:59], v[40:43], v[104:107]
    v_mfma_f32_16x16x32_bf16 v[108:111], v[56:59], v[44:47], v[108:111]
    s_waitcnt lgkmcnt(0)
    v_mfma_f32_16x16x32_bf16 v[112:115], v[60:63], v[32:35], v[112:115]
    v_mfma_f32_16x16x32_bf16 v[116:119], v[60:63], v[36:39], v[116:119]
    v_mfma_f32_16x16x32_bf16 v[120:123], v[60:63], v[40:43], v[120:123]
    v_mfma_f32_16x16x32_bf16 v[124:127], v[60:63], v[44:47], v[124:127]
    s_waitcnt vmcnt(8)
    s_barrier
    s_add_u32 s27, s20, 13312
    s_add_u32 m0, s21, 16384
    s_nop 0
    buffer_load_dwordx4 v3, s[4:7], s27 offen lds
    s_add_u32 s27, s20, 33792
    s_add_u32 m0, s21, 17408
    s_nop 0
    buffer_load_dwordx4 v3, s[4:7], s27 offen lds
    s_add_u32 s27, s20, 54272
    s_add_u32 m0, s21, 18432
    s_nop 0
    buffer_load_dwordx4 v3, s[4:7], s27 offen lds
    s_add_u32 s27, s20, 74752
    s_add_u32 m0, s21, 19456
    s_nop 0
    buffer_load_dwordx4 v3, s[4:7], s27 offen lds
    ds_read_b128 v[32:35], v4 offset:32768
    ds_read_b128 v[36:39], v4 offset:33792
    ds_read_b128 v[40:43], v4 offset:34816
    ds_read_b128 v[44:47], v4 offset:35840
    ds_read_b128 v[48:51], v5 offset:32768
    ds_read_b128 v[52:55], v5 offset:33792
    ds_read_b128 v[56:59], v5 offset:34816
    ds_read_b128 v[60:63], v5 offset:35840
    s_waitcnt lgkmcnt(3)
    v_mfma_f32_16x16x32_bf16 v[64:67], v[48:51], v[32:35], v[64:67]
    v_mfma_f32_16x16x32_bf16 v[68:71], v[48:51], v[36:39], v[68:71]
    v_mfma_f32_16x16x32_bf16 v[72:75], v[48:51], v[40:43], v[72:75]
    v_mfma_f32_16x16x32_bf16 v[76:79], v[48:51], v[44:47], v[76:79]
    s_waitcnt lgkmcnt(2)
    v_mfma_f32_16x16x32_bf16 v[80:83], v[52:55], v[32:35], v[80:83]
    v_mfma_f32_16x16x32_bf16 v[84:87], v[52:55], v[36:39], v[84:87]
    v_mfma_f32_16x16x32_bf16 v[88:91], v[52:55], v[40:43], v[88:91]
    v_mfma_f32_16x16x32_bf16 v[92:95], v[52:55], v[44:47], v[92:95]
    s_waitcnt lgkmcnt(1)
    v_mfma_f32_16x16x32_bf16 v[96:99], v[56:59], v[32:35], v[96:99]
    v_mfma_f32_16x16x32_bf16 v[100:103], v[56:59], v[36:39], v[100:103]
    v_mfma_f32_16x16x32_bf16 v[104:107], v[56:59], v[40:43], v[104:107]
    v_mfma_f32_16x16x32_bf16 v[108:111], v[56:59], v[44:47], v[108:111]
    s_waitcnt lgkmcnt(0)
    v_mfma_f32_16x16x32_bf16 v[112:115], v[60:63], v[32:35], v[112:115]
    v_mfma_f32_16x16x32_bf16 v[116:119], v[60:63], v[36:39], v[116:119]
    v_mfma_f32_16x16x32_bf16 v[120:123], v[60:63], v[40:43], v[120:123]
    v_mfma_f32_16x16x32_bf16 v[124:127], v[60:63], v[44:47], v[124:127]
    s_waitcnt vmcnt(8)
    s_barrier
    s_add_u32 s27, s20, 14336
    s_add_u32 m0, s21, 32768
    s_nop 0
    buffer_load_dwordx4 v3, s[4:7], s27 offen lds
    s_add_u32 s27, s20, 34816
    s_add_u32 m0, s21, 33792
    s_nop 0
    buffer_load_dwordx4 v3, s[4:7], s27 offen lds
    s_add_u32 s27, s20, 55296
    s_add_u32 m0, s21, 34816
    s_nop 0
    buffer_load_dwordx4 v3, s[4:7], s27 offen lds
    s_add_u32 s27, s20, 75776
    s_add_u32 m0, s21, 35840
    s_nop 0
    buffer_load_dwordx4 v3, s[4:7], s27 offen lds
    ds_read_b128 v[32:35], v4 offset:49152
    ds_read_b128 v[36:39], v4 offset:50176
    ds_read_b128 v[40:43], v4 offset:51200
    ds_read_b128 v[44:47], v4 offset:52224
    ds_read_b128 v[48:51], v5 offset:49152
    ds_read_b128 v[52:55], v5 offset:50176
    ds_read_b128 v[56:59], v5 offset:51200
    ds_read_b128 v[60:63], v5 offset:52224
    s_waitcnt lgkmcnt(3)
    v_mfma_f32_16x16x32_bf16 v[64:67], v[48:51], v[32:35], v[64:67]
    v_mfma_f32_16x16x32_bf16 v[68:71], v[48:51], v[36:39], v[68:71]
    v_mfma_f32_16x16x32_bf16 v[72:75], v[48:51], v[40:43], v[72:75]
    v_mfma_f32_16x16x32_bf16 v[76:79], v[48:51], v[44:47], v[76:79]
    s_waitcnt lgkmcnt(2)
    v_mfma_f32_16x16x32_bf16 v[80:83], v[52:55], v[32:35], v[80:83]
    v_mfma_f32_16x16x32_bf16 v[84:87], v[52:55], v[36:39], v[84:87]
    v_mfma_f32_16x16x32_bf16 v[88:91], v[52:55], v[40:43], v[88:91]
    v_mfma_f32_16x16x32_bf16 v[92:95], v[52:55], v[44:47], v[92:95]
    s_waitcnt lgkmcnt(1)
    v_mfma_f32_16x16x32_bf16 v[96:99], v[56:59], v[32:35], v[96:99]
    v_mfma_f32_16x16x32_bf16 v[100:103], v[56:59], v[36:39], v[100:103]
    v_mfma_f32_16x16x32_bf16 v[104:107], v[56:59], v[40:43], v[104:107]
    v_mfma_f32_16x16x32_bf16 v[108:111], v[56:59], v[44:47], v[108:111]
    s_waitcnt lgkmcnt(0)
    v_mfma_f32_16x16x32_bf16 v[112:115], v[60:63], v[32:35], v[112:115]
    v_mfma_f32_16x16x32_bf16 v[116:119], v[60:63], v[36:39], v[116:119]
    v_mfma_f32_16x16x32_bf16 v[120:123], v[60:63], v[40:43], v[120:123]
    v_mfma_f32_16x16x32_bf16 v[124:127], v[60:63], v[44:47], v[124:127]
    s_waitcnt vmcnt(8)
    s_barrier
    s_add_u32 s27, s20, 15360
    s_add_u32 m0, s21, 49152
    s_nop 0
    buffer_load_dwordx4 v3, s[4:7], s27 offen lds
    s_add_u32 s27, s20, 35840
    s_add_u32 m0, s21, 50176
    s_nop 0
    buffer_load_dwordx4 v3, s[4:7], s27 offen lds
    s_add_u32 s27, s20, 56320
    s_add_u32 m0, s21, 51200
    s_nop 0
    buffer_load_dwordx4 v3, s[4:7], s27 offen lds
    s_add_u32 s27, s20, 76800
    s_add_u32 m0, s21, 52224
    s_nop 0
    buffer_load_dwordx4 v3, s[4:7], s27 offen lds
    ds_read_b128 v[32:35], v4 offset:0
    ds_read_b128 v[36:39], v4 offset:1024
    ds_read_b128 v[40:43], v4 offset:2048
    ds_read_b128 v[44:47], v4 offset:3072
    ds_read_b128 v[48:51], v5 offset:0
    ds_read_b128 v[52:55], v5 offset:1024
    ds_read_b128 v[56:59], v5 offset:2048
    ds_read_b128 v[60:63], v5 offset:3072
    s_waitcnt lgkmcnt(3)
    v_mfma_f32_16x16x32_bf16 v[64:67], v[48:51], v[32:35], v[64:67]
    v_mfma_f32_16x16x32_bf16 v[68:71], v[48:51], v[36:39], v[68:71]
    v_mfma_f32_16x16x32_bf16 v[72:75], v[48:51], v[40:43], v[72:75]
    v_mfma_f32_16x16x32_bf16 v[76:79], v[48:51], v[44:47], v[76:79]
    s_waitcnt lgkmcnt(2)
    v_mfma_f32_16x16x32_bf16 v[80:83], v[52:55], v[32:35], v[80:83]
    v_mfma_f32_16x16x32_bf16 v[84:87], v[52:55], v[36:39], v[84:87]
    v_mfma_f32_16x16x32_bf16 v[88:91], v[52:55], v[40:43], v[88:91]
    v_mfma_f32_16x16x32_bf16 v[92:95], v[52:55], v[44:47], v[92:95]
    s_waitcnt lgkmcnt(1)
    v_mfma_f32_16x16x32_bf16 v[96:99], v[56:59], v[32:35], v[96:99]
    v_mfma_f32_16x16x32_bf16 v[100:103], v[56:59], v[36:39], v[100:103]
    v_mfma_f32_16x16x32_bf16 v[104:107], v[56:59], v[40:43], v[104:107]
    v_mfma_f32_16x16x32_bf16 v[108:111], v[56:59], v[44:47], v[108:111]
    s_waitcnt lgkmcnt(0)
    v_mfma_f32_16x16x32_bf16 v[112:115], v[60:63], v[32:35], v[112:115]
    v_mfma_f32_16x16x32_bf16 v[116:119], v[60:63], v[36:39], v[116:119]
    v_mfma_f32_16x16x32_bf16 v[120:123], v[60:63], v[40:43], v[120:123]
    v_mfma_f32_16x16x32_bf16 v[124:127], v[60:63], v[44:47], v[124:127]
    s_waitcnt vmcnt(8)
    s_barrier
    s_add_u32 s27, s20, 16384
    s_add_u32 m0, s21, 0
    s_nop 0
    buffer_load_dwordx4 v3, s[4:7], s27 offen lds
    s_add_u32 s27, s20, 36864
    s_add_u32 m0, s21, 1024
    s_nop 0
    buffer_load_dwordx4 v3, s[4:7], s27 offen lds
    s_add_u32 s27, s20, 57344
    s_add_u32 m0, s21, 2048
    s_nop 0
    buffer_load_dwordx4 v3, s[4:7], s27 offen lds
    s_add_u32 s27, s20, 77824
    s_add_u32 m0, s21, 3072
    s_nop 0
    buffer_load_dwordx4 v3, s[4:7], s27 offen lds
    ds_read_b128 v[32:35], v4 offset:16384
    ds_read_b128 v[36:39], v4 offset:17408
    ds_read_b128 v[40:43], v4 offset:18432
    ds_read_b128 v[44:47], v4 offset:19456
    ds_read_b128 v[48:51], v5 offset:16384
    ds_read_b128 v[52:55], v5 offset:17408
    ds_read_b128 v[56:59], v5 offset:18432
    ds_read_b128 v[60:63], v5 offset:19456
    s_waitcnt lgkmcnt(3)
    v_mfma_f32_16x16x32_bf16 v[64:67], v[48:51], v[32:35], v[64:67]
    v_mfma_f32_16x16x32_bf16 v[68:71], v[48:51], v[36:39], v[68:71]
    v_mfma_f32_16x16x32_bf16 v[72:75], v[48:51], v[40:43], v[72:75]
    v_mfma_f32_16x16x32_bf16 v[76:79], v[48:51], v[44:47], v[76:79]
    s_waitcnt lgkmcnt(2)
    v_mfma_f32_16x16x32_bf16 v[80:83], v[52:55], v[32:35], v[80:83]
    v_mfma_f32_16x16x32_bf16 v[84:87], v[52:55], v[36:39], v[84:87]
    v_mfma_f32_16x16x32_bf16 v[88:91], v[52:55], v[40:43], v[88:91]
    v_mfma_f32_16x16x32_bf16 v[92:95], v[52:55], v[44:47], v[92:95]
    s_waitcnt lgkmcnt(1)
    v_mfma_f32_16x16x32_bf16 v[96:99], v[56:59], v[32:35], v[96:99]
    v_mfma_f32_16x16x32_bf16 v[100:103], v[56:59], v[36:39], v[100:103]
    v_mfma_f32_16x16x32_bf16 v[104:107], v[56:59], v[40:43], v[104:107]
    v_mfma_f32_16x16x32_bf16 v[108:111], v[56:59], v[44:47], v[108:111]
    s_waitcnt lgkmcnt(0)
    v_mfma_f32_16x16x32_bf16 v[112:115], v[60:63], v[32:35], v[112:115]
    v_mfma_f32_16x16x32_bf16 v[116:119], v[60:63], v[36:39], v[116:119]
    v_mfma_f32_16x16x32_bf16 v[120:123], v[60:63], v[40:43], v[120:123]
    v_mfma_f32_16x16x32_bf16 v[124:127], v[60:63], v[44:47], v[124:127]
    s_waitcnt vmcnt(8)
    s_barrier
    s_add_u32 s27, s20, 17408
    s_add_u32 m0, s21, 16384
    s_nop 0
    buffer_load_dwordx4 v3, s[4:7], s27 offen lds
    s_add_u32 s27, s20, 37888
    s_add_u32 m0, s21, 17408
    s_nop 0
    buffer_load_dwordx4 v3, s[4:7], s27 offen lds
    s_add_u32 s27, s20, 58368
    s_add_u32 m0, s21, 18432
    s_nop 0
    buffer_load_dwordx4 v3, s[4:7], s27 offen lds
    s_add_u32 s27, s20, 78848
    s_add_u32 m0, s21, 19456
    s_nop 0
    buffer_load_dwordx4 v3, s[4:7], s27 offen lds
    ds_read_b128 v[32:35], v4 offset:32768
    ds_read_b128 v[36:39], v4 offset:33792
    ds_read_b128 v[40:43], v4 offset:34816
    ds_read_b128 v[44:47], v4 offset:35840
    ds_read_b128 v[48:51], v5 offset:32768
    ds_read_b128 v[52:55], v5 offset:33792
    ds_read_b128 v[56:59], v5 offset:34816
    ds_read_b128 v[60:63], v5 offset:35840
    s_waitcnt lgkmcnt(3)
    v_mfma_f32_16x16x32_bf16 v[64:67], v[48:51], v[32:35], v[64:67]
    v_mfma_f32_16x16x32_bf16 v[68:71], v[48:51], v[36:39], v[68:71]
    v_mfma_f32_16x16x32_bf16 v[72:75], v[48:51], v[40:43], v[72:75]
    v_mfma_f32_16x16x32_bf16 v[76:79], v[48:51], v[44:47], v[76:79]
    s_waitcnt lgkmcnt(2)
    v_mfma_f32_16x16x32_bf16 v[80:83], v[52:55], v[32:35], v[80:83]
    v_mfma_f32_16x16x32_bf16 v[84:87], v[52:55], v[36:39], v[84:87]
    v_mfma_f32_16x16x32_bf16 v[88:91], v[52:55], v[40:43], v[88:91]
    v_mfma_f32_16x16x32_bf16 v[92:95], v[52:55], v[44:47], v[92:95]
    s_waitcnt lgkmcnt(1)
    v_mfma_f32_16x16x32_bf16 v[96:99], v[56:59], v[32:35], v[96:99]
    v_mfma_f32_16x16x32_bf16 v[100:103], v[56:59], v[36:39], v[100:103]
    v_mfma_f32_16x16x32_bf16 v[104:107], v[56:59], v[40:43], v[104:107]
    v_mfma_f32_16x16x32_bf16 v[108:111], v[56:59], v[44:47], v[108:111]
    s_waitcnt lgkmcnt(0)
    v_mfma_f32_16x16x32_bf16 v[112:115], v[60:63], v[32:35], v[112:115]
    v_mfma_f32_16x16x32_bf16 v[116:119], v[60:63], v[36:39], v[116:119]
    v_mfma_f32_16x16x32_bf16 v[120:123], v[60:63], v[40:43], v[120:123]
    v_mfma_f32_16x16x32_bf16 v[124:127], v[60:63], v[44:47], v[124:127]
    s_waitcnt vmcnt(8)
    s_barrier
    s_add_u32 s27, s20, 18432
    s_add_u32 m0, s21, 32768
    s_nop 0
    buffer_load_dwordx4 v3, s[4:7], s27 offen lds
    s_add_u32 s27, s20, 38912
    s_add_u32 m0, s21, 33792
    s_nop 0
    buffer_load_dwordx4 v3, s[4:7], s27 offen lds
    s_add_u32 s27, s20, 59392
    s_add_u32 m0, s21, 34816
    s_nop 0
    buffer_load_dwordx4 v3, s[4:7], s27 offen lds
    s_add_u32 s27, s20, 79872
    s_add_u32 m0, s21, 35840
    s_nop 0
    buffer_load_dwordx4 v3, s[4:7], s27 offen lds
    ds_read_b128 v[32:35], v4 offset:49152
    ds_read_b128 v[36:39], v4 offset:50176
    ds_read_b128 v[40:43], v4 offset:51200
    ds_read_b128 v[44:47], v4 offset:52224
    ds_read_b128 v[48:51], v5 offset:49152
    ds_read_b128 v[52:55], v5 offset:50176
    ds_read_b128 v[56:59], v5 offset:51200
    ds_read_b128 v[60:63], v5 offset:52224
    s_waitcnt lgkmcnt(3)
    v_mfma_f32_16x16x32_bf16 v[64:67], v[48:51], v[32:35], v[64:67]
    v_mfma_f32_16x16x32_bf16 v[68:71], v[48:51], v[36:39], v[68:71]
    v_mfma_f32_16x16x32_bf16 v[72:75], v[48:51], v[40:43], v[72:75]
    v_mfma_f32_16x16x32_bf16 v[76:79], v[48:51], v[44:47], v[76:79]
    s_waitcnt lgkmcnt(2)
    v_mfma_f32_16x16x32_bf16 v[80:83], v[52:55], v[32:35], v[80:83]
    v_mfma_f32_16x16x32_bf16 v[84:87], v[52:55], v[36:39], v[84:87]
    v_mfma_f32_16x16x32_bf16 v[88:91], v[52:55], v[40:43], v[88:91]
    v_mfma_f32_16x16x32_bf16 v[92:95], v[52:55], v[44:47], v[92:95]
    s_waitcnt lgkmcnt(1)
    v_mfma_f32_16x16x32_bf16 v[96:99], v[56:59], v[32:35], v[96:99]
    v_mfma_f32_16x16x32_bf16 v[100:103], v[56:59], v[36:39], v[100:103]
    v_mfma_f32_16x16x32_bf16 v[104:107], v[56:59], v[40:43], v[104:107]
    v_mfma_f32_16x16x32_bf16 v[108:111], v[56:59], v[44:47], v[108:111]
    s_waitcnt lgkmcnt(0)
    v_mfma_f32_16x16x32_bf16 v[112:115], v[60:63], v[32:35], v[112:115]
    v_mfma_f32_16x16x32_bf16 v[116:119], v[60:63], v[36:39], v[116:119]
    v_mfma_f32_16x16x32_bf16 v[120:123], v[60:63], v[40:43], v[120:123]
    v_mfma_f32_16x16x32_bf16 v[124:127], v[60:63], v[44:47], v[124:127]
    s_waitcnt vmcnt(8)
    s_barrier
    s_add_u32 s27, s20, 19456
    s_add_u32 m0, s21, 49152
    s_nop 0
    buffer_load_dwordx4 v3, s[4:7], s27 offen lds
    s_add_u32 s27, s20, 39936
    s_add_u32 m0, s21, 50176
    s_nop 0
    buffer_load_dwordx4 v3, s[4:7], s27 offen lds
    s_add_u32 s27, s20, 60416
    s_add_u32 m0, s21, 51200
    s_nop 0
    buffer_load_dwordx4 v3, s[4:7], s27 offen lds
    s_add_u32 s27, s20, 80896
    s_add_u32 m0, s21, 52224
    s_nop 0
    buffer_load_dwordx4 v3, s[4:7], s27 offen lds
    ds_read_b128 v[32:35], v4 offset:0
    ds_read_b128 v[36:39], v4 offset:1024
    ds_read_b128 v[40:43], v4 offset:2048
    ds_read_b128 v[44:47], v4 offset:3072
    ds_read_b128 v[48:51], v5 offset:0
    ds_read_b128 v[52:55], v5 offset:1024
    ds_read_b128 v[56:59], v5 offset:2048
    ds_read_b128 v[60:63], v5 offset:3072
    s_waitcnt lgkmcnt(3)
    v_mfma_f32_16x16x32_bf16 v[64:67], v[48:51], v[32:35], v[64:67]
    v_mfma_f32_16x16x32_bf16 v[68:71], v[48:51], v[36:39], v[68:71]
    v_mfma_f32_16x16x32_bf16 v[72:75], v[48:51], v[40:43], v[72:75]
    v_mfma_f32_16x16x32_bf16 v[76:79], v[48:51], v[44:47], v[76:79]
    s_waitcnt lgkmcnt(2)
    v_mfma_f32_16x16x32_bf16 v[80:83], v[52:55], v[32:35], v[80:83]
    v_mfma_f32_16x16x32_bf16 v[84:87], v[52:55], v[36:39], v[84:87]
    v_mfma_f32_16x16x32_bf16 v[88:91], v[52:55], v[40:43], v[88:91]
    v_mfma_f32_16x16x32_bf16 v[92:95], v[52:55], v[44:47], v[92:95]
    s_waitcnt lgkmcnt(1)
    v_mfma_f32_16x16x32_bf16 v[96:99], v[56:59], v[32:35], v[96:99]
    v_mfma_f32_16x16x32_bf16 v[100:103], v[56:59], v[36:39], v[100:103]
    v_mfma_f32_16x16x32_bf16 v[104:107], v[56:59], v[40:43], v[104:107]
    v_mfma_f32_16x16x32_bf16 v[108:111], v[56:59], v[44:47], v[108:111]
    s_waitcnt lgkmcnt(0)
    v_mfma_f32_16x16x32_bf16 v[112:115], v[60:63], v[32:35], v[112:115]
    v_mfma_f32_16x16x32_bf16 v[116:119], v[60:63], v[36:39], v[116:119]
    v_mfma_f32_16x16x32_bf16 v[120:123], v[60:63], v[40:43], v[120:123]
    v_mfma_f32_16x16x32_bf16 v[124:127], v[60:63], v[44:47], v[124:127]
    s_waitcnt vmcnt(8)
    s_barrier
    ds_read_b128 v[32:35], v4 offset:16384
    ds_read_b128 v[36:39], v4 offset:17408
    ds_read_b128 v[40:43], v4 offset:18432
    ds_read_b128 v[44:47], v4 offset:19456
    ds_read_b128 v[48:51], v5 offset:16384
    ds_read_b128 v[52:55], v5 offset:17408
    ds_read_b128 v[56:59], v5 offset:18432
    ds_read_b128 v[60:63], v5 offset:19456
    s_waitcnt lgkmcnt(3)
    v_mfma_f32_16x16x32_bf16 v[64:67], v[48:51], v[32:35], v[64:67]
    v_mfma_f32_16x16x32_bf16 v[68:71], v[48:51], v[36:39], v[68:71]
    v_mfma_f32_16x16x32_bf16 v[72:75], v[48:51], v[40:43], v[72:75]
    v_mfma_f32_16x16x32_bf16 v[76:79], v[48:51], v[44:47], v[76:79]
    s_waitcnt lgkmcnt(2)
    v_mfma_f32_16x16x32_bf16 v[80:83], v[52:55], v[32:35], v[80:83]
    v_mfma_f32_16x16x32_bf16 v[84:87], v[52:55], v[36:39], v[84:87]
    v_mfma_f32_16x16x32_bf16 v[88:91], v[52:55], v[40:43], v[88:91]
    v_mfma_f32_16x16x32_bf16 v[92:95], v[52:55], v[44:47], v[92:95]
    s_waitcnt lgkmcnt(1)
    v_mfma_f32_16x16x32_bf16 v[96:99], v[56:59], v[32:35], v[96:99]
    v_mfma_f32_16x16x32_bf16 v[100:103], v[56:59], v[36:39], v[100:103]
    v_mfma_f32_16x16x32_bf16 v[104:107], v[56:59], v[40:43], v[104:107]
    v_mfma_f32_16x16x32_bf16 v[108:111], v[56:59], v[44:47], v[108:111]
    s_waitcnt lgkmcnt(0)
    v_mfma_f32_16x16x32_bf16 v[112:115], v[60:63], v[32:35], v[112:115]
    v_mfma_f32_16x16x32_bf16 v[116:119], v[60:63], v[36:39], v[116:119]
    v_mfma_f32_16x16x32_bf16 v[120:123], v[60:63], v[40:43], v[120:123]
    v_mfma_f32_16x16x32_bf16 v[124:127], v[60:63], v[44:47], v[124:127]
    s_waitcnt vmcnt(4)
    s_barrier
    ds_read_b128 v[32:35], v4 offset:32768
    ds_read_b128 v[36:39], v4 offset:33792
    ds_read_b128 v[40:43], v4 offset:34816
    ds_read_b128 v[44:47], v4 offset:35840
    ds_read_b128 v[48:51], v5 offset:32768
    ds_read_b128 v[52:55], v5 offset:33792
    ds_read_b128 v[56:59], v5 offset:34816
    ds_read_b128 v[60:63], v5 offset:35840
    s_waitcnt lgkmcnt(3)
    v_mfma_f32_16x16x32_bf16 v[64:67], v[48:51], v[32:35], v[64:67]
    v_mfma_f32_16x16x32_bf16 v[68:71], v[48:51], v[36:39], v[68:71]
    v_mfma_f32_16x16x32_bf16 v[72:75], v[48:51], v[40:43], v[72:75]
    v_mfma_f32_16x16x32_bf16 v[76:79], v[48:51], v[44:47], v[76:79]
    s_waitcnt lgkmcnt(2)
    v_mfma_f32_16x16x32_bf16 v[80:83], v[52:55], v[32:35], v[80:83]
    v_mfma_f32_16x16x32_bf16 v[84:87], v[52:55], v[36:39], v[84:87]
    v_mfma_f32_16x16x32_bf16 v[88:91], v[52:55], v[40:43], v[88:91]
    v_mfma_f32_16x16x32_bf16 v[92:95], v[52:55], v[44:47], v[92:95]
    s_waitcnt lgkmcnt(1)
    v_mfma_f32_16x16x32_bf16 v[96:99], v[56:59], v[32:35], v[96:99]
    v_mfma_f32_16x16x32_bf16 v[100:103], v[56:59], v[36:39], v[100:103]
    v_mfma_f32_16x16x32_bf16 v[104:107], v[56:59], v[40:43], v[104:107]
    v_mfma_f32_16x16x32_bf16 v[108:111], v[56:59], v[44:47], v[108:111]
    s_waitcnt lgkmcnt(0)
    v_mfma_f32_16x16x32_bf16 v[112:115], v[60:63], v[32:35], v[112:115]
    v_mfma_f32_16x16x32_bf16 v[116:119], v[60:63], v[36:39], v[116:119]
    v_mfma_f32_16x16x32_bf16 v[120:123], v[60:63], v[40:43], v[120:123]
    v_mfma_f32_16x16x32_bf16 v[124:127], v[60:63], v[44:47], v[124:127]
    s_waitcnt vmcnt(0)
    s_barrier
    ds_read_b128 v[32:35], v4 offset:49152
    ds_read_b128 v[36:39], v4 offset:50176
    ds_read_b128 v[40:43], v4 offset:51200
    ds_read_b128 v[44:47], v4 offset:52224
    ds_read_b128 v[48:51], v5 offset:49152
    ds_read_b128 v[52:55], v5 offset:50176
    ds_read_b128 v[56:59], v5 offset:51200
    ds_read_b128 v[60:63], v5 offset:52224
    s_waitcnt lgkmcnt(3)
    v_mfma_f32_16x16x32_bf16 v[64:67], v[48:51], v[32:35], v[64:67]
    v_mfma_f32_16x16x32_bf16 v[68:71], v[48:51], v[36:39], v[68:71]
    v_mfma_f32_16x16x32_bf16 v[72:75], v[48:51], v[40:43], v[72:75]
    v_mfma_f32_16x16x32_bf16 v[76:79], v[48:51], v[44:47], v[76:79]
    s_waitcnt lgkmcnt(2)
    v_mfma_f32_16x16x32_bf16 v[80:83], v[52:55], v[32:35], v[80:83]
    v_mfma_f32_16x16x32_bf16 v[84:87], v[52:55], v[36:39], v[84:87]
    v_mfma_f32_16x16x32_bf16 v[88:91], v[52:55], v[40:43], v[88:91]
    v_mfma_f32_16x16x32_bf16 v[92:95], v[52:55], v[44:47], v[92:95]
    s_waitcnt lgkmcnt(1)
    v_mfma_f32_16x16x32_bf16 v[96:99], v[56:59], v[32:35], v[96:99]
    v_mfma_f32_16x16x32_bf16 v[100:103], v[56:59], v[36:39], v[100:103]
    v_mfma_f32_16x16x32_bf16 v[104:107], v[56:59], v[40:43], v[104:107]
    v_mfma_f32_16x16x32_bf16 v[108:111], v[56:59], v[44:47], v[108:111]
    s_waitcnt lgkmcnt(0)
    v_mfma_f32_16x16x32_bf16 v[112:115], v[60:63], v[32:35], v[112:115]
    v_mfma_f32_16x16x32_bf16 v[116:119], v[60:63], v[36:39], v[116:119]
    v_mfma_f32_16x16x32_bf16 v[120:123], v[60:63], v[40:43], v[120:123]
    v_mfma_f32_16x16x32_bf16 v[124:127], v[60:63], v[44:47], v[124:127]
    s_and_b32 s27, s19, 31
    s_cmp_lt_u32 s19, 32
    s_mov_b32 s28, 52428800
    s_cselect_b32 s28, 35651584, s28
    s_lshl_b32 s29, s18, 3
    s_lshl_b32 s30, s24, 2
    s_add_u32 s29, s29, s30
    s_lshl_b32 s29, s29, 5
    s_add_u32 s29, s29, s27
    s_lshl_b32 s29, s29, 2
    s_lshl_b32 s30, s25, 1
    s_add_u32 s29, s29, s30
    s_lshl_b32 s29, s29, 10
    s_add_u32 s28, s28, s29
    v_cvt_pk_bf16_f32 v32, v64, v65
    v_cvt_pk_bf16_f32 v33, v66, v67
    v_cvt_pk_bf16_f32 v34, v80, v81
    v_cvt_pk_bf16_f32 v35, v82, v83
    s_add_u32 s29, s28, 0
    buffer_store_dwordx4 v[32:35], v3, s[4:7], s29 offen
    v_cvt_pk_bf16_f32 v36, v96, v97
    v_cvt_pk_bf16_f32 v37, v98, v99
    v_cvt_pk_bf16_f32 v38, v112, v113
    v_cvt_pk_bf16_f32 v39, v114, v115
    s_add_u32 s29, s28, 1024
    buffer_store_dwordx4 v[36:39], v3, s[4:7], s29 offen
    v_cvt_pk_bf16_f32 v40, v68, v69
    v_cvt_pk_bf16_f32 v41, v70, v71
    v_cvt_pk_bf16_f32 v42, v84, v85
    v_cvt_pk_bf16_f32 v43, v86, v87
    s_add_u32 s29, s28, 131072
    buffer_store_dwordx4 v[40:43], v3, s[4:7], s29 offen
    v_cvt_pk_bf16_f32 v44, v100, v101
    v_cvt_pk_bf16_f32 v45, v102, v103
    v_cvt_pk_bf16_f32 v46, v116, v117
    v_cvt_pk_bf16_f32 v47, v118, v119
    s_add_u32 s29, s28, 132096
    buffer_store_dwordx4 v[44:47], v3, s[4:7], s29 offen
    v_cvt_pk_bf16_f32 v32, v72, v73
    v_cvt_pk_bf16_f32 v33, v74, v75
    v_cvt_pk_bf16_f32 v34, v88, v89
    v_cvt_pk_bf16_f32 v35, v90, v91
    s_add_u32 s29, s28, 262144
    buffer_store_dwordx4 v[32:35], v3, s[4:7], s29 offen
    v_cvt_pk_bf16_f32 v36, v104, v105
    v_cvt_pk_bf16_f32 v37, v106, v107
    v_cvt_pk_bf16_f32 v38, v120, v121
    v_cvt_pk_bf16_f32 v39, v122, v123
    s_add_u32 s29, s28, 263168
    buffer_store_dwordx4 v[36:39], v3, s[4:7], s29 offen
    v_cvt_pk_bf16_f32 v40, v76, v77
    v_cvt_pk_bf16_f32 v41, v78, v79
    v_cvt_pk_bf16_f32 v42, v92, v93
    v_cvt_pk_bf16_f32 v43, v94, v95
    s_add_u32 s29, s28, 393216
    buffer_store_dwordx4 v[40:43], v3, s[4:7], s29 offen
    v_cvt_pk_bf16_f32 v44, v108, v109
    v_cvt_pk_bf16_f32 v45, v110, v111
    v_cvt_pk_bf16_f32 v46, v124, v125
    v_cvt_pk_bf16_f32 v47, v126, v127
    s_add_u32 s29, s28, 394240
    buffer_store_dwordx4 v[44:47], v3, s[4:7], s29 offen
    s_branch K3_END
K3_VPATH:
    s_waitcnt vmcnt(8)
    s_barrier
    s_add_u32 s27, s20, 3072
    s_add_u32 m0, s21, 49152
    s_nop 0
    buffer_load_dwordx4 v3, s[4:7], s27 offen lds
    s_add_u32 s27, s20, 23552
    s_add_u32 m0, s21, 50176
    s_nop 0
    buffer_load_dwordx4 v3, s[4:7], s27 offen lds
    s_add_u32 s27, s20, 44032
    s_add_u32 m0, s21, 51200
    s_nop 0
    buffer_load_dwordx4 v3, s[4:7], s27 offen lds
    s_add_u32 s27, s20, 64512
    s_add_u32 m0, s21, 52224
    s_nop 0
    buffer_load_dwordx4 v3, s[4:7], s27 offen lds
    ds_read_b128 v[32:35], v4 offset:0
    ds_read_b128 v[36:39], v4 offset:1024
    ds_read_b128 v[40:43], v4 offset:2048
    ds_read_b128 v[44:47], v4 offset:3072
    ds_read_b128 v[48:51], v5 offset:0
    ds_read_b128 v[52:55], v5 offset:1024
    ds_read_b128 v[56:59], v5 offset:2048
    ds_read_b128 v[60:63], v5 offset:3072
    s_waitcnt lgkmcnt(3)
    v_mfma_f32_16x16x32_bf16 v[64:67], v[32:35], v[48:51], v[64:67]
    v_mfma_f32_16x16x32_bf16 v[68:71], v[36:39], v[48:51], v[68:71]
    v_mfma_f32_16x16x32_bf16 v[72:75], v[40:43], v[48:51], v[72:75]
    v_mfma_f32_16x16x32_bf16 v[76:79], v[44:47], v[48:51], v[76:79]
    s_waitcnt lgkmcnt(2)
    v_mfma_f32_16x16x32_bf16 v[80:83], v[32:35], v[52:55], v[80:83]
    v_mfma_f32_16x16x32_bf16 v[84:87], v[36:39], v[52:55], v[84:87]
    v_mfma_f32_16x16x32_bf16 v[88:91], v[40:43], v[52:55], v[88:91]
    v_mfma_f32_16x16x32_bf16 v[92:95], v[44:47], v[52:55], v[92:95]
    s_waitcnt lgkmcnt(1)
    v_mfma_f32_16x16x32_bf16 v[96:99], v[32:35], v[56:59], v[96:99]
    v_mfma_f32_16x16x32_bf16 v[100:103], v[36:39], v[56:59], v[100:103]
    v_mfma_f32_16x16x32_bf16 v[104:107], v[40:43], v[56:59], v[104:107]
    v_mfma_f32_16x16x32_bf16 v[108:111], v[44:47], v[56:59], v[108:111]
    s_waitcnt lgkmcnt(0)
    v_mfma_f32_16x16x32_bf16 v[112:115], v[32:35], v[60:63], v[112:115]
    v_mfma_f32_16x16x32_bf16 v[116:119], v[36:39], v[60:63], v[116:119]
    v_mfma_f32_16x16x32_bf16 v[120:123], v[40:43], v[60:63], v[120:123]
    v_mfma_f32_16x16x32_bf16 v[124:127], v[44:47], v[60:63], v[124:127]
    s_waitcnt vmcnt(8)
    s_barrier
    s_add_u32 s27, s20, 4096
    s_add_u32 m0, s21, 0
    s_nop 0
    buffer_load_dwordx4 v3, s[4:7], s27 offen lds
    s_add_u32 s27, s20, 24576
    s_add_u32 m0, s21, 1024
    s_nop 0
    buffer_load_dwordx4 v3, s[4:7], s27 offen lds
    s_add_u32 s27, s20, 45056
    s_add_u32 m0, s21, 2048
    s_nop 0
    buffer_load_dwordx4 v3, s[4:7], s27 offen lds
    s_add_u32 s27, s20, 65536
    s_add_u32 m0, s21, 3072
    s_nop 0
    buffer_load_dwordx4 v3, s[4:7], s27 offen lds
    ds_read_b128 v[32:35], v4 offset:16384
    ds_read_b128 v[36:39], v4 offset:17408
    ds_read_b128 v[40:43], v4 offset:18432
    ds_read_b128 v[44:47], v4 offset:19456
    ds_read_b128 v[48:51], v5 offset:16384
    ds_read_b128 v[52:55], v5 offset:17408
    ds_read_b128 v[56:59], v5 offset:18432
    ds_read_b128 v[60:63], v5 offset:19456
    s_waitcnt lgkmcnt(3)
    v_mfma_f32_16x16x32_bf16 v[64:67], v[32:35], v[48:51], v[64:67]
    v_mfma_f32_16x16x32_bf16 v[68:71], v[36:39], v[48:51], v[68:71]
    v_mfma_f32_16x16x32_bf16 v[72:75], v[40:43], v[48:51], v[72:75]
    v_mfma_f32_16x16x32_bf16 v[76:79], v[44:47], v[48:51], v[76:79]
    s_waitcnt lgkmcnt(2)
    v_mfma_f32_16x16x32_bf16 v[80:83], v[32:35], v[52:55], v[80:83]
    v_mfma_f32_16x16x32_bf16 v[84:87], v[36:39], v[52:55], v[84:87]
    v_mfma_f32_16x16x32_bf16 v[88:91], v[40:43], v[52:55], v[88:91]
    v_mfma_f32_16x16x32_bf16 v[92:95], v[44:47], v[52:55], v[92:95]
    s_waitcnt lgkmcnt(1)
    v_mfma_f32_16x16x32_bf16 v[96:99], v[32:35], v[56:59], v[96:99]
    v_mfma_f32_16x16x32_bf16 v[100:103], v[36:39], v[56:59], v[100:103]
    v_mfma_f32_16x16x32_bf16 v[104:107], v[40:43], v[56:59], v[104:107]
    v_mfma_f32_16x16x32_bf16 v[108:111], v[44:47], v[56:59], v[108:111]
    s_waitcnt lgkmcnt(0)
    v_mfma_f32_16x16x32_bf16 v[112:115], v[32:35], v[60:63], v[112:115]
    v_mfma_f32_16x16x32_bf16 v[116:119], v[36:39], v[60:63], v[116:119]
    v_mfma_f32_16x16x32_bf16 v[120:123], v[40:43], v[60:63], v[120:123]
    v_mfma_f32_16x16x32_bf16 v[124:127], v[44:47], v[60:63], v[124:127]
    s_waitcnt vmcnt(8)
    s_barrier
    s_add_u32 s27, s20, 5120
    s_add_u32 m0, s21, 16384
    s_nop 0
    buffer_load_dwordx4 v3, s[4:7], s27 offen lds
    s_add_u32 s27, s20, 25600
    s_add_u32 m0, s21, 17408
    s_nop 0
    buffer_load_dwordx4 v3, s[4:7], s27 offen lds
    s_add_u32 s27, s20, 46080
    s_add_u32 m0, s21, 18432
    s_nop 0
    buffer_load_dwordx4 v3, s[4:7], s27 offen lds
    s_add_u32 s27, s20, 66560
    s_add_u32 m0, s21, 19456
    s_nop 0
    buffer_load_dwordx4 v3, s[4:7], s27 offen lds
    ds_read_b128 v[32:35], v4 offset:32768
    ds_read_b128 v[36:39], v4 offset:33792
    ds_read_b128 v[40:43], v4 offset:34816
    ds_read_b128 v[44:47], v4 offset:35840
    ds_read_b128 v[48:51], v5 offset:32768
    ds_read_b128 v[52:55], v5 offset:33792
    ds_read_b128 v[56:59], v5 offset:34816
    ds_read_b128 v[60:63], v5 offset:35840
    s_waitcnt lgkmcnt(3)
    v_mfma_f32_16x16x32_bf16 v[64:67], v[32:35], v[48:51], v[64:67]
    v_mfma_f32_16x16x32_bf16 v[68:71], v[36:39], v[48:51], v[68:71]
    v_mfma_f32_16x16x32_bf16 v[72:75], v[40:43], v[48:51], v[72:75]
    v_mfma_f32_16x16x32_bf16 v[76:79], v[44:47], v[48:51], v[76:79]
    s_waitcnt lgkmcnt(2)
    v_mfma_f32_16x16x32_bf16 v[80:83], v[32:35], v[52:55], v[80:83]
    v_mfma_f32_16x16x32_bf16 v[84:87], v[36:39], v[52:55], v[84:87]
    v_mfma_f32_16x16x32_bf16 v[88:91], v[40:43], v[52:55], v[88:91]
    v_mfma_f32_16x16x32_bf16 v[92:95], v[44:47], v[52:55], v[92:95]
    s_waitcnt lgkmcnt(1)
    v_mfma_f32_16x16x32_bf16 v[96:99], v[32:35], v[56:59], v[96:99]
    v_mfma_f32_16x16x32_bf16 v[100:103], v[36:39], v[56:59], v[100:103]
    v_mfma_f32_16x16x32_bf16 v[104:107], v[40:43], v[56:59], v[104:107]
    v_mfma_f32_16x16x32_bf16 v[108:111], v[44:47], v[56:59], v[108:111]
    s_waitcnt lgkmcnt(0)
    v_mfma_f32_16x16x32_bf16 v[112:115], v[32:35], v[60:63], v[112:115]
    v_mfma_f32_16x16x32_bf16 v[116:119], v[36:39], v[60:63], v[116:119]
    v_mfma_f32_16x16x32_bf16 v[120:123], v[40:43], v[60:63], v[120:123]
    v_mfma_f32_16x16x32_bf16 v[124:127], v[44:47], v[60:63], v[124:127]
    s_waitcnt vmcnt(8)
    s_barrier
    s_add_u32 s27, s20, 6144
    s_add_u32 m0, s21, 32768
    s_nop 0
    buffer_load_dwordx4 v3, s[4:7], s27 offen lds
    s_add_u32 s27, s20, 26624
    s_add_u32 m0, s21, 33792
    s_nop 0
    buffer_load_dwordx4 v3, s[4:7], s27 offen lds
    s_add_u32 s27, s20, 47104
    s_add_u32 m0, s21, 34816
    s_nop 0
    buffer_load_dwordx4 v3, s[4:7], s27 offen lds
    s_add_u32 s27, s20, 67584
    s_add_u32 m0, s21, 35840
    s_nop 0
    buffer_load_dwordx4 v3, s[4:7], s27 offen lds
    ds_read_b128 v[32:35], v4 offset:49152
    ds_read_b128 v[36:39], v4 offset:50176
    ds_read_b128 v[40:43], v4 offset:51200
    ds_read_b128 v[44:47], v4 offset:52224
    ds_read_b128 v[48:51], v5 offset:49152
    ds_read_b128 v[52:55], v5 offset:50176
    ds_read_b128 v[56:59], v5 offset:51200
    ds_read_b128 v[60:63], v5 offset:52224
    s_waitcnt lgkmcnt(3)
    v_mfma_f32_16x16x32_bf16 v[64:67], v[32:35], v[48:51], v[64:67]
    v_mfma_f32_16x16x32_bf16 v[68:71], v[36:39], v[48:51], v[68:71]
    v_mfma_f32_16x16x32_bf16 v[72:75], v[40:43], v[48:51], v[72:75]
    v_mfma_f32_16x16x32_bf16 v[76:79], v[44:47], v[48:51], v[76:79]
    s_waitcnt lgkmcnt(2)
    v_mfma_f32_16x16x32_bf16 v[80:83], v[32:35], v[52:55], v[80:83]
    v_mfma_f32_16x16x32_bf16 v[84:87], v[36:39], v[52:55], v[84:87]
    v_mfma_f32_16x16x32_bf16 v[88:91], v[40:43], v[52:55], v[88:91]
    v_mfma_f32_16x16x32_bf16 v[92:95], v[44:47], v[52:55], v[92:95]
    s_waitcnt lgkmcnt(1)
    v_mfma_f32_16x16x32_bf16 v[96:99], v[32:35], v[56:59], v[96:99]
    v_mfma_f32_16x16x32_bf16 v[100:103], v[36:39], v[56:59], v[100:103]
    v_mfma_f32_16x16x32_bf16 v[104:107], v[40:43], v[56:59], v[104:107]
    v_mfma_f32_16x16x32_bf16 v[108:111], v[44:47], v[56:59], v[108:111]
    s_waitcnt lgkmcnt(0)
    v_mfma_f32_16x16x32_bf16 v[112:115], v[32:35], v[60:63], v[112:115]
    v_mfma_f32_16x16x32_bf16 v[116:119], v[36:39], v[60:63], v[116:119]
    v_mfma_f32_16x16x32_bf16 v[120:123], v[40:43], v[60:63], v[120:123]
    v_mfma_f32_16x16x32_bf16 v[124:127], v[44:47], v[60:63], v[124:127]
    s_waitcnt vmcnt(8)
    s_barrier
    s_add_u32 s27, s20, 7168
    s_add_u32 m0, s21, 49152
    s_nop 0
    buffer_load_dwordx4 v3, s[4:7], s27 offen lds
    s_add_u32 s27, s20, 27648
    s_add_u32 m0, s21, 50176
    s_nop 0
    buffer_load_dwordx4 v3, s[4:7], s27 offen lds
    s_add_u32 s27, s20, 48128
    s_add_u32 m0, s21, 51200
    s_nop 0
    buffer_load_dwordx4 v3, s[4:7], s27 offen lds
    s_add_u32 s27, s20, 68608
    s_add_u32 m0, s21, 52224
    s_nop 0
    buffer_load_dwordx4 v3, s[4:7], s27 offen lds
    ds_read_b128 v[32:35], v4 offset:0
    ds_read_b128 v[36:39], v4 offset:1024
    ds_read_b128 v[40:43], v4 offset:2048
    ds_read_b128 v[44:47], v4 offset:3072
    ds_read_b128 v[48:51], v5 offset:0
    ds_read_b128 v[52:55], v5 offset:1024
    ds_read_b128 v[56:59], v5 offset:2048
    ds_read_b128 v[60:63], v5 offset:3072
    s_waitcnt lgkmcnt(3)
    v_mfma_f32_16x16x32_bf16 v[64:67], v[32:35], v[48:51], v[64:67]
    v_mfma_f32_16x16x32_bf16 v[68:71], v[36:39], v[48:51], v[68:71]
    v_mfma_f32_16x16x32_bf16 v[72:75], v[40:43], v[48:51], v[72:75]
    v_mfma_f32_16x16x32_bf16 v[76:79], v[44:47], v[48:51], v[76:79]
    s_waitcnt lgkmcnt(2)
    v_mfma_f32_16x16x32_bf16 v[80:83], v[32:35], v[52:55], v[80:83]
    v_mfma_f32_16x16x32_bf16 v[84:87], v[36:39], v[52:55], v[84:87]
    v_mfma_f32_16x16x32_bf16 v[88:91], v[40:43], v[52:55], v[88:91]
    v_mfma_f32_16x16x32_bf16 v[92:95], v[44:47], v[52:55], v[92:95]
    s_waitcnt lgkmcnt(1)
    v_mfma_f32_16x16x32_bf16 v[96:99], v[32:35], v[56:59], v[96:99]
    v_mfma_f32_16x16x32_bf16 v[100:103], v[36:39], v[56:59], v[100:103]
    v_mfma_f32_16x16x32_bf16 v[104:107], v[40:43], v[56:59], v[104:107]
    v_mfma_f32_16x16x32_bf16 v[108:111], v[44:47], v[56:59], v[108:111]
    s_waitcnt lgkmcnt(0)
    v_mfma_f32_16x16x32_bf16 v[112:115], v[32:35], v[60:63], v[112:115]
    v_mfma_f32_16x16x32_bf16 v[116:119], v[36:39], v[60:63], v[116:119]
    v_mfma_f32_16x16x32_bf16 v[120:123], v[40:43], v[60:63], v[120:123]
    v_mfma_f32_16x16x32_bf16 v[124:127], v[44:47], v[60:63], v[124:127]
    s_waitcnt vmcnt(8)
    s_barrier
    s_add_u32 s27, s20, 8192
    s_add_u32 m0, s21, 0
    s_nop 0
    buffer_load_dwordx4 v3, s[4:7], s27 offen lds
    s_add_u32 s27, s20, 28672
    s_add_u32 m0, s21, 1024
    s_nop 0
    buffer_load_dwordx4 v3, s[4:7], s27 offen lds
    s_add_u32 s27, s20, 49152
    s_add_u32 m0, s21, 2048
    s_nop 0
    buffer_load_dwordx4 v3, s[4:7], s27 offen lds
    s_add_u32 s27, s20, 69632
    s_add_u32 m0, s21, 3072
    s_nop 0
    buffer_load_dwordx4 v3, s[4:7], s27 offen lds
    ds_read_b128 v[32:35], v4 offset:16384
    ds_read_b128 v[36:39], v4 offset:17408
    ds_read_b128 v[40:43], v4 offset:18432
    ds_read_b128 v[44:47], v4 offset:19456
    ds_read_b128 v[48:51], v5 offset:16384
    ds_read_b128 v[52:55], v5 offset:17408
    ds_read_b128 v[56:59], v5 offset:18432
    ds_read_b128 v[60:63], v5 offset:19456
    s_waitcnt lgkmcnt(3)
    v_mfma_f32_16x16x32_bf16 v[64:67], v[32:35], v[48:51], v[64:67]
    v_mfma_f32_16x16x32_bf16 v[68:71], v[36:39], v[48:51], v[68:71]
    v_mfma_f32_16x16x32_bf16 v[72:75], v[40:43], v[48:51], v[72:75]
    v_mfma_f32_16x16x32_bf16 v[76:79], v[44:47], v[48:51], v[76:79]
    s_waitcnt lgkmcnt(2)
    v_mfma_f32_16x16x32_bf16 v[80:83], v[32:35], v[52:55], v[80:83]
    v_mfma_f32_16x16x32_bf16 v[84:87], v[36:39], v[52:55], v[84:87]
    v_mfma_f32_16x16x32_bf16 v[88:91], v[40:43], v[52:55], v[88:91]
    v_mfma_f32_16x16x32_bf16 v[92:95], v[44:47], v[52:55], v[92:95]
    s_waitcnt lgkmcnt(1)
    v_mfma_f32_16x16x32_bf16 v[96:99], v[32:35], v[56:59], v[96:99]
    v_mfma_f32_16x16x32_bf16 v[100:103], v[36:39], v[56:59], v[100:103]
    v_mfma_f32_16x16x32_bf16 v[104:107], v[40:43], v[56:59], v[104:107]
    v_mfma_f32_16x16x32_bf16 v[108:111], v[44:47], v[56:59], v[108:111]
    s_waitcnt lgkmcnt(0)
    v_mfma_f32_16x16x32_bf16 v[112:115], v[32:35], v[60:63], v[112:115]
    v_mfma_f32_16x16x32_bf16 v[116:119], v[36:39], v[60:63], v[116:119]
    v_mfma_f32_16x16x32_bf16 v[120:123], v[40:43], v[60:63], v[120:123]
    v_mfma_f32_16x16x32_bf16 v[124:127], v[44:47], v[60:63], v[124:127]
    s_waitcnt vmcnt(8)
    s_barrier
    s_add_u32 s27, s20, 9216
    s_add_u32 m0, s21, 16384
    s_nop 0
    buffer_load_dwordx4 v3, s[4:7], s27 offen lds
    s_add_u32 s27, s20, 29696
    s_add_u32 m0, s21, 17408
    s_nop 0
    buffer_load_dwordx4 v3, s[4:7], s27 offen lds
    s_add_u32 s27, s20, 50176
    s_add_u32 m0, s21, 18432
    s_nop 0
    buffer_load_dwordx4 v3, s[4:7], s27 offen lds
    s_add_u32 s27, s20, 70656
    s_add_u32 m0, s21, 19456
    s_nop 0
    buffer_load_dwordx4 v3, s[4:7], s27 offen lds
    ds_read_b128 v[32:35], v4 offset:32768
    ds_read_b128 v[36:39], v4 offset:33792
    ds_read_b128 v[40:43], v4 offset:34816
    ds_read_b128 v[44:47], v4 offset:35840
    ds_read_b128 v[48:51], v5 offset:32768
    ds_read_b128 v[52:55], v5 offset:33792
    ds_read_b128 v[56:59], v5 offset:34816
    ds_read_b128 v[60:63], v5 offset:35840
    s_waitcnt lgkmcnt(3)
    v_mfma_f32_16x16x32_bf16 v[64:67], v[32:35], v[48:51], v[64:67]
    v_mfma_f32_16x16x32_bf16 v[68:71], v[36:39], v[48:51], v[68:71]
    v_mfma_f32_16x16x32_bf16 v[72:75], v[40:43], v[48:51], v[72:75]
    v_mfma_f32_16x16x32_bf16 v[76:79], v[44:47], v[48:51], v[76:79]
    s_waitcnt lgkmcnt(2)
    v_mfma_f32_16x16x32_bf16 v[80:83], v[32:35], v[52:55], v[80:83]
    v_mfma_f32_16x16x32_bf16 v[84:87], v[36:39], v[52:55], v[84:87]
    v_mfma_f32_16x16x32_bf16 v[88:91], v[40:43], v[52:55], v[88:91]
    v_mfma_f32_16x16x32_bf16 v[92:95], v[44:47], v[52:55], v[92:95]
    s_waitcnt lgkmcnt(1)
    v_mfma_f32_16x16x32_bf16 v[96:99], v[32:35], v[56:59], v[96:99]
    v_mfma_f32_16x16x32_bf16 v[100:103], v[36:39], v[56:59], v[100:103]
    v_mfma_f32_16x16x32_bf16 v[104:107], v[40:43], v[56:59], v[104:107]
    v_mfma_f32_16x16x32_bf16 v[108:111], v[44:47], v[56:59], v[108:111]
    s_waitcnt lgkmcnt(0)
    v_mfma_f32_16x16x32_bf16 v[112:115], v[32:35], v[60:63], v[112:115]
    v_mfma_f32_16x16x32_bf16 v[116:119], v[36:39], v[60:63], v[116:119]
    v_mfma_f32_16x16x32_bf16 v[120:123], v[40:43], v[60:63], v[120:123]
    v_mfma_f32_16x16x32_bf16 v[124:127], v[44:47], v[60:63], v[124:127]
    s_waitcnt vmcnt(8)
    s_barrier
    s_add_u32 s27, s20, 10240
    s_add_u32 m0, s21, 32768
    s_nop 0
    buffer_load_dwordx4 v3, s[4:7], s27 offen lds
    s_add_u32 s27, s20, 30720
    s_add_u32 m0, s21, 33792
    s_nop 0
    buffer_load_dwordx4 v3, s[4:7], s27 offen lds
    s_add_u32 s27, s20, 51200
    s_add_u32 m0, s21, 34816
    s_nop 0
    buffer_load_dwordx4 v3, s[4:7], s27 offen lds
    s_add_u32 s27, s20, 71680
    s_add_u32 m0, s21, 35840
    s_nop 0
    buffer_load_dwordx4 v3, s[4:7], s27 offen lds
    ds_read_b128 v[32:35], v4 offset:49152
    ds_read_b128 v[36:39], v4 offset:50176
    ds_read_b128 v[40:43], v4 offset:51200
    ds_read_b128 v[44:47], v4 offset:52224
    ds_read_b128 v[48:51], v5 offset:49152
    ds_read_b128 v[52:55], v5 offset:50176
    ds_read_b128 v[56:59], v5 offset:51200
    ds_read_b128 v[60:63], v5 offset:52224
    s_waitcnt lgkmcnt(3)
    v_mfma_f32_16x16x32_bf16 v[64:67], v[32:35], v[48:51], v[64:67]
    v_mfma_f32_16x16x32_bf16 v[68:71], v[36:39], v[48:51], v[68:71]
    v_mfma_f32_16x16x32_bf16 v[72:75], v[40:43], v[48:51], v[72:75]
    v_mfma_f32_16x16x32_bf16 v[76:79], v[44:47], v[48:51], v[76:79]
    s_waitcnt lgkmcnt(2)
    v_mfma_f32_16x16x32_bf16 v[80:83], v[32:35], v[52:55], v[80:83]
    v_mfma_f32_16x16x32_bf16 v[84:87], v[36:39], v[52:55], v[84:87]
    v_mfma_f32_16x16x32_bf16 v[88:91], v[40:43], v[52:55], v[88:91]
    v_mfma_f32_16x16x32_bf16 v[92:95], v[44:47], v[52:55], v[92:95]
    s_waitcnt lgkmcnt(1)
    v_mfma_f32_16x16x32_bf16 v[96:99], v[32:35], v[56:59], v[96:99]
    v_mfma_f32_16x16x32_bf16 v[100:103], v[36:39], v[56:59], v[100:103]
    v_mfma_f32_16x16x32_bf16 v[104:107], v[40:43], v[56:59], v[104:107]
    v_mfma_f32_16x16x32_bf16 v[108:111], v[44:47], v[56:59], v[108:111]
    s_waitcnt lgkmcnt(0)
    v_mfma_f32_16x16x32_bf16 v[112:115], v[32:35], v[60:63], v[112:115]
    v_mfma_f32_16x16x32_bf16 v[116:119], v[36:39], v[60:63], v[116:119]
    v_mfma_f32_16x16x32_bf16 v[120:123], v[40:43], v[60:63], v[120:123]
    v_mfma_f32_16x16x32_bf16 v[124:127], v[44:47], v[60:63], v[124:127]
    s_waitcnt vmcnt(8)
    s_barrier
    s_add_u32 s27, s20, 11264
    s_add_u32 m0, s21, 49152
    s_nop 0
    buffer_load_dwordx4 v3, s[4:7], s27 offen lds
    s_add_u32 s27, s20, 31744
    s_add_u32 m0, s21, 50176
    s_nop 0
    buffer_load_dwordx4 v3, s[4:7], s27 offen lds
    s_add_u32 s27, s20, 52224
    s_add_u32 m0, s21, 51200
    s_nop 0
    buffer_load_dwordx4 v3, s[4:7], s27 offen lds
    s_add_u32 s27, s20, 72704
    s_add_u32 m0, s21, 52224
    s_nop 0
    buffer_load_dwordx4 v3, s[4:7], s27 offen lds
    ds_read_b128 v[32:35], v4 offset:0
    ds_read_b128 v[36:39], v4 offset:1024
    ds_read_b128 v[40:43], v4 offset:2048
    ds_read_b128 v[44:47], v4 offset:3072
    ds_read_b128 v[48:51], v5 offset:0
    ds_read_b128 v[52:55], v5 offset:1024
    ds_read_b128 v[56:59], v5 offset:2048
    ds_read_b128 v[60:63], v5 offset:3072
    s_waitcnt lgkmcnt(3)
    v_mfma_f32_16x16x32_bf16 v[64:67], v[32:35], v[48:51], v[64:67]
    v_mfma_f32_16x16x32_bf16 v[68:71], v[36:39], v[48:51], v[68:71]
    v_mfma_f32_16x16x32_bf16 v[72:75], v[40:43], v[48:51], v[72:75]
    v_mfma_f32_16x16x32_bf16 v[76:79], v[44:47], v[48:51], v[76:79]
    s_waitcnt lgkmcnt(2)
    v_mfma_f32_16x16x32_bf16 v[80:83], v[32:35], v[52:55], v[80:83]
    v_mfma_f32_16x16x32_bf16 v[84:87], v[36:39], v[52:55], v[84:87]
    v_mfma_f32_16x16x32_bf16 v[88:91], v[40:43], v[52:55], v[88:91]
    v_mfma_f32_16x16x32_bf16 v[92:95], v[44:47], v[52:55], v[92:95]
    s_waitcnt lgkmcnt(1)
    v_mfma_f32_16x16x32_bf16 v[96:99], v[32:35], v[56:59], v[96:99]
    v_mfma_f32_16x16x32_bf16 v[100:103], v[36:39], v[56:59], v[100:103]
    v_mfma_f32_16x16x32_bf16 v[104:107], v[40:43], v[56:59], v[104:107]
    v_mfma_f32_16x16x32_bf16 v[108:111], v[44:47], v[56:59], v[108:111]
    s_waitcnt lgkmcnt(0)
    v_mfma_f32_16x16x32_bf16 v[112:115], v[32:35], v[60:63], v[112:115]
    v_mfma_f32_16x16x32_bf16 v[116:119], v[36:39], v[60:63], v[116:119]
    v_mfma_f32_16x16x32_bf16 v[120:123], v[40:43], v[60:63], v[120:123]
    v_mfma_f32_16x16x32_bf16 v[124:127], v[44:47], v[60:63], v[124:127]
    s_waitcnt vmcnt(8)
    s_barrier
    s_add_u32 s27, s20, 12288
    s_add_u32 m0, s21, 0
    s_nop 0
    buffer_load_dwordx4 v3, s[4:7], s27 offen lds
    s_add_u32 s27, s20, 32768
    s_add_u32 m0, s21, 1024
    s_nop 0
    buffer_load_dwordx4 v3, s[4:7], s27 offen lds
    s_add_u32 s27, s20, 53248
    s_add_u32 m0, s21, 2048
    s_nop 0
    buffer_load_dwordx4 v3, s[4:7], s27 offen lds
    s_add_u32 s27, s20, 73728
    s_add_u32 m0, s21, 3072
    s_nop 0
    buffer_load_dwordx4 v3, s[4:7], s27 offen lds
    ds_read_b128 v[32:35], v4 offset:16384
    ds_read_b128 v[36:39], v4 offset:17408
    ds_read_b128 v[40:43], v4 offset:18432
    ds_read_b128 v[44:47], v4 offset:19456
    ds_read_b128 v[48:51], v5 offset:16384
    ds_read_b128 v[52:55], v5 offset:17408
    ds_read_b128 v[56:59], v5 offset:18432
    ds_read_b128 v[60:63], v5 offset:19456
    s_waitcnt lgkmcnt(3)
    v_mfma_f32_16x16x32_bf16 v[64:67], v[32:35], v[48:51], v[64:67]
    v_mfma_f32_16x16x32_bf16 v[68:71], v[36:39], v[48:51], v[68:71]
    v_mfma_f32_16x16x32_bf16 v[72:75], v[40:43], v[48:51], v[72:75]
    v_mfma_f32_16x16x32_bf16 v[76:79], v[44:47], v[48:51], v[76:79]
    s_waitcnt lgkmcnt(2)
    v_mfma_f32_16x16x32_bf16 v[80:83], v[32:35], v[52:55], v[80:83]
    v_mfma_f32_16x16x32_bf16 v[84:87], v[36:39], v[52:55], v[84:87]
    v_mfma_f32_16x16x32_bf16 v[88:91], v[40:43], v[52:55], v[88:91]
    v_mfma_f32_16x16x32_bf16 v[92:95], v[44:47], v[52:55], v[92:95]
    s_waitcnt lgkmcnt(1)
    v_mfma_f32_16x16x32_bf16 v[96:99], v[32:35], v[56:59], v[96:99]
    v_mfma_f32_16x16x32_bf16 v[100:103], v[36:39], v[56:59], v[100:103]
    v_mfma_f32_16x16x32_bf16 v[104:107], v[40:43], v[56:59], v[104:107]
    v_mfma_f32_16x16x32_bf16 v[108:111], v[44:47], v[56:59], v[108:111]
    s_waitcnt lgkmcnt(0)
    v_mfma_f32_16x16x32_bf16 v[112:115], v[32:35], v[60:63], v[112:115]
    v_mfma_f32_16x16x32_bf16 v[116:119], v[36:39], v[60:63], v[116:119]
    v_mfma_f32_16x16x32_bf16 v[120:123], v[40:43], v[60:63], v[120:123]
    v_mfma_f32_16x16x32_bf16 v[124:127], v[44:47], v[60:63], v[124:127]
    s_waitcnt vmcnt(8)
    s_barrier
    s_add_u32 s27, s20, 13312
    s_add_u32 m0, s21, 16384
    s_nop 0
    buffer_load_dwordx4 v3, s[4:7], s27 offen lds
    s_add_u32 s27, s20, 33792
    s_add_u32 m0, s21, 17408
    s_nop 0
    buffer_load_dwordx4 v3, s[4:7], s27 offen lds
    s_add_u32 s27, s20, 54272
    s_add_u32 m0, s21, 18432
    s_nop 0
    buffer_load_dwordx4 v3, s[4:7], s27 offen lds
    s_add_u32 s27, s20, 74752
    s_add_u32 m0, s21, 19456
    s_nop 0
    buffer_load_dwordx4 v3, s[4:7], s27 offen lds
    ds_read_b128 v[32:35], v4 offset:32768
    ds_read_b128 v[36:39], v4 offset:33792
    ds_read_b128 v[40:43], v4 offset:34816
    ds_read_b128 v[44:47], v4 offset:35840
    ds_read_b128 v[48:51], v5 offset:32768
    ds_read_b128 v[52:55], v5 offset:33792
    ds_read_b128 v[56:59], v5 offset:34816
    ds_read_b128 v[60:63], v5 offset:35840
    s_waitcnt lgkmcnt(3)
    v_mfma_f32_16x16x32_bf16 v[64:67], v[32:35], v[48:51], v[64:67]
    v_mfma_f32_16x16x32_bf16 v[68:71], v[36:39], v[48:51], v[68:71]
    v_mfma_f32_16x16x32_bf16 v[72:75], v[40:43], v[48:51], v[72:75]
    v_mfma_f32_16x16x32_bf16 v[76:79], v[44:47], v[48:51], v[76:79]
    s_waitcnt lgkmcnt(2)
    v_mfma_f32_16x16x32_bf16 v[80:83], v[32:35], v[52:55], v[80:83]
    v_mfma_f32_16x16x32_bf16 v[84:87], v[36:39], v[52:55], v[84:87]
    v_mfma_f32_16x16x32_bf16 v[88:91], v[40:43], v[52:55], v[88:91]
    v_mfma_f32_16x16x32_bf16 v[92:95], v[44:47], v[52:55], v[92:95]
    s_waitcnt lgkmcnt(1)
    v_mfma_f32_16x16x32_bf16 v[96:99], v[32:35], v[56:59], v[96:99]
    v_mfma_f32_16x16x32_bf16 v[100:103], v[36:39], v[56:59], v[100:103]
    v_mfma_f32_16x16x32_bf16 v[104:107], v[40:43], v[56:59], v[104:107]
    v_mfma_f32_16x16x32_bf16 v[108:111], v[44:47], v[56:59], v[108:111]
    s_waitcnt lgkmcnt(0)
    v_mfma_f32_16x16x32_bf16 v[112:115], v[32:35], v[60:63], v[112:115]
    v_mfma_f32_16x16x32_bf16 v[116:119], v[36:39], v[60:63], v[116:119]
    v_mfma_f32_16x16x32_bf16 v[120:123], v[40:43], v[60:63], v[120:123]
    v_mfma_f32_16x16x32_bf16 v[124:127], v[44:47], v[60:63], v[124:127]
    s_waitcnt vmcnt(8)
    s_barrier
    s_add_u32 s27, s20, 14336
    s_add_u32 m0, s21, 32768
    s_nop 0
    buffer_load_dwordx4 v3, s[4:7], s27 offen lds
    s_add_u32 s27, s20, 34816
    s_add_u32 m0, s21, 33792
    s_nop 0
    buffer_load_dwordx4 v3, s[4:7], s27 offen lds
    s_add_u32 s27, s20, 55296
    s_add_u32 m0, s21, 34816
    s_nop 0
    buffer_load_dwordx4 v3, s[4:7], s27 offen lds
    s_add_u32 s27, s20, 75776
    s_add_u32 m0, s21, 35840
    s_nop 0
    buffer_load_dwordx4 v3, s[4:7], s27 offen lds
    ds_read_b128 v[32:35], v4 offset:49152
    ds_read_b128 v[36:39], v4 offset:50176
    ds_read_b128 v[40:43], v4 offset:51200
    ds_read_b128 v[44:47], v4 offset:52224
    ds_read_b128 v[48:51], v5 offset:49152
    ds_read_b128 v[52:55], v5 offset:50176
    ds_read_b128 v[56:59], v5 offset:51200
    ds_read_b128 v[60:63], v5 offset:52224
    s_waitcnt lgkmcnt(3)
    v_mfma_f32_16x16x32_bf16 v[64:67], v[32:35], v[48:51], v[64:67]
    v_mfma_f32_16x16x32_bf16 v[68:71], v[36:39], v[48:51], v[68:71]
    v_mfma_f32_16x16x32_bf16 v[72:75], v[40:43], v[48:51], v[72:75]
    v_mfma_f32_16x16x32_bf16 v[76:79], v[44:47], v[48:51], v[76:79]
    s_waitcnt lgkmcnt(2)
    v_mfma_f32_16x16x32_bf16 v[80:83], v[32:35], v[52:55], v[80:83]
    v_mfma_f32_16x16x32_bf16 v[84:87], v[36:39], v[52:55], v[84:87]
    v_mfma_f32_16x16x32_bf16 v[88:91], v[40:43], v[52:55], v[88:91]
    v_mfma_f32_16x16x32_bf16 v[92:95], v[44:47], v[52:55], v[92:95]
    s_waitcnt lgkmcnt(1)
    v_mfma_f32_16x16x32_bf16 v[96:99], v[32:35], v[56:59], v[96:99]
    v_mfma_f32_16x16x32_bf16 v[100:103], v[36:39], v[56:59], v[100:103]
    v_mfma_f32_16x16x32_bf16 v[104:107], v[40:43], v[56:59], v[104:107]
    v_mfma_f32_16x16x32_bf16 v[108:111], v[44:47], v[56:59], v[108:111]
    s_waitcnt lgkmcnt(0)
    v_mfma_f32_16x16x32_bf16 v[112:115], v[32:35], v[60:63], v[112:115]
    v_mfma_f32_16x16x32_bf16 v[116:119], v[36:39], v[60:63], v[116:119]
    v_mfma_f32_16x16x32_bf16 v[120:123], v[40:43], v[60:63], v[120:123]
    v_mfma_f32_16x16x32_bf16 v[124:127], v[44:47], v[60:63], v[124:127]
    s_waitcnt vmcnt(8)
    s_barrier
    s_add_u32 s27, s20, 15360
    s_add_u32 m0, s21, 49152
    s_nop 0
    buffer_load_dwordx4 v3, s[4:7], s27 offen lds
    s_add_u32 s27, s20, 35840
    s_add_u32 m0, s21, 50176
    s_nop 0
    buffer_load_dwordx4 v3, s[4:7], s27 offen lds
    s_add_u32 s27, s20, 56320
    s_add_u32 m0, s21, 51200
    s_nop 0
    buffer_load_dwordx4 v3, s[4:7], s27 offen lds
    s_add_u32 s27, s20, 76800
    s_add_u32 m0, s21, 52224
    s_nop 0
    buffer_load_dwordx4 v3, s[4:7], s27 offen lds
    ds_read_b128 v[32:35], v4 offset:0
    ds_read_b128 v[36:39], v4 offset:1024
    ds_read_b128 v[40:43], v4 offset:2048
    ds_read_b128 v[44:47], v4 offset:3072
    ds_read_b128 v[48:51], v5 offset:0
    ds_read_b128 v[52:55], v5 offset:1024
    ds_read_b128 v[56:59], v5 offset:2048
    ds_read_b128 v[60:63], v5 offset:3072
    s_waitcnt lgkmcnt(3)
    v_mfma_f32_16x16x32_bf16 v[64:67], v[32:35], v[48:51], v[64:67]
    v_mfma_f32_16x16x32_bf16 v[68:71], v[36:39], v[48:51], v[68:71]
    v_mfma_f32_16x16x32_bf16 v[72:75], v[40:43], v[48:51], v[72:75]
    v_mfma_f32_16x16x32_bf16 v[76:79], v[44:47], v[48:51], v[76:79]
    s_waitcnt lgkmcnt(2)
    v_mfma_f32_16x16x32_bf16 v[80:83], v[32:35], v[52:55], v[80:83]
    v_mfma_f32_16x16x32_bf16 v[84:87], v[36:39], v[52:55], v[84:87]
    v_mfma_f32_16x16x32_bf16 v[88:91], v[40:43], v[52:55], v[88:91]
    v_mfma_f32_16x16x32_bf16 v[92:95], v[44:47], v[52:55], v[92:95]
    s_waitcnt lgkmcnt(1)
    v_mfma_f32_16x16x32_bf16 v[96:99], v[32:35], v[56:59], v[96:99]
    v_mfma_f32_16x16x32_bf16 v[100:103], v[36:39], v[56:59], v[100:103]
    v_mfma_f32_16x16x32_bf16 v[104:107], v[40:43], v[56:59], v[104:107]
    v_mfma_f32_16x16x32_bf16 v[108:111], v[44:47], v[56:59], v[108:111]
    s_waitcnt lgkmcnt(0)
    v_mfma_f32_16x16x32_bf16 v[112:115], v[32:35], v[60:63], v[112:115]
    v_mfma_f32_16x16x32_bf16 v[116:119], v[36:39], v[60:63], v[116:119]
    v_mfma_f32_16x16x32_bf16 v[120:123], v[40:43], v[60:63], v[120:123]
    v_mfma_f32_16x16x32_bf16 v[124:127], v[44:47], v[60:63], v[124:127]
    s_waitcnt vmcnt(8)
    s_barrier
    s_add_u32 s27, s20, 16384
    s_add_u32 m0, s21, 0
    s_nop 0
    buffer_load_dwordx4 v3, s[4:7], s27 offen lds
    s_add_u32 s27, s20, 36864
    s_add_u32 m0, s21, 1024
    s_nop 0
    buffer_load_dwordx4 v3, s[4:7], s27 offen lds
    s_add_u32 s27, s20, 57344
    s_add_u32 m0, s21, 2048
    s_nop 0
    buffer_load_dwordx4 v3, s[4:7], s27 offen lds
    s_add_u32 s27, s20, 77824
    s_add_u32 m0, s21, 3072
    s_nop 0
    buffer_load_dwordx4 v3, s[4:7], s27 offen lds
    ds_read_b128 v[32:35], v4 offset:16384
    ds_read_b128 v[36:39], v4 offset:17408
    ds_read_b128 v[40:43], v4 offset:18432
    ds_read_b128 v[44:47], v4 offset:19456
    ds_read_b128 v[48:51], v5 offset:16384
    ds_read_b128 v[52:55], v5 offset:17408
    ds_read_b128 v[56:59], v5 offset:18432
    ds_read_b128 v[60:63], v5 offset:19456
    s_waitcnt lgkmcnt(3)
    v_mfma_f32_16x16x32_bf16 v[64:67], v[32:35], v[48:51], v[64:67]
    v_mfma_f32_16x16x32_bf16 v[68:71], v[36:39], v[48:51], v[68:71]
    v_mfma_f32_16x16x32_bf16 v[72:75], v[40:43], v[48:51], v[72:75]
    v_mfma_f32_16x16x32_bf16 v[76:79], v[44:47], v[48:51], v[76:79]
    s_waitcnt lgkmcnt(2)
    v_mfma_f32_16x16x32_bf16 v[80:83], v[32:35], v[52:55], v[80:83]
    v_mfma_f32_16x16x32_bf16 v[84:87], v[36:39], v[52:55], v[84:87]
    v_mfma_f32_16x16x32_bf16 v[88:91], v[40:43], v[52:55], v[88:91]
    v_mfma_f32_16x16x32_bf16 v[92:95], v[44:47], v[52:55], v[92:95]
    s_waitcnt lgkmcnt(1)
    v_mfma_f32_16x16x32_bf16 v[96:99], v[32:35], v[56:59], v[96:99]
    v_mfma_f32_16x16x32_bf16 v[100:103], v[36:39], v[56:59], v[100:103]
    v_mfma_f32_16x16x32_bf16 v[104:107], v[40:43], v[56:59], v[104:107]
    v_mfma_f32_16x16x32_bf16 v[108:111], v[44:47], v[56:59], v[108:111]
    s_waitcnt lgkmcnt(0)
    v_mfma_f32_16x16x32_bf16 v[112:115], v[32:35], v[60:63], v[112:115]
    v_mfma_f32_16x16x32_bf16 v[116:119], v[36:39], v[60:63], v[116:119]
    v_mfma_f32_16x16x32_bf16 v[120:123], v[40:43], v[60:63], v[120:123]
    v_mfma_f32_16x16x32_bf16 v[124:127], v[44:47], v[60:63], v[124:127]
    s_waitcnt vmcnt(8)
    s_barrier
    s_add_u32 s27, s20, 17408
    s_add_u32 m0, s21, 16384
    s_nop 0
    buffer_load_dwordx4 v3, s[4:7], s27 offen lds
    s_add_u32 s27, s20, 37888
    s_add_u32 m0, s21, 17408
    s_nop 0
    buffer_load_dwordx4 v3, s[4:7], s27 offen lds
    s_add_u32 s27, s20, 58368
    s_add_u32 m0, s21, 18432
    s_nop 0
    buffer_load_dwordx4 v3, s[4:7], s27 offen lds
    s_add_u32 s27, s20, 78848
    s_add_u32 m0, s21, 19456
    s_nop 0
    buffer_load_dwordx4 v3, s[4:7], s27 offen lds
    ds_read_b128 v[32:35], v4 offset:32768
    ds_read_b128 v[36:39], v4 offset:33792
    ds_read_b128 v[40:43], v4 offset:34816
    ds_read_b128 v[44:47], v4 offset:35840
    ds_read_b128 v[48:51], v5 offset:32768
    ds_read_b128 v[52:55], v5 offset:33792
    ds_read_b128 v[56:59], v5 offset:34816
    ds_read_b128 v[60:63], v5 offset:35840
    s_waitcnt lgkmcnt(3)
    v_mfma_f32_16x16x32_bf16 v[64:67], v[32:35], v[48:51], v[64:67]
    v_mfma_f32_16x16x32_bf16 v[68:71], v[36:39], v[48:51], v[68:71]
    v_mfma_f32_16x16x32_bf16 v[72:75], v[40:43], v[48:51], v[72:75]
    v_mfma_f32_16x16x32_bf16 v[76:79], v[44:47], v[48:51], v[76:79]
    s_waitcnt lgkmcnt(2)
    v_mfma_f32_16x16x32_bf16 v[80:83], v[32:35], v[52:55], v[80:83]
    v_mfma_f32_16x16x32_bf16 v[84:87], v[36:39], v[52:55], v[84:87]
    v_mfma_f32_16x16x32_bf16 v[88:91], v[40:43], v[52:55], v[88:91]
    v_mfma_f32_16x16x32_bf16 v[92:95], v[44:47], v[52:55], v[92:95]
    s_waitcnt lgkmcnt(1)
    v_mfma_f32_16x16x32_bf16 v[96:99], v[32:35], v[56:59], v[96:99]
    v_mfma_f32_16x16x32_bf16 v[100:103], v[36:39], v[56:59], v[100:103]
    v_mfma_f32_16x16x32_bf16 v[104:107], v[40:43], v[56:59], v[104:107]
    v_mfma_f32_16x16x32_bf16 v[108:111], v[44:47], v[56:59], v[108:111]
    s_waitcnt lgkmcnt(0)
    v_mfma_f32_16x16x32_bf16 v[112:115], v[32:35], v[60:63], v[112:115]
    v_mfma_f32_16x16x32_bf16 v[116:119], v[36:39], v[60:63], v[116:119]
    v_mfma_f32_16x16x32_bf16 v[120:123], v[40:43], v[60:63], v[120:123]
    v_mfma_f32_16x16x32_bf16 v[124:127], v[44:47], v[60:63], v[124:127]
    s_waitcnt vmcnt(8)
    s_barrier
    s_add_u32 s27, s20, 18432
    s_add_u32 m0, s21, 32768
    s_nop 0
    buffer_load_dwordx4 v3, s[4:7], s27 offen lds
    s_add_u32 s27, s20, 38912
    s_add_u32 m0, s21, 33792
    s_nop 0
    buffer_load_dwordx4 v3, s[4:7], s27 offen lds
    s_add_u32 s27, s20, 59392
    s_add_u32 m0, s21, 34816
    s_nop 0
    buffer_load_dwordx4 v3, s[4:7], s27 offen lds
    s_add_u32 s27, s20, 79872
    s_add_u32 m0, s21, 35840
    s_nop 0
    buffer_load_dwordx4 v3, s[4:7], s27 offen lds
    ds_read_b128 v[32:35], v4 offset:49152
    ds_read_b128 v[36:39], v4 offset:50176
    ds_read_b128 v[40:43], v4 offset:51200
    ds_read_b128 v[44:47], v4 offset:52224
    ds_read_b128 v[48:51], v5 offset:49152
    ds_read_b128 v[52:55], v5 offset:50176
    ds_read_b128 v[56:59], v5 offset:51200
    ds_read_b128 v[60:63], v5 offset:52224
    s_waitcnt lgkmcnt(3)
    v_mfma_f32_16x16x32_bf16 v[64:67], v[32:35], v[48:51], v[64:67]
    v_mfma_f32_16x16x32_bf16 v[68:71], v[36:39], v[48:51], v[68:71]
    v_mfma_f32_16x16x32_bf16 v[72:75], v[40:43], v[48:51], v[72:75]
    v_mfma_f32_16x16x32_bf16 v[76:79], v[44:47], v[48:51], v[76:79]
    s_waitcnt lgkmcnt(2)
    v_mfma_f32_16x16x32_bf16 v[80:83], v[32:35], v[52:55], v[80:83]
    v_mfma_f32_16x16x32_bf16 v[84:87], v[36:39], v[52:55], v[84:87]
    v_mfma_f32_16x16x32_bf16 v[88:91], v[40:43], v[52:55], v[88:91]
    v_mfma_f32_16x16x32_bf16 v[92:95], v[44:47], v[52:55], v[92:95]
    s_waitcnt lgkmcnt(1)
    v_mfma_f32_16x16x32_bf16 v[96:99], v[32:35], v[56:59], v[96:99]
    v_mfma_f32_16x16x32_bf16 v[100:103], v[36:39], v[56:59], v[100:103]
    v_mfma_f32_16x16x32_bf16 v[104:107], v[40:43], v[56:59], v[104:107]
    v_mfma_f32_16x16x32_bf16 v[108:111], v[44:47], v[56:59], v[108:111]
    s_waitcnt lgkmcnt(0)
    v_mfma_f32_16x16x32_bf16 v[112:115], v[32:35], v[60:63], v[112:115]
    v_mfma_f32_16x16x32_bf16 v[116:119], v[36:39], v[60:63], v[116:119]
    v_mfma_f32_16x16x32_bf16 v[120:123], v[40:43], v[60:63], v[120:123]
    v_mfma_f32_16x16x32_bf16 v[124:127], v[44:47], v[60:63], v[124:127]
    s_waitcnt vmcnt(8)
    s_barrier
    s_add_u32 s27, s20, 19456
    s_add_u32 m0, s21, 49152
    s_nop 0
    buffer_load_dwordx4 v3, s[4:7], s27 offen lds
    s_add_u32 s27, s20, 39936
    s_add_u32 m0, s21, 50176
    s_nop 0
    buffer_load_dwordx4 v3, s[4:7], s27 offen lds
    s_add_u32 s27, s20, 60416
    s_add_u32 m0, s21, 51200
    s_nop 0
    buffer_load_dwordx4 v3, s[4:7], s27 offen lds
    s_add_u32 s27, s20, 80896
    s_add_u32 m0, s21, 52224
    s_nop 0
    buffer_load_dwordx4 v3, s[4:7], s27 offen lds
    ds_read_b128 v[32:35], v4 offset:0
    ds_read_b128 v[36:39], v4 offset:1024
    ds_read_b128 v[40:43], v4 offset:2048
    ds_read_b128 v[44:47], v4 offset:3072
    ds_read_b128 v[48:51], v5 offset:0
    ds_read_b128 v[52:55], v5 offset:1024
    ds_read_b128 v[56:59], v5 offset:2048
    ds_read_b128 v[60:63], v5 offset:3072
    s_waitcnt lgkmcnt(3)
    v_mfma_f32_16x16x32_bf16 v[64:67], v[32:35], v[48:51], v[64:67]
    v_mfma_f32_16x16x32_bf16 v[68:71], v[36:39], v[48:51], v[68:71]
    v_mfma_f32_16x16x32_bf16 v[72:75], v[40:43], v[48:51], v[72:75]
    v_mfma_f32_16x16x32_bf16 v[76:79], v[44:47], v[48:51], v[76:79]
    s_waitcnt lgkmcnt(2)
    v_mfma_f32_16x16x32_bf16 v[80:83], v[32:35], v[52:55], v[80:83]
    v_mfma_f32_16x16x32_bf16 v[84:87], v[36:39], v[52:55], v[84:87]
    v_mfma_f32_16x16x32_bf16 v[88:91], v[40:43], v[52:55], v[88:91]
    v_mfma_f32_16x16x32_bf16 v[92:95], v[44:47], v[52:55], v[92:95]
    s_waitcnt lgkmcnt(1)
    v_mfma_f32_16x16x32_bf16 v[96:99], v[32:35], v[56:59], v[96:99]
    v_mfma_f32_16x16x32_bf16 v[100:103], v[36:39], v[56:59], v[100:103]
    v_mfma_f32_16x16x32_bf16 v[104:107], v[40:43], v[56:59], v[104:107]
    v_mfma_f32_16x16x32_bf16 v[108:111], v[44:47], v[56:59], v[108:111]
    s_waitcnt lgkmcnt(0)
    v_mfma_f32_16x16x32_bf16 v[112:115], v[32:35], v[60:63], v[112:115]
    v_mfma_f32_16x16x32_bf16 v[116:119], v[36:39], v[60:63], v[116:119]
    v_mfma_f32_16x16x32_bf16 v[120:123], v[40:43], v[60:63], v[120:123]
    v_mfma_f32_16x16x32_bf16 v[124:127], v[44:47], v[60:63], v[124:127]
    s_waitcnt vmcnt(8)
    s_barrier
    ds_read_b128 v[32:35], v4 offset:16384
    ds_read_b128 v[36:39], v4 offset:17408
    ds_read_b128 v[40:43], v4 offset:18432
    ds_read_b128 v[44:47], v4 offset:19456
    ds_read_b128 v[48:51], v5 offset:16384
    ds_read_b128 v[52:55], v5 offset:17408
    ds_read_b128 v[56:59], v5 offset:18432
    ds_read_b128 v[60:63], v5 offset:19456
    s_waitcnt lgkmcnt(3)
    v_mfma_f32_16x16x32_bf16 v[64:67], v[32:35], v[48:51], v[64:67]
    v_mfma_f32_16x16x32_bf16 v[68:71], v[36:39], v[48:51], v[68:71]
    v_mfma_f32_16x16x32_bf16 v[72:75], v[40:43], v[48:51], v[72:75]
    v_mfma_f32_16x16x32_bf16 v[76:79], v[44:47], v[48:51], v[76:79]
    s_waitcnt lgkmcnt(2)
    v_mfma_f32_16x16x32_bf16 v[80:83], v[32:35], v[52:55], v[80:83]
    v_mfma_f32_16x16x32_bf16 v[84:87], v[36:39], v[52:55], v[84:87]
    v_mfma_f32_16x16x32_bf16 v[88:91], v[40:43], v[52:55], v[88:91]
    v_mfma_f32_16x16x32_bf16 v[92:95], v[44:47], v[52:55], v[92:95]
    s_waitcnt lgkmcnt(1)
    v_mfma_f32_16x16x32_bf16 v[96:99], v[32:35], v[56:59], v[96:99]
    v_mfma_f32_16x16x32_bf16 v[100:103], v[36:39], v[56:59], v[100:103]
    v_mfma_f32_16x16x32_bf16 v[104:107], v[40:43], v[56:59], v[104:107]
    v_mfma_f32_16x16x32_bf16 v[108:111], v[44:47], v[56:59], v[108:111]
    s_waitcnt lgkmcnt(0)
    v_mfma_f32_16x16x32_bf16 v[112:115], v[32:35], v[60:63], v[112:115]
    v_mfma_f32_16x16x32_bf16 v[116:119], v[36:39], v[60:63], v[116:119]
    v_mfma_f32_16x16x32_bf16 v[120:123], v[40:43], v[60:63], v[120:123]
    v_mfma_f32_16x16x32_bf16 v[124:127], v[44:47], v[60:63], v[124:127]
    s_waitcnt vmcnt(4)
    s_barrier
    ds_read_b128 v[32:35], v4 offset:32768
    ds_read_b128 v[36:39], v4 offset:33792
    ds_read_b128 v[40:43], v4 offset:34816
    ds_read_b128 v[44:47], v4 offset:35840
    ds_read_b128 v[48:51], v5 offset:32768
    ds_read_b128 v[52:55], v5 offset:33792
    ds_read_b128 v[56:59], v5 offset:34816
    ds_read_b128 v[60:63], v5 offset:35840
    s_waitcnt lgkmcnt(3)
    v_mfma_f32_16x16x32_bf16 v[64:67], v[32:35], v[48:51], v[64:67]
    v_mfma_f32_16x16x32_bf16 v[68:71], v[36:39], v[48:51], v[68:71]
    v_mfma_f32_16x16x32_bf16 v[72:75], v[40:43], v[48:51], v[72:75]
    v_mfma_f32_16x16x32_bf16 v[76:79], v[44:47], v[48:51], v[76:79]
    s_waitcnt lgkmcnt(2)
    v_mfma_f32_16x16x32_bf16 v[80:83], v[32:35], v[52:55], v[80:83]
    v_mfma_f32_16x16x32_bf16 v[84:87], v[36:39], v[52:55], v[84:87]
    v_mfma_f32_16x16x32_bf16 v[88:91], v[40:43], v[52:55], v[88:91]
    v_mfma_f32_16x16x32_bf16 v[92:95], v[44:47], v[52:55], v[92:95]
    s_waitcnt lgkmcnt(1)
    v_mfma_f32_16x16x32_bf16 v[96:99], v[32:35], v[56:59], v[96:99]
    v_mfma_f32_16x16x32_bf16 v[100:103], v[36:39], v[56:59], v[100:103]
    v_mfma_f32_16x16x32_bf16 v[104:107], v[40:43], v[56:59], v[104:107]
    v_mfma_f32_16x16x32_bf16 v[108:111], v[44:47], v[56:59], v[108:111]
    s_waitcnt lgkmcnt(0)
    v_mfma_f32_16x16x32_bf16 v[112:115], v[32:35], v[60:63], v[112:115]
    v_mfma_f32_16x16x32_bf16 v[116:119], v[36:39], v[60:63], v[116:119]
    v_mfma_f32_16x16x32_bf16 v[120:123], v[40:43], v[60:63], v[120:123]
    v_mfma_f32_16x16x32_bf16 v[124:127], v[44:47], v[60:63], v[124:127]
    s_waitcnt vmcnt(0)
    s_barrier
    ds_read_b128 v[32:35], v4 offset:49152
    ds_read_b128 v[36:39], v4 offset:50176
    ds_read_b128 v[40:43], v4 offset:51200
    ds_read_b128 v[44:47], v4 offset:52224
    ds_read_b128 v[48:51], v5 offset:49152
    ds_read_b128 v[52:55], v5 offset:50176
    ds_read_b128 v[56:59], v5 offset:51200
    ds_read_b128 v[60:63], v5 offset:52224
    s_waitcnt lgkmcnt(3)
    v_mfma_f32_16x16x32_bf16 v[64:67], v[32:35], v[48:51], v[64:67]
    v_mfma_f32_16x16x32_bf16 v[68:71], v[36:39], v[48:51], v[68:71]
    v_mfma_f32_16x16x32_bf16 v[72:75], v[40:43], v[48:51], v[72:75]
    v_mfma_f32_16x16x32_bf16 v[76:79], v[44:47], v[48:51], v[76:79]
    s_waitcnt lgkmcnt(2)
    v_mfma_f32_16x16x32_bf16 v[80:83], v[32:35], v[52:55], v[80:83]
    v_mfma_f32_16x16x32_bf16 v[84:87], v[36:39], v[52:55], v[84:87]
    v_mfma_f32_16x16x32_bf16 v[88:91], v[40:43], v[52:55], v[88:91]
    v_mfma_f32_16x16x32_bf16 v[92:95], v[44:47], v[52:55], v[92:95]
    s_waitcnt lgkmcnt(1)
    v_mfma_f32_16x16x32_bf16 v[96:99], v[32:35], v[56:59], v[96:99]
    v_mfma_f32_16x16x32_bf16 v[100:103], v[36:39], v[56:59], v[100:103]
    v_mfma_f32_16x16x32_bf16 v[104:107], v[40:43], v[56:59], v[104:107]
    v_mfma_f32_16x16x32_bf16 v[108:111], v[44:47], v[56:59], v[108:111]
    s_waitcnt lgkmcnt(0)
    v_mfma_f32_16x16x32_bf16 v[112:115], v[32:35], v[60:63], v[112:115]
    v_mfma_f32_16x16x32_bf16 v[116:119], v[36:39], v[60:63], v[116:119]
    v_mfma_f32_16x16x32_bf16 v[120:123], v[40:43], v[60:63], v[120:123]
    v_mfma_f32_16x16x32_bf16 v[124:127], v[44:47], v[60:63], v[124:127]
    s_and_b32 s27, s19, 31
    s_lshl_b32 s29, s18, 2
    s_lshl_b32 s30, s24, 1
    s_add_u32 s29, s29, s30
    s_lshl_b32 s29, s29, 5
    s_add_u32 s29, s29, s27
    s_lshl_b32 s29, s29, 3
    s_lshl_b32 s30, s25, 2
    s_add_u32 s29, s29, s30
    s_lshl_b32 s29, s29, 10
    s_add_u32 s28, s29, 69206016
    v_cvt_pk_bf16_f32 v32, v64, v65
    v_cvt_pk_bf16_f32 v33, v66, v67
    v_cvt_pk_bf16_f32 v34, v68, v69
    v_cvt_pk_bf16_f32 v35, v70, v71
    s_add_u32 s29, s28, 0
    buffer_store_dwordx4 v[32:35], v3, s[4:7], s29 offen
    v_cvt_pk_bf16_f32 v36, v80, v81
    v_cvt_pk_bf16_f32 v37, v82, v83
    v_cvt_pk_bf16_f32 v38, v84, v85
    v_cvt_pk_bf16_f32 v39, v86, v87
    s_add_u32 s29, s28, 1024
    buffer_store_dwordx4 v[36:39], v3, s[4:7], s29 offen
    v_cvt_pk_bf16_f32 v40, v96, v97
    v_cvt_pk_bf16_f32 v41, v98, v99
    v_cvt_pk_bf16_f32 v42, v100, v101
    v_cvt_pk_bf16_f32 v43, v102, v103
    s_add_u32 s29, s28, 2048
    buffer_store_dwordx4 v[40:43], v3, s[4:7], s29 offen
    v_cvt_pk_bf16_f32 v44, v112, v113
    v_cvt_pk_bf16_f32 v45, v114, v115
    v_cvt_pk_bf16_f32 v46, v116, v117
    v_cvt_pk_bf16_f32 v47, v118, v119
    s_add_u32 s29, s28, 3072
    buffer_store_dwordx4 v[44:47], v3, s[4:7], s29 offen
    v_cvt_pk_bf16_f32 v32, v72, v73
    v_cvt_pk_bf16_f32 v33, v74, v75
    v_cvt_pk_bf16_f32 v34, v76, v77
    v_cvt_pk_bf16_f32 v35, v78, v79
    s_add_u32 s29, s28, 262144
    buffer_store_dwordx4 v[32:35], v3, s[4:7], s29 offen
    v_cvt_pk_bf16_f32 v36, v88, v89
    v_cvt_pk_bf16_f32 v37, v90, v91
    v_cvt_pk_bf16_f32 v38, v92, v93
    v_cvt_pk_bf16_f32 v39, v94, v95
    s_add_u32 s29, s28, 263168
    buffer_store_dwordx4 v[36:39], v3, s[4:7], s29 offen
    v_cvt_pk_bf16_f32 v40, v104, v105
    v_cvt_pk_bf16_f32 v41, v106, v107
    v_cvt_pk_bf16_f32 v42, v108, v109
    v_cvt_pk_bf16_f32 v43, v110, v111
    s_add_u32 s29, s28, 264192
    buffer_store_dwordx4 v[40:43], v3, s[4:7], s29 offen
    v_cvt_pk_bf16_f32 v44, v120, v121
    v_cvt_pk_bf16_f32 v45, v122, v123
    v_cvt_pk_bf16_f32 v46, v124, v125
    v_cvt_pk_bf16_f32 v47, v126, v127
    s_add_u32 s29, s28, 265216
    buffer_store_dwordx4 v[44:47], v3, s[4:7], s29 offen
K3_END:
    s_endpgm
.text
.globl k4_kernel
.p2align 8
.type k4_kernel,@function
k4_kernel:
    s_load_dwordx2 s[4:5], s[0:1], 112
    s_load_dwordx2 s[8:9], s[0:1], 8
    s_cmp_ge_u32 s2, 256
    s_cbranch_scc1 K4_END
    v_lshrrev_b32 v1, 6, v0
    s_nop 0
    v_readfirstlane_b32 s3, v1
    v_and_b32 v2, 63, v0
    s_mov_b32 s6, 268435456
    s_mov_b32 s7, 0x00020000
    s_mov_b32 s10, 10240
    s_mov_b32 s11, 0x00020000
    s_lshr_b32 s16, s2, 6
    s_lshl_b32 s16, s16, 3
    s_and_b32 s17, s2, 7
    s_add_u32 s16, s16, s17
    s_lshr_b32 s17, s2, 3
    s_and_b32 s17, s17, 7
    v_lshlrev_b32 v1, 4, v2
    v_add_u32 v12, 0, v0
    v_lshlrev_b32 v3, 6, v12
    s_mov_b32 s18, 43691
    v_mul_lo_u32 v13, v12, s18
    v_lshrrev_b32 v13, 21, v13
    v_mul_u32_u24 v14, 48, v13
    v_sub_u32 v14, v12, v14
    v_mul_lo_u32 v15, v14, s18
    v_lshrrev_b32 v15, 18, v15
    v_mul_u32_u24 v16, 6, v15
    v_sub_u32 v16, v14, v16
    v_mul_u32_u24 v15, 1296, v15
    v_mul_u32_u24 v13, 160, v13
    v_mul_u32_u24 v16, 28, v16
    v_add3_u32 v6, v15, v13, v16
    v_cmp_eq_u32 vcc, 140, v16
    s_mov_b64 s[48:49], vcc
    v_add_u32 v12, 256, v0
    v_lshlrev_b32 v4, 6, v12
    s_mov_b32 s18, 43691
    v_mul_lo_u32 v13, v12, s18
    v_lshrrev_b32 v13, 21, v13
    v_mul_u32_u24 v14, 48, v13
    v_sub_u32 v14, v12, v14
    v_mul_lo_u32 v15, v14, s18
    v_lshrrev_b32 v15, 18, v15
    v_mul_u32_u24 v16, 6, v15
    v_sub_u32 v16, v14, v16
    v_mul_u32_u24 v15, 1296, v15
    v_mul_u32_u24 v13, 160, v13
    v_mul_u32_u24 v16, 28, v16
    v_add3_u32 v7, v15, v13, v16
    v_cmp_eq_u32 vcc, 140, v16
    s_mov_b64 s[50:51], vcc
    v_cmp_gt_u32 vcc, 128, v0
    s_mov_b64 s[52:53], vcc
    v_mov_b32 v12, 0x7ffffff0
    v_cndmask_b32 v4, v12, v4, vcc
    v_add_u32 v12, 0, v0
    s_mov_b32 s18, 52429
    v_mul_lo_u32 v13, v12, s18
    v_lshrrev_b32 v13, 22, v13
    v_mul_u32_u24 v14, 80, v13
    v_sub_u32 v14, v12, v14
    v_mul_u32_u24 v13, 1296, v13
    v_lshl_add_u32 v24, v14, 4, v13
    v_lshlrev_b32 v104, 4, v12
    v_add_u32 v12, 256, v0
    s_mov_b32 s18, 52429
    v_mul_lo_u32 v13, v12, s18
    v_lshrrev_b32 v13, 22, v13
    v_mul_u32_u24 v14, 80, v13
    v_sub_u32 v14, v12, v14
    v_mul_u32_u24 v13, 1296, v13
    v_lshl_add_u32 v25, v14, 4, v13
    v_lshlrev_b32 v105, 4, v12
    v_add_u32 v12, 512, v0
    s_mov_b32 s18, 52429
    v_mul_lo_u32 v13, v12, s18
    v_lshrrev_b32 v13, 22, v13
    v_mul_u32_u24 v14, 80, v13
    v_sub_u32 v14, v12, v14
    v_mul_u32_u24 v13, 1296, v13
    v_lshl_add_u32 v26, v14, 4, v13
    v_lshlrev_b32 v106, 4, v12
    v_cmp_gt_u32 vcc, 128, v0
    v_mov_b32 v12, 0x7ffffff0
    s_nop 0
    v_cndmask_b32 v106, v12, v106, vcc
    v_mov_b32 v12, 32768
    v_lshl_add_u32 v12, v0, 4, v12
    v_cndmask_b32 v26, v12, v26, vcc
    v_and_b32 v12, 7, v2
    v_mul_u32_u24 v12, 1296, v12
    v_lshrrev_b32 v13, 4, v2
    v_lshl_add_u32 v5, v13, 4, v12
    s_waitcnt lgkmcnt(0)
    s_lshl_b32 s20, s16, 3
    s_lshl_b32 s21, s3, 1
    s_add_u32 s20, s20, s21
    s_mul_i32 s20, s20, 20480
    s_add_u32 s20, s20, 6291456
    s_add_u32 s21, s20, 0
    buffer_load_dwordx4 a[0:3], v1, s[4:7], s21 offen
    s_add_u32 s21, s20, 1024
    buffer_load_dwordx4 a[4:7], v1, s[4:7], s21 offen
    s_add_u32 s21, s20, 2048
    buffer_load_dwordx4 a[8:11], v1, s[4:7], s21 offen
    s_add_u32 s21, s20, 3072
    buffer_load_dwordx4 a[12:15], v1, s[4:7], s21 offen
    s_add_u32 s21, s20, 4096
    buffer_load_dwordx4 a[16:19], v1, s[4:7], s21 offen
    s_add_u32 s21, s20, 5120
    buffer_load_dwordx4 a[20:23], v1, s[4:7], s21 offen
    s_add_u32 s21, s20, 6144
    buffer_load_dwordx4 a[24:27], v1, s[4:7], s21 offen
    s_add_u32 s21, s20, 7168
    buffer_load_dwordx4 a[28:31], v1, s[4:7], s21 offen
    s_add_u32 s21, s20, 8192
    buffer_load_dwordx4 a[32:35], v1, s[4:7], s21 offen
    s_add_u32 s21, s20, 9216
    buffer_load_dwordx4 a[36:39], v1, s[4:7], s21 offen
    s_add_u32 s21, s20, 10240
    buffer_load_dwordx4 a[40:43], v1, s[4:7], s21 offen
    s_add_u32 s21, s20, 11264
    buffer_load_dwordx4 a[44:47], v1, s[4:7], s21 offen
    s_add_u32 s21, s20, 12288
    buffer_load_dwordx4 a[48:51], v1, s[4:7], s21 offen
    s_add_u32 s21, s20, 13312
    buffer_load_dwordx4 a[52:55], v1, s[4:7], s21 offen
    s_add_u32 s21, s20, 14336
    buffer_load_dwordx4 a[56:59], v1, s[4:7], s21 offen
    s_add_u32 s21, s20, 15360
    buffer_load_dwordx4 a[60:63], v1, s[4:7], s21 offen
    s_add_u32 s21, s20, 16384
    buffer_load_dwordx4 a[64:67], v1, s[4:7], s21 offen
    s_add_u32 s21, s20, 17408
    buffer_load_dwordx4 a[68:71], v1, s[4:7], s21 offen
    s_add_u32 s21, s20, 18432
    buffer_load_dwordx4 a[72:75], v1, s[4:7], s21 offen
    s_add_u32 s21, s20, 19456
    buffer_load_dwordx4 a[76:79], v1, s[4:7], s21 offen
    s_add_u32 s21, s20, 20480
    buffer_load_dwordx4 a[80:83], v1, s[4:7], s21 offen
    s_add_u32 s21, s20, 21504
    buffer_load_dwordx4 a[84:87], v1, s[4:7], s21 offen
    s_add_u32 s21, s20, 22528
    buffer_load_dwordx4 a[88:91], v1, s[4:7], s21 offen
    s_add_u32 s21, s20, 23552
    buffer_load_dwordx4 a[92:95], v1, s[4:7], s21 offen
    s_add_u32 s21, s20, 24576
    buffer_load_dwordx4 a[96:99], v1, s[4:7], s21 offen
    s_add_u32 s21, s20, 25600
    buffer_load_dwordx4 a[100:103], v1, s[4:7], s21 offen
    s_add_u32 s21, s20, 26624
    buffer_load_dwordx4 a[104:107], v1, s[4:7], s21 offen
    s_add_u32 s21, s20, 27648
    buffer_load_dwordx4 a[108:111], v1, s[4:7], s21 offen
    s_add_u32 s21, s20, 28672
    buffer_load_dwordx4 a[112:115], v1, s[4:7], s21 offen
    s_add_u32 s21, s20, 29696
    buffer_load_dwordx4 a[116:119], v1, s[4:7], s21 offen
    s_add_u32 s21, s20, 30720
    buffer_load_dwordx4 a[120:123], v1, s[4:7], s21 offen
    s_add_u32 s21, s20, 31744
    buffer_load_dwordx4 a[124:127], v1, s[4:7], s21 offen
    s_add_u32 s21, s20, 32768
    buffer_load_dwordx4 a[128:131], v1, s[4:7], s21 offen
    s_add_u32 s21, s20, 33792
    buffer_load_dwordx4 a[132:135], v1, s[4:7], s21 offen
    s_add_u32 s21, s20, 34816
    buffer_load_dwordx4 a[136:139], v1, s[4:7], s21 offen
    s_add_u32 s21, s20, 35840
    buffer_load_dwordx4 a[140:143], v1, s[4:7], s21 offen
    s_add_u32 s21, s20, 36864
    buffer_load_dwordx4 a[144:147], v1, s[4:7], s21 offen
    s_add_u32 s21, s20, 37888
    buffer_load_dwordx4 a[148:151], v1, s[4:7], s21 offen
    s_add_u32 s21, s20, 38912
    buffer_load_dwordx4 a[152:155], v1, s[4:7], s21 offen
    s_add_u32 s21, s20, 39936
    buffer_load_dwordx4 a[156:159], v1, s[4:7], s21 offen
    s_add_u32 s21, s20, 5242880
    buffer_load_dwordx4 a[160:163], v1, s[4:7], s21 offen
    s_add_u32 s21, s20, 5243904
    buffer_load_dwordx4 a[164:167], v1, s[4:7], s21 offen
    s_add_u32 s21, s20, 5244928
    buffer_load_dwordx4 a[168:171], v1, s[4:7], s21 offen
    s_add_u32 s21, s20, 5245952
    buffer_load_dwordx4 a[172:175], v1, s[4:7], s21 offen
    s_add_u32 s21, s20, 5246976
    buffer_load_dwordx4 a[176:179], v1, s[4:7], s21 offen
    s_add_u32 s21, s20, 5248000
    buffer_load_dwordx4 a[180:183], v1, s[4:7], s21 offen
    s_add_u32 s21, s20, 5249024
    buffer_load_dwordx4 a[184:187], v1, s[4:7], s21 offen
    s_add_u32 s21, s20, 5250048
    buffer_load_dwordx4 a[188:191], v1, s[4:7], s21 offen
    s_add_u32 s21, s20, 5251072
    buffer_load_dwordx4 a[192:195], v1, s[4:7], s21 offen
    s_add_u32 s21, s20, 5252096
    buffer_load_dwordx4 a[196:199], v1, s[4:7], s21 offen
    s_add_u32 s21, s20, 5253120
    buffer_load_dwordx4 a[200:203], v1, s[4:7], s21 offen
    s_add_u32 s21, s20, 5254144
    buffer_load_dwordx4 a[204:207], v1, s[4:7], s21 offen
    s_add_u32 s21, s20, 5255168
    buffer_load_dwordx4 a[208:211], v1, s[4:7], s21 offen
    s_add_u32 s21, s20, 5256192
    buffer_load_dwordx4 a[212:215], v1, s[4:7], s21 offen
    s_add_u32 s21, s20, 5257216
    buffer_load_dwordx4 a[216:219], v1, s[4:7], s21 offen
    s_add_u32 s21, s20, 5258240
    buffer_load_dwordx4 a[220:223], v1, s[4:7], s21 offen
    s_add_u32 s21, s20, 5259264
    buffer_load_dwordx4 a[224:227], v1, s[4:7], s21 offen
    s_add_u32 s21, s20, 5260288
    buffer_load_dwordx4 a[228:231], v1, s[4:7], s21 offen
    s_add_u32 s21, s20, 5261312
    buffer_load_dwordx4 a[232:235], v1, s[4:7], s21 offen
    s_add_u32 s21, s20, 5262336
    buffer_load_dwordx4 a[236:239], v1, s[4:7], s21 offen
    s_add_u32 s21, s20, 5263360
    buffer_load_dwordx4 a[240:243], v1, s[4:7], s21 offen
    s_add_u32 s21, s20, 5264384
    buffer_load_dwordx4 a[244:247], v1, s[4:7], s21 offen
    s_add_u32 s21, s20, 5265408
    buffer_load_dwordx4 a[248:251], v1, s[4:7], s21 offen
    s_add_u32 s21, s20, 5266432
    buffer_load_dwordx4 a[252:255], v1, s[4:7], s21 offen
    s_add_u32 s21, s20, 5267456
    buffer_load_dwordx4 v[192:195], v1, s[4:7], s21 offen
    s_add_u32 s21, s20, 5268480
    buffer_load_dwordx4 v[196:199], v1, s[4:7], s21 offen
    s_add_u32 s21, s20, 5269504
    buffer_load_dwordx4 v[200:203], v1, s[4:7], s21 offen
    s_add_u32 s21, s20, 5270528
    buffer_load_dwordx4 v[204:207], v1, s[4:7], s21 offen
    s_add_u32 s21, s20, 5271552
    buffer_load_dwordx4 v[208:211], v1, s[4:7], s21 offen
    s_add_u32 s21, s20, 5272576
    buffer_load_dwordx4 v[212:215], v1, s[4:7], s21 offen
    s_add_u32 s21, s20, 5273600
    buffer_load_dwordx4 v[216:219], v1, s[4:7], s21 offen
    s_add_u32 s21, s20, 5274624
    buffer_load_dwordx4 v[220:223], v1, s[4:7], s21 offen
    s_add_u32 s21, s20, 5275648
    buffer_load_dwordx4 v[224:227], v1, s[4:7], s21 offen
    s_add_u32 s21, s20, 5276672
    buffer_load_dwordx4 v[228:231], v1, s[4:7], s21 offen
    s_add_u32 s21, s20, 5277696
    buffer_load_dwordx4 v[232:235], v1, s[4:7], s21 offen
    s_add_u32 s21, s20, 5278720
    buffer_load_dwordx4 v[236:239], v1, s[4:7], s21 offen
    s_add_u32 s21, s20, 5279744
    buffer_load_dwordx4 v[240:243], v1, s[4:7], s21 offen
    s_add_u32 s21, s20, 5280768
    buffer_load_dwordx4 v[244:247], v1, s[4:7], s21 offen
    s_add_u32 s21, s20, 5281792
    buffer_load_dwordx4 v[248:251], v1, s[4:7], s21 offen
    s_add_u32 s21, s20, 5282816
    buffer_load_dwordx4 v[252:255], v1, s[4:7], s21 offen
    s_add_u32 s21, s20, 10485760
    buffer_load_dwordx4 v[112:115], v1, s[4:7], s21 offen
    s_add_u32 s21, s20, 10486784
    buffer_load_dwordx4 v[116:119], v1, s[4:7], s21 offen
    s_add_u32 s21, s20, 10487808
    buffer_load_dwordx4 v[120:123], v1, s[4:7], s21 offen
    s_add_u32 s21, s20, 10488832
    buffer_load_dwordx4 v[124:127], v1, s[4:7], s21 offen
    s_add_u32 s21, s20, 10489856
    buffer_load_dwordx4 v[128:131], v1, s[4:7], s21 offen
    s_add_u32 s21, s20, 10490880
    buffer_load_dwordx4 v[132:135], v1, s[4:7], s21 offen
    s_add_u32 s21, s20, 10491904
    buffer_load_dwordx4 v[136:139], v1, s[4:7], s21 offen
    s_add_u32 s21, s20, 10492928
    buffer_load_dwordx4 v[140:143], v1, s[4:7], s21 offen
    s_add_u32 s21, s20, 10493952
    buffer_load_dwordx4 v[144:147], v1, s[4:7], s21 offen
    s_add_u32 s21, s20, 10494976
    buffer_load_dwordx4 v[148:151], v1, s[4:7], s21 offen
    s_add_u32 s21, s20, 10496000
    buffer_load_dwordx4 v[152:155], v1, s[4:7], s21 offen
    s_add_u32 s21, s20, 10497024
    buffer_load_dwordx4 v[156:159], v1, s[4:7], s21 offen
    s_add_u32 s21, s20, 10498048
    buffer_load_dwordx4 v[160:163], v1, s[4:7], s21 offen
    s_add_u32 s21, s20, 10499072
    buffer_load_dwordx4 v[164:167], v1, s[4:7], s21 offen
    s_add_u32 s21, s20, 10500096
    buffer_load_dwordx4 v[168:171], v1, s[4:7], s21 offen
    s_add_u32 s21, s20, 10501120
    buffer_load_dwordx4 v[172:175], v1, s[4:7], s21 offen
    s_add_u32 s21, s20, 10502144
    buffer_load_dwordx4 v[176:179], v1, s[4:7], s21 offen
    s_add_u32 s21, s20, 10503168
    buffer_load_dwordx4 v[180:183], v1, s[4:7], s21 offen
    s_add_u32 s21, s20, 10504192
    buffer_load_dwordx4 v[184:187], v1, s[4:7], s21 offen
    s_add_u32 s21, s20, 10505216
    buffer_load_dwordx4 v[188:191], v1, s[4:7], s21 offen
    s_mul_i32 s22, s3, 20480
    s_add_u32 s21, s20, 10506240
    s_add_u32 m0, s22, 73728
    s_nop 0
    buffer_load_dwordx4 v1, s[4:7], s21 offen lds
    s_add_u32 s21, s20, 10507264
    s_add_u32 m0, s22, 74752
    s_nop 0
    buffer_load_dwordx4 v1, s[4:7], s21 offen lds
    s_add_u32 s21, s20, 10508288
    s_add_u32 m0, s22, 75776
    s_nop 0
    buffer_load_dwordx4 v1, s[4:7], s21 offen lds
    s_add_u32 s21, s20, 10509312
    s_add_u32 m0, s22, 76800
    s_nop 0
    buffer_load_dwordx4 v1, s[4:7], s21 offen lds
    s_add_u32 s21, s20, 10510336
    s_add_u32 m0, s22, 77824
    s_nop 0
    buffer_load_dwordx4 v1, s[4:7], s21 offen lds
    s_add_u32 s21, s20, 10511360
    s_add_u32 m0, s22, 78848
    s_nop 0
    buffer_load_dwordx4 v1, s[4:7], s21 offen lds
    s_add_u32 s21, s20, 10512384
    s_add_u32 m0, s22, 79872
    s_nop 0
    buffer_load_dwordx4 v1, s[4:7], s21 offen lds
    s_add_u32 s21, s20, 10513408
    s_add_u32 m0, s22, 80896
    s_nop 0
    buffer_load_dwordx4 v1, s[4:7], s21 offen lds
    s_add_u32 s21, s20, 10514432
    s_add_u32 m0, s22, 81920
    s_nop 0
    buffer_load_dwordx4 v1, s[4:7], s21 offen lds
    s_add_u32 s21, s20, 10515456
    s_add_u32 m0, s22, 82944
    s_nop 0
    buffer_load_dwordx4 v1, s[4:7], s21 offen lds
    s_add_u32 s21, s20, 10516480
    s_add_u32 m0, s22, 83968
    s_nop 0
    buffer_load_dwordx4 v1, s[4:7], s21 offen lds
    s_add_u32 s21, s20, 10517504
    s_add_u32 m0, s22, 84992
    s_nop 0
    buffer_load_dwordx4 v1, s[4:7], s21 offen lds
    s_add_u32 s21, s20, 10518528
    s_add_u32 m0, s22, 86016
    s_nop 0
    buffer_load_dwordx4 v1, s[4:7], s21 offen lds
    s_add_u32 s21, s20, 10519552
    s_add_u32 m0, s22, 87040
    s_nop 0
    buffer_load_dwordx4 v1, s[4:7], s21 offen lds
    s_add_u32 s21, s20, 10520576
    s_add_u32 m0, s22, 88064
    s_nop 0
    buffer_load_dwordx4 v1, s[4:7], s21 offen lds
    s_add_u32 s21, s20, 10521600
    s_add_u32 m0, s22, 89088
    s_nop 0
    buffer_load_dwordx4 v1, s[4:7], s21 offen lds
    s_add_u32 s21, s20, 10522624
    s_add_u32 m0, s22, 90112
    s_nop 0
    buffer_load_dwordx4 v1, s[4:7], s21 offen lds
    s_add_u32 s21, s20, 10523648
    s_add_u32 m0, s22, 91136
    s_nop 0
    buffer_load_dwordx4 v1, s[4:7], s21 offen lds
    s_add_u32 s21, s20, 10524672
    s_add_u32 m0, s22, 92160
    s_nop 0
    buffer_load_dwordx4 v1, s[4:7], s21 offen lds
    s_add_u32 s21, s20, 10525696
    s_add_u32 m0, s22, 93184
    s_nop 0
    buffer_load_dwordx4 v1, s[4:7], s21 offen lds
    s_mul_i32 s23, s17, 5
    s_lshl_b32 s23, s23, 7
    s_lshl_b32 s24, s16, 2
    s_add_u32 s23, s23, s24
    s_add_u32 s23, s23, s3
    s_lshl_b32 s23, s23, 10
    s_add_u32 s23, s23, 22020096
    s_mul_i32 s22, s3, 5120
    s_add_u32 s21, s23, 0
    s_add_u32 m0, s22, 53248
    s_nop 0
    buffer_load_dwordx4 v1, s[4:7], s21 offen lds
    s_add_u32 s21, s23, 131072
    s_add_u32 m0, s22, 54272
    s_nop 0
    buffer_load_dwordx4 v1, s[4:7], s21 offen lds
    s_add_u32 s21, s23, 262144
    s_add_u32 m0, s22, 55296
    s_nop 0
    buffer_load_dwordx4 v1, s[4:7], s21 offen lds
    s_add_u32 s21, s23, 393216
    s_add_u32 m0, s22, 56320
    s_nop 0
    buffer_load_dwordx4 v1, s[4:7], s21 offen lds
    s_add_u32 s21, s23, 524288
    s_add_u32 m0, s22, 57344
    s_nop 0
    buffer_load_dwordx4 v1, s[4:7], s21 offen lds
    s_mul_i32 s22, s3, 20480
    s_add_u32 s22, s22, 73728
    v_add_u32 v9, s22, v1
    s_mul_i32 s22, s3, 5120
    s_add_u32 s22, s22, 53248
    v_add_u32 v10, s22, v1
    s_lshl_b32 s25, s16, 2
    s_add_u32 s25, s25, s3
    s_lshl_b32 s25, s25, 10
    s_add_u32 s25, s25, 52428800
    s_lshl_b32 s26, s16, 3
    s_lshl_b32 s21, s3, 1
    s_add_u32 s26, s26, s21
    s_lshl_b32 s26, s26, 10
    s_add_u32 s26, s26, 69206016
    buffer_load_dwordx4 v[64:67], v1, s[4:7], s25 offen
    s_add_u32 s21, s25, 131072
    buffer_load_dwordx4 v[68:71], v1, s[4:7], s21 offen
    buffer_load_dwordx4 v[72:75], v1, s[4:7], s26 offen
    buffer_load_dwordx4 v[76:79], v1, s[4:7], s26 offen offset:1024
    s_add_u32 s25, s25, 262144
    s_add_u32 s26, s26, 262144
    s_lshl_b32 s27, s16, 2
    s_add_u32 s27, s27, s3
    s_lshl_b32 s27, s27, 10
    s_add_u32 s27, s27, 102760448
    s_lshl_b32 s28, s16, 3
    s_lshl_b32 s21, s3, 1
    s_add_u32 s28, s28, s21
    s_lshl_b32 s28, s28, 9
    s_add_u32 s28, s28, 111149056
    v_lshlrev_b32 v11, 3, v2
    s_mul_i32 s29, s17, 3072
    s_lshl_b32 s21, s3, 8
    s_add_u32 s29, s29, s21
    s_add_u32 s29, s29, 119537664
    v_lshlrev_b32 v108, 2, v2
    s_mov_b32 s34, 119537664
    s_lshl_b32 s21, s3, 2
    s_add_u32 s21, s21, 0
    v_lshrrev_b32 v12, 4, v2
    v_add_u32 v12, s21, v12
    s_mov_b32 s18, 43691
    v_mul_lo_u32 v13, v12, s18
    v_lshrrev_b32 v13, 18, v13
    v_mul_u32_u24 v14, 6, v13
    v_sub_u32 v14, v12, v14
    v_mul_u32_u24 v14, 14, v14
    v_and_b32 v15, 15, v2
    v_add_u32 v14, v14, v15
    v_subrev_u32 v14, 1, v14
    v_cmp_gt_u32 vcc, 80, v14
    s_mov_b64 s[54:55], vcc
    v_min_u32 v14, 79, v14
    v_lshrrev_b32 v15, 4, v14
    v_lshlrev_b32 v15, 10, v15
    v_and_b32 v16, 15, v14
    v_lshl_add_u32 v15, v16, 4, v15
    v_lshrrev_b32 v16, 2, v13
    v_lshl_add_u32 v15, v16, 8, v15
    v_and_b32 v16, 3, v13
    v_lshl_add_u32 v15, v16, 2, v15
    v_add_u32 v8, 32768, v15
    s_lshl_b32 s21, s3, 2
    s_add_u32 s21, s21, 16
    v_lshrrev_b32 v12, 4, v2
    v_add_u32 v12, s21, v12
    s_mov_b32 s18, 43691
    v_mul_lo_u32 v13, v12, s18
    v_lshrrev_b32 v13, 18, v13
    v_mul_u32_u24 v14, 6, v13
    v_sub_u32 v14, v12, v14
    v_mul_u32_u24 v14, 14, v14
    v_and_b32 v15, 15, v2
    v_add_u32 v14, v14, v15
    v_subrev_u32 v14, 1, v14
    v_cmp_gt_u32 vcc, 80, v14
    s_mov_b64 s[56:57], vcc
    v_min_u32 v14, 79, v14
    v_lshrrev_b32 v15, 4, v14
    v_lshlrev_b32 v15, 10, v15
    v_and_b32 v16, 15, v14
    v_lshl_add_u32 v15, v16, 4, v15
    v_lshrrev_b32 v16, 2, v13
    v_lshl_add_u32 v15, v16, 8, v15
    v_and_b32 v16, 3, v13
    v_lshl_add_u32 v15, v16, 2, v15
    v_add_u32 v109, 32768, v15
    s_lshl_b32 s21, s3, 2
    s_add_u32 s21, s21, 32
    v_lshrrev_b32 v12, 4, v2
    v_add_u32 v12, s21, v12
    s_mov_b32 s18, 43691
    v_mul_lo_u32 v13, v12, s18
    v_lshrrev_b32 v13, 18, v13
    v_mul_u32_u24 v14, 6, v13
    v_sub_u32 v14, v12, v14
    v_mul_u32_u24 v14, 14, v14
    v_and_b32 v15, 15, v2
    v_add_u32 v14, v14, v15
    v_subrev_u32 v14, 1, v14
    v_cmp_gt_u32 vcc, 80, v14
    s_mov_b64 s[58:59], vcc
    v_min_u32 v14, 79, v14
    v_lshrrev_b32 v15, 4, v14
    v_lshlrev_b32 v15, 10, v15
    v_and_b32 v16, 15, v14
    v_lshl_add_u32 v15, v16, 4, v15
    v_lshrrev_b32 v16, 2, v13
    v_lshl_add_u32 v15, v16, 8, v15
    v_and_b32 v16, 3, v13
    v_lshl_add_u32 v15, v16, 2, v15
    v_add_u32 v0, 32768, v15
    s_mov_b32 s60, 0x80018001
    s_mov_b32 s61, 0x80018001
    s_mov_b32 s35, 0
    s_lshl_b32 s47, s2, 2
    s_add_u32 s47, s47, s3
    s_lshl_b32 s47, s47, 12
    s_add_u32 s47, s47, 167772160
    v_mov_b32 v111, 0
    s_mov_b32 s36, 0
    s_mov_b32 s38, 0
    s_mov_b32 s39, -1
    s_mov_b32 s40, 0x3db50000
    s_mov_b32 s41, 0x3fb8aa3b
    buffer_load_dwordx4 v[12:15], v104, s[8:11], 0 offen
    buffer_load_dwordx4 v[16:19], v105, s[8:11], 0 offen
    buffer_load_dwordx4 v[20:23], v106, s[8:11], 0 offen
    s_waitcnt vmcnt(0)
    ds_write_b128 v24, v[12:15]
    ds_write_b128 v25, v[16:19]
    ds_write_b128 v26, v[20:23]
    s_branch K4_GOTW
K4_STEP:
    s_mov_b32 s37, 0
    s_sleep 26
K4_POLL:
    buffer_load_dwordx4 v[12:15], v3, s[4:7], s34 offen offset:0 sc1
    buffer_load_dwordx4 v[16:19], v3, s[4:7], s34 offen offset:16 sc1
    buffer_load_dwordx4 v[20:23], v3, s[4:7], s34 offen offset:32 sc1
    buffer_load_dwordx4 v[24:27], v3, s[4:7], s34 offen offset:48 sc1
    buffer_load_dwordx4 v[28:31], v4, s[4:7], s34 offen offset:0 sc1
    buffer_load_dwordx4 v[32:35], v4, s[4:7], s34 offen offset:16 sc1
    buffer_load_dwordx4 v[36:39], v4, s[4:7], s34 offen offset:32 sc1
    buffer_load_dwordx4 v[40:43], v4, s[4:7], s34 offen offset:48 sc1
    s_waitcnt vmcnt(0)
    s_mov_b32 s21, 0x42000000
    v_cmp_neq_f32 vcc, s21, v12
    v_cmp_neq_f32 s[22:23], s21, v27
    s_or_b64 vcc, vcc, s[22:23]
    v_cmp_neq_f32 s[22:23], s21, v28
    s_and_b64 s[22:23], s[22:23], s[52:53]
    s_or_b64 vcc, vcc, s[22:23]
    v_cmp_neq_f32 s[22:23], s21, v43
    s_and_b64 s[22:23], s[22:23], s[52:53]
    s_or_b64 vcc, vcc, s[22:23]
    s_cbranch_vccz K4_RDY
    s_add_u32 s37, s37, 1
    s_cmp_lg_u32 s36, 0
    s_cbranch_scc1 K4_RDY
    s_sleep 4
    s_cmp_lt_u32 s37, 65536
    s_cbranch_scc1 K4_POLL
    s_mov_b32 s36, 1
K4_RDY:
    s_add_u32 s34, s34, 24576
    v_cvt_pk_bf16_f32 v13, v13, v14
    v_cvt_pk_bf16_f32 v15, v15, v16
    v_cvt_pk_bf16_f32 v17, v17, v18
    v_cvt_pk_bf16_f32 v19, v19, v20
    v_cvt_pk_bf16_f32 v21, v21, v22
    v_cvt_pk_bf16_f32 v23, v23, v24
    v_cvt_pk_bf16_f32 v25, v25, v26
    ds_write_b32 v6, v13 offset:0
    ds_write_b32 v6, v15 offset:4
    ds_write_b32 v6, v17 offset:8
    ds_write_b32 v6, v19 offset:12
    ds_write_b32 v6, v21 offset:16
    s_andn2_b64 exec, exec, s[48:49]
    ds_write_b32 v6, v23 offset:20
    ds_write_b32 v6, v25 offset:24
    s_mov_b64 exec, -1
    s_mov_b64 exec, s[52:53]
    v_cvt_pk_bf16_f32 v29, v29, v30
    v_cvt_pk_bf16_f32 v31, v31, v32
    v_cvt_pk_bf16_f32 v33, v33, v34
    v_cvt_pk_bf16_f32 v35, v35, v36
    v_cvt_pk_bf16_f32 v37, v37, v38
    v_cvt_pk_bf16_f32 v39, v39, v40
    v_cvt_pk_bf16_f32 v41, v41, v42
    ds_write_b32 v7, v29 offset:0
    ds_write_b32 v7, v31 offset:4
    ds_write_b32 v7, v33 offset:8
    ds_write_b32 v7, v35 offset:12
    ds_write_b32 v7, v37 offset:16
    s_andn2_b64 exec, exec, s[50:51]
    ds_write_b32 v7, v39 offset:20
    ds_write_b32 v7, v41 offset:24
    s_mov_b64 exec, -1
K4_GOTW:
    s_waitcnt vmcnt(0) lgkmcnt(0)
    s_barrier
    ds_read_b128 v[12:15], v5 offset:0
    ds_read_b128 v[16:19], v5 offset:64
    s_waitcnt lgkmcnt(1)
    v_mfma_f32_16x16x32_bf16 v[40:43], a[0:3], v[12:15], 0
    v_mfma_f32_16x16x32_bf16 v[48:51], a[160:163], v[12:15], 0
    v_mfma_f32_16x16x32_bf16 v[44:47], a[80:83], v[12:15], 0
    v_mfma_f32_16x16x32_bf16 v[52:55], a[240:243], v[12:15], 0
    ds_read_b128 v[12:15], v5 offset:128
    s_waitcnt lgkmcnt(1)
    v_mfma_f32_16x16x32_bf16 v[40:43], a[4:7], v[16:19], v[40:43]
    v_mfma_f32_16x16x32_bf16 v[48:51], a[164:167], v[16:19], v[48:51]
    v_mfma_f32_16x16x32_bf16 v[44:47], a[84:87], v[16:19], v[44:47]
    v_mfma_f32_16x16x32_bf16 v[52:55], a[244:247], v[16:19], v[52:55]
    ds_read_b128 v[16:19], v5 offset:192
    s_waitcnt lgkmcnt(1)
    v_mfma_f32_16x16x32_bf16 v[40:43], a[8:11], v[12:15], v[40:43]
    v_mfma_f32_16x16x32_bf16 v[48:51], a[168:171], v[12:15], v[48:51]
    v_mfma_f32_16x16x32_bf16 v[44:47], a[88:91], v[12:15], v[44:47]
    v_mfma_f32_16x16x32_bf16 v[52:55], a[248:251], v[12:15], v[52:55]
    ds_read_b128 v[12:15], v5 offset:256
    s_waitcnt lgkmcnt(1)
    v_mfma_f32_16x16x32_bf16 v[40:43], a[12:15], v[16:19], v[40:43]
    v_mfma_f32_16x16x32_bf16 v[48:51], a[172:175], v[16:19], v[48:51]
    v_mfma_f32_16x16x32_bf16 v[44:47], a[92:95], v[16:19], v[44:47]
    v_mfma_f32_16x16x32_bf16 v[52:55], a[252:255], v[16:19], v[52:55]
    ds_read_b128 v[16:19], v5 offset:320
    s_waitcnt lgkmcnt(1)
    v_mfma_f32_16x16x32_bf16 v[40:43], a[16:19], v[12:15], v[40:43]
    v_mfma_f32_16x16x32_bf16 v[48:51], a[176:179], v[12:15], v[48:51]
    v_mfma_f32_16x16x32_bf16 v[44:47], a[96:99], v[12:15], v[44:47]
    v_mfma_f32_16x16x32_bf16 v[52:55], v[192:195], v[12:15], v[52:55]
    ds_read_b128 v[12:15], v5 offset:384
    s_waitcnt lgkmcnt(1)
    v_mfma_f32_16x16x32_bf16 v[40:43], a[20:23], v[16:19], v[40:43]
    v_mfma_f32_16x16x32_bf16 v[48:51], a[180:183], v[16:19], v[48:51]
    v_mfma_f32_16x16x32_bf16 v[44:47], a[100:103], v[16:19], v[44:47]
    v_mfma_f32_16x16x32_bf16 v[52:55], v[196:199], v[16:19], v[52:55]
    ds_read_b128 v[16:19], v5 offset:448
    s_waitcnt lgkmcnt(1)
    v_mfma_f32_16x16x32_bf16 v[40:43], a[24:27], v[12:15], v[40:43]
    v_mfma_f32_16x16x32_bf16 v[48:51], a[184:187], v[12:15], v[48:51]
    v_mfma_f32_16x16x32_bf16 v[44:47], a[104:107], v[12:15], v[44:47]
    v_mfma_f32_16x16x32_bf16 v[52:55], v[200:203], v[12:15], v[52:55]
    ds_read_b128 v[12:15], v5 offset:512
    s_waitcnt lgkmcnt(1)
    v_mfma_f32_16x16x32_bf16 v[40:43], a[28:31], v[16:19], v[40:43]
    v_mfma_f32_16x16x32_bf16 v[48:51], a[188:191], v[16:19], v[48:51]
    v_mfma_f32_16x16x32_bf16 v[44:47], a[108:111], v[16:19], v[44:47]
    v_mfma_f32_16x16x32_bf16 v[52:55], v[204:207], v[16:19], v[52:55]
    ds_read_b128 v[16:19], v5 offset:576
    s_waitcnt lgkmcnt(1)
    v_mfma_f32_16x16x32_bf16 v[40:43], a[32:35], v[12:15], v[40:43]
    v_mfma_f32_16x16x32_bf16 v[48:51], a[192:195], v[12:15], v[48:51]
    v_mfma_f32_16x16x32_bf16 v[44:47], a[112:115], v[12:15], v[44:47]
    v_mfma_f32_16x16x32_bf16 v[52:55], v[208:211], v[12:15], v[52:55]
    ds_read_b128 v[12:15], v5 offset:640
    s_waitcnt lgkmcnt(1)
    v_mfma_f32_16x16x32_bf16 v[40:43], a[36:39], v[16:19], v[40:43]
    v_mfma_f32_16x16x32_bf16 v[48:51], a[196:199], v[16:19], v[48:51]
    v_mfma_f32_16x16x32_bf16 v[44:47], a[116:119], v[16:19], v[44:47]
    v_mfma_f32_16x16x32_bf16 v[52:55], v[212:215], v[16:19], v[52:55]
    ds_read_b128 v[16:19], v5 offset:704
    s_waitcnt lgkmcnt(1)
    v_mfma_f32_16x16x32_bf16 v[40:43], a[40:43], v[12:15], v[40:43]
    v_mfma_f32_16x16x32_bf16 v[48:51], a[200:203], v[12:15], v[48:51]
    v_mfma_f32_16x16x32_bf16 v[44:47], a[120:123], v[12:15], v[44:47]
    v_mfma_f32_16x16x32_bf16 v[52:55], v[216:219], v[12:15], v[52:55]
    ds_read_b128 v[12:15], v5 offset:768
    s_waitcnt lgkmcnt(1)
    v_mfma_f32_16x16x32_bf16 v[40:43], a[44:47], v[16:19], v[40:43]
    v_mfma_f32_16x16x32_bf16 v[48:51], a[204:207], v[16:19], v[48:51]
    v_mfma_f32_16x16x32_bf16 v[44:47], a[124:127], v[16:19], v[44:47]
    v_mfma_f32_16x16x32_bf16 v[52:55], v[220:223], v[16:19], v[52:55]
    ds_read_b128 v[16:19], v5 offset:832
    s_waitcnt lgkmcnt(1)
    v_mfma_f32_16x16x32_bf16 v[40:43], a[48:51], v[12:15], v[40:43]
    v_mfma_f32_16x16x32_bf16 v[48:51], a[208:211], v[12:15], v[48:51]
    v_mfma_f32_16x16x32_bf16 v[44:47], a[128:131], v[12:15], v[44:47]
    v_mfma_f32_16x16x32_bf16 v[52:55], v[224:227], v[12:15], v[52:55]
    ds_read_b128 v[12:15], v5 offset:896
    s_waitcnt lgkmcnt(1)
    v_mfma_f32_16x16x32_bf16 v[40:43], a[52:55], v[16:19], v[40:43]
    v_mfma_f32_16x16x32_bf16 v[48:51], a[212:215], v[16:19], v[48:51]
    v_mfma_f32_16x16x32_bf16 v[44:47], a[132:135], v[16:19], v[44:47]
    v_mfma_f32_16x16x32_bf16 v[52:55], v[228:231], v[16:19], v[52:55]
    ds_read_b128 v[16:19], v5 offset:960
    s_waitcnt lgkmcnt(1)
    v_mfma_f32_16x16x32_bf16 v[40:43], a[56:59], v[12:15], v[40:43]
    v_mfma_f32_16x16x32_bf16 v[48:51], a[216:219], v[12:15], v[48:51]
    v_mfma_f32_16x16x32_bf16 v[44:47], a[136:139], v[12:15], v[44:47]
    v_mfma_f32_16x16x32_bf16 v[52:55], v[232:235], v[12:15], v[52:55]
    ds_read_b128 v[12:15], v5 offset:1024
    s_waitcnt lgkmcnt(1)
    v_mfma_f32_16x16x32_bf16 v[40:43], a[60:63], v[16:19], v[40:43]
    v_mfma_f32_16x16x32_bf16 v[48:51], a[220:223], v[16:19], v[48:51]
    v_mfma_f32_16x16x32_bf16 v[44:47], a[140:143], v[16:19], v[44:47]
    v_mfma_f32_16x16x32_bf16 v[52:55], v[236:239], v[16:19], v[52:55]
    ds_read_b128 v[16:19], v5 offset:1088
    s_waitcnt lgkmcnt(1)
    v_mfma_f32_16x16x32_bf16 v[40:43], a[64:67], v[12:15], v[40:43]
    v_mfma_f32_16x16x32_bf16 v[48:51], a[224:227], v[12:15], v[48:51]
    v_mfma_f32_16x16x32_bf16 v[44:47], a[144:147], v[12:15], v[44:47]
    v_mfma_f32_16x16x32_bf16 v[52:55], v[240:243], v[12:15], v[52:55]
    ds_read_b128 v[12:15], v5 offset:1152
    s_waitcnt lgkmcnt(1)
    v_mfma_f32_16x16x32_bf16 v[40:43], a[68:71], v[16:19], v[40:43]
    v_mfma_f32_16x16x32_bf16 v[48:51], a[228:231], v[16:19], v[48:51]
    v_mfma_f32_16x16x32_bf16 v[44:47], a[148:151], v[16:19], v[44:47]
    v_mfma_f32_16x16x32_bf16 v[52:55], v[244:247], v[16:19], v[52:55]
    ds_read_b128 v[16:19], v5 offset:1216
    s_waitcnt lgkmcnt(1)
    v_mfma_f32_16x16x32_bf16 v[40:43], a[72:75], v[12:15], v[40:43]
    v_mfma_f32_16x16x32_bf16 v[48:51], a[232:235], v[12:15], v[48:51]
    v_mfma_f32_16x16x32_bf16 v[44:47], a[152:155], v[12:15], v[44:47]
    v_mfma_f32_16x16x32_bf16 v[52:55], v[248:251], v[12:15], v[52:55]
    s_waitcnt lgkmcnt(0)
    v_mfma_f32_16x16x32_bf16 v[40:43], a[76:79], v[16:19], v[40:43]
    v_mfma_f32_16x16x32_bf16 v[48:51], a[236:239], v[16:19], v[48:51]
    v_mfma_f32_16x16x32_bf16 v[44:47], a[156:159], v[16:19], v[44:47]
    v_mfma_f32_16x16x32_bf16 v[52:55], v[252:255], v[16:19], v[52:55]
    ds_read_b128 v[12:15], v5 offset:0
    ds_read_b128 v[20:23], v9 offset:0
    s_nop 2
    v_cvt_pk_bf16_f32 v80, v40, v41
    v_cvt_pk_bf16_f32 v81, v42, v43
    v_cvt_pk_bf16_f32 v82, v44, v45
    v_cvt_pk_bf16_f32 v83, v46, v47
    v_cvt_pk_bf16_f32 v84, v48, v49
    v_cvt_pk_bf16_f32 v85, v50, v51
    v_cvt_pk_bf16_f32 v86, v52, v53
    v_cvt_pk_bf16_f32 v87, v54, v55
    s_nop 1
    v_mfma_f32_16x16x32_bf16 v[92:95], v[84:87], v[80:83], 0
    v_mfma_f32_16x16x32_bf16 v[96:99], v[64:67], v[80:83], 0
    v_mfma_f32_16x16x32_bf16 v[100:103], v[68:71], v[80:83], 0
    s_mul_i32 s21, s3, 3072
    v_add_u32 v104, s21, v1
    ds_read_b128 v[16:19], v5 offset:64
    ds_read_b128 v[24:27], v9 offset:1024
    s_waitcnt lgkmcnt(3)
    v_mfma_f32_16x16x32_bf16 v[56:59], v[12:15], v[112:115], 0
    s_waitcnt lgkmcnt(2)
    v_mfma_f32_16x16x32_bf16 v[60:63], v[12:15], v[20:23], 0
    ds_read_b128 v[12:15], v5 offset:128
    ds_read_b128 v[20:23], v9 offset:2048
    s_waitcnt lgkmcnt(3)
    v_mfma_f32_16x16x32_bf16 v[56:59], v[16:19], v[116:119], v[56:59]
    s_waitcnt lgkmcnt(2)
    v_mfma_f32_16x16x32_bf16 v[60:63], v[16:19], v[24:27], v[60:63]
    ds_write_b128 v104, v[92:95] offset:20480
    ds_write_b128 v104, v[96:99] offset:21504
    ds_write_b128 v104, v[100:103] offset:22528
    ds_read_b128 v[16:19], v5 offset:192
    ds_read_b128 v[24:27], v9 offset:3072
    s_waitcnt lgkmcnt(6)
    v_mfma_f32_16x16x32_bf16 v[56:59], v[12:15], v[120:123], v[56:59]
    s_waitcnt lgkmcnt(5)
    v_mfma_f32_16x16x32_bf16 v[60:63], v[12:15], v[20:23], v[60:63]
    ds_read_b128 v[12:15], v5 offset:256
    ds_read_b128 v[20:23], v9 offset:4096
    s_waitcnt lgkmcnt(3)
    v_mfma_f32_16x16x32_bf16 v[56:59], v[16:19], v[124:127], v[56:59]
    s_waitcnt lgkmcnt(2)
    v_mfma_f32_16x16x32_bf16 v[60:63], v[16:19], v[24:27], v[60:63]
    ds_read_b128 v[16:19], v5 offset:320
    ds_read_b128 v[24:27], v9 offset:5120
    s_waitcnt lgkmcnt(3)
    v_mfma_f32_16x16x32_bf16 v[56:59], v[12:15], v[128:131], v[56:59]
    s_waitcnt lgkmcnt(2)
    v_mfma_f32_16x16x32_bf16 v[60:63], v[12:15], v[20:23], v[60:63]
    s_waitcnt lgkmcnt(0)
    s_barrier
    ds_read_b128 v[28:31], v1 offset:20480
    ds_read_b128 v[32:35], v1 offset:23552
    ds_read_b128 v[36:39], v1 offset:21504
    ds_read_b128 v[40:43], v1 offset:24576
    ds_read_b128 v[44:47], v1 offset:22528
    ds_read_b128 v[48:51], v1 offset:25600
    s_waitcnt lgkmcnt(4)
    v_add_f32 v92, v28, v32
    v_add_f32 v93, v29, v33
    v_add_f32 v94, v30, v34
    ds_read_b128 v[12:15], v5 offset:384
    ds_read_b128 v[20:23], v9 offset:6144
    v_mfma_f32_16x16x32_bf16 v[56:59], v[16:19], v[132:135], v[56:59]
    v_mfma_f32_16x16x32_bf16 v[60:63], v[16:19], v[24:27], v[60:63]
    v_add_f32 v95, v31, v35
    s_waitcnt lgkmcnt(4)
    v_add_f32 v96, v36, v40
    v_add_f32 v97, v37, v41
    v_add_f32 v98, v38, v42
    v_add_f32 v99, v39, v43
    s_waitcnt lgkmcnt(2)
    v_add_f32 v100, v44, v48
    v_add_f32 v101, v45, v49
    v_add_f32 v102, v46, v50
    v_add_f32 v103, v47, v51
    ds_read_b128 v[16:19], v5 offset:448
    ds_read_b128 v[24:27], v9 offset:7168
    s_waitcnt lgkmcnt(3)
    v_mfma_f32_16x16x32_bf16 v[56:59], v[12:15], v[136:139], v[56:59]
    s_waitcnt lgkmcnt(2)
    v_mfma_f32_16x16x32_bf16 v[60:63], v[12:15], v[20:23], v[60:63]
    ds_read_b128 v[28:31], v1 offset:26624
    ds_read_b128 v[32:35], v1 offset:29696
    ds_read_b128 v[36:39], v1 offset:27648
    ds_read_b128 v[40:43], v1 offset:30720
    ds_read_b128 v[44:47], v1 offset:28672
    ds_read_b128 v[48:51], v1 offset:31744
    s_waitcnt lgkmcnt(4)
    v_add_f32 v28, v28, v32
    v_add_f32 v92, v92, v28
    v_add_f32 v29, v29, v33
    ds_read_b128 v[12:15], v5 offset:512
    ds_read_b128 v[20:23], v9 offset:8192
    v_mfma_f32_16x16x32_bf16 v[56:59], v[16:19], v[140:143], v[56:59]
    v_mfma_f32_16x16x32_bf16 v[60:63], v[16:19], v[24:27], v[60:63]
    v_add_f32 v93, v93, v29
    v_add_f32 v30, v30, v34
    v_add_f32 v94, v94, v30
    v_add_f32 v31, v31, v35
    v_add_f32 v95, v95, v31
    s_waitcnt lgkmcnt(4)
    v_add_f32 v36, v36, v40
    v_add_f32 v96, v96, v36
    v_add_f32 v37, v37, v41
    v_add_f32 v97, v97, v37
    ds_read_b128 v[16:19], v5 offset:576
    ds_read_b128 v[24:27], v9 offset:9216
    s_waitcnt lgkmcnt(3)
    v_mfma_f32_16x16x32_bf16 v[56:59], v[12:15], v[144:147], v[56:59]
    s_waitcnt lgkmcnt(2)
    v_mfma_f32_16x16x32_bf16 v[60:63], v[12:15], v[20:23], v[60:63]
    v_add_f32 v38, v38, v42
    v_add_f32 v98, v98, v38
    v_add_f32 v39, v39, v43
    v_add_f32 v99, v99, v39
    v_add_f32 v44, v44, v48
    v_add_f32 v100, v100, v44
    v_add_f32 v45, v45, v49
    v_add_f32 v101, v101, v45
    v_add_f32 v46, v46, v50
    ds_read_b128 v[12:15], v5 offset:640
    ds_read_b128 v[20:23], v9 offset:10240
    s_waitcnt lgkmcnt(3)
    v_mfma_f32_16x16x32_bf16 v[56:59], v[16:19], v[148:151], v[56:59]
    s_waitcnt lgkmcnt(2)
    v_mfma_f32_16x16x32_bf16 v[60:63], v[16:19], v[24:27], v[60:63]
    v_add_f32 v102, v102, v46
    v_add_f32 v47, v47, v51
    v_add_f32 v103, v103, v47
    v_cvt_pk_bf16_f32 v104, v92, v93
    v_lshlrev_b32 v92, 16, v104
    v_and_b32 v93, 0xffff0000, v104
    v_mul_f32 v92, s40, v92
    v_mul_f32 v93, s40, v93
    v_cvt_pk_bf16_f32 v104, v92, v93
    ds_read_b128 v[16:19], v5 offset:704
    ds_read_b128 v[24:27], v9 offset:11264
    s_waitcnt lgkmcnt(3)
    v_mfma_f32_16x16x32_bf16 v[56:59], v[12:15], v[152:155], v[56:59]
    s_waitcnt lgkmcnt(2)
    v_mfma_f32_16x16x32_bf16 v[60:63], v[12:15], v[20:23], v[60:63]
    v_lshlrev_b32 v92, 16, v104
    v_and_b32 v93, 0xffff0000, v104
    v_cvt_pk_bf16_f32 v105, v94, v95
    v_lshlrev_b32 v94, 16, v105
    v_and_b32 v95, 0xffff0000, v105
    v_mul_f32 v94, s40, v94
    v_mul_f32 v95, s40, v95
    v_cvt_pk_bf16_f32 v105, v94, v95
    v_lshlrev_b32 v94, 16, v105
    ds_read_b128 v[12:15], v5 offset:768
    ds_read_b128 v[20:23], v9 offset:12288
    s_waitcnt lgkmcnt(3)
    v_mfma_f32_16x16x32_bf16 v[56:59], v[16:19], v[156:159], v[56:59]
    s_waitcnt lgkmcnt(2)
    v_mfma_f32_16x16x32_bf16 v[60:63], v[16:19], v[24:27], v[60:63]
    v_and_b32 v95, 0xffff0000, v105
    v_cvt_pk_bf16_f32 v104, v96, v97
    v_lshlrev_b32 v96, 16, v104
    v_and_b32 v97, 0xffff0000, v104
    v_mul_f32 v96, s40, v96
    v_mul_f32 v97, s40, v97
    v_cvt_pk_bf16_f32 v104, v96, v97
    v_lshlrev_b32 v96, 16, v104
    v_and_b32 v97, 0xffff0000, v104
    ds_read_b128 v[16:19], v5 offset:832
    ds_read_b128 v[24:27], v9 offset:13312
    s_waitcnt lgkmcnt(3)
    v_mfma_f32_16x16x32_bf16 v[56:59], v[12:15], v[160:163], v[56:59]
    s_waitcnt lgkmcnt(2)
    v_mfma_f32_16x16x32_bf16 v[60:63], v[12:15], v[20:23], v[60:63]
    v_cvt_pk_bf16_f32 v105, v98, v99
    v_lshlrev_b32 v98, 16, v105
    v_and_b32 v99, 0xffff0000, v105
    v_mul_f32 v98, s40, v98
    v_mul_f32 v99, s40, v99
    v_cvt_pk_bf16_f32 v105, v98, v99
    v_lshlrev_b32 v98, 16, v105
    v_and_b32 v99, 0xffff0000, v105
    v_cvt_pk_bf16_f32 v104, v100, v101
    ds_read_b128 v[12:15], v5 offset:896
    ds_read_b128 v[20:23], v9 offset:14336
    s_waitcnt lgkmcnt(3)
    v_mfma_f32_16x16x32_bf16 v[56:59], v[16:19], v[164:167], v[56:59]
    s_waitcnt lgkmcnt(2)
    v_mfma_f32_16x16x32_bf16 v[60:63], v[16:19], v[24:27], v[60:63]
    v_lshlrev_b32 v100, 16, v104
    v_and_b32 v101, 0xffff0000, v104
    v_mul_f32 v100, s40, v100
    v_mul_f32 v101, s40, v101
    v_cvt_pk_bf16_f32 v104, v100, v101
    v_lshlrev_b32 v100, 16, v104
    v_and_b32 v101, 0xffff0000, v104
    v_cvt_pk_bf16_f32 v105, v102, v103
    v_lshlrev_b32 v102, 16, v105
    ds_read_b128 v[16:19], v5 offset:960
    ds_read_b128 v[24:27], v9 offset:15360
    s_waitcnt lgkmcnt(3)
    v_mfma_f32_16x16x32_bf16 v[56:59], v[12:15], v[168:171], v[56:59]
    s_waitcnt lgkmcnt(2)
    v_mfma_f32_16x16x32_bf16 v[60:63], v[12:15], v[20:23], v[60:63]
    v_and_b32 v103, 0xffff0000, v105
    v_mul_f32 v102, s40, v102
    v_mul_f32 v103, s40, v103
    v_cvt_pk_bf16_f32 v105, v102, v103
    v_lshlrev_b32 v102, 16, v105
    v_and_b32 v103, 0xffff0000, v105
    v_mov_b32 v104, 0xce6e6b28
    v_cndmask_b32 v92, v92, v104, s[38:39]
    v_cndmask_b32 v93, v93, v104, s[38:39]
    ds_read_b128 v[12:15], v5 offset:1024
    ds_read_b128 v[20:23], v9 offset:16384
    s_waitcnt lgkmcnt(3)
    v_mfma_f32_16x16x32_bf16 v[56:59], v[16:19], v[172:175], v[56:59]
    s_waitcnt lgkmcnt(2)
    v_mfma_f32_16x16x32_bf16 v[60:63], v[16:19], v[24:27], v[60:63]
    v_cndmask_b32 v94, v94, v104, s[38:39]
    v_cndmask_b32 v95, v95, v104, s[38:39]
    v_max3_f32 v104, v92, v93, v94
    v_max3_f32 v105, v95, v96, v97
    v_max3_f32 v106, v98, v99, v100
    v_max3_f32 v107, v101, v102, v103
    v_max3_f32 v104, v104, v105, v106
    v_max_f32 v104, v104, v107
    v_mov_b32 v105, v104
    ds_read_b128 v[16:19], v5 offset:1088
    ds_read_b128 v[24:27], v9 offset:17408
    s_waitcnt lgkmcnt(3)
    v_mfma_f32_16x16x32_bf16 v[56:59], v[12:15], v[176:179], v[56:59]
    s_waitcnt lgkmcnt(2)
    v_mfma_f32_16x16x32_bf16 v[60:63], v[12:15], v[20:23], v[60:63]
    v_permlane32_swap_b32 v104, v105
    v_max_f32 v104, v104, v105
    v_mov_b32 v105, v104
    s_nop 1
    v_permlane16_swap_b32 v104, v105
    v_max_f32 v104, v104, v105
    v_mul_f32 v104, s41, v104
    v_fma_f32 v92, v92, s41, -v104
    v_fma_f32 v93, v93, s41, -v104
    v_fma_f32 v94, v94, s41, -v104
    ds_read_b128 v[12:15], v5 offset:1152
    ds_read_b128 v[20:23], v9 offset:18432
    s_waitcnt lgkmcnt(3)
    v_mfma_f32_16x16x32_bf16 v[56:59], v[16:19], v[180:183], v[56:59]
    s_waitcnt lgkmcnt(2)
    v_mfma_f32_16x16x32_bf16 v[60:63], v[16:19], v[24:27], v[60:63]
    v_fma_f32 v95, v95, s41, -v104
    v_fma_f32 v96, v96, s41, -v104
    v_fma_f32 v97, v97, s41, -v104
    v_fma_f32 v98, v98, s41, -v104
    v_fma_f32 v99, v99, s41, -v104
    v_fma_f32 v100, v100, s41, -v104
    v_fma_f32 v101, v101, s41, -v104
    v_fma_f32 v102, v102, s41, -v104
    v_fma_f32 v103, v103, s41, -v104
    ds_read_b128 v[16:19], v5 offset:1216
    ds_read_b128 v[24:27], v9 offset:19456
    s_waitcnt lgkmcnt(3)
    v_mfma_f32_16x16x32_bf16 v[56:59], v[12:15], v[184:187], v[56:59]
    s_waitcnt lgkmcnt(2)
    v_mfma_f32_16x16x32_bf16 v[60:63], v[12:15], v[20:23], v[60:63]
    v_exp_f32 v92, v92
    v_exp_f32 v93, v93
    v_exp_f32 v94, v94
    v_exp_f32 v95, v95
    v_exp_f32 v96, v96
    v_exp_f32 v97, v97
    v_exp_f32 v98, v98
    v_exp_f32 v99, v99
    v_exp_f32 v100, v100
    s_waitcnt lgkmcnt(1)
    v_mfma_f32_16x16x32_bf16 v[56:59], v[16:19], v[188:191], v[56:59]
    s_waitcnt lgkmcnt(0)
    v_mfma_f32_16x16x32_bf16 v[60:63], v[16:19], v[24:27], v[60:63]
    v_exp_f32 v101, v101
    v_exp_f32 v102, v102
    v_exp_f32 v103, v103
    v_add_f32 v104, v92, v93
    v_add_f32 v105, v94, v95
    v_add_f32 v106, v96, v97
    v_add_f32 v107, v98, v99
    v_add_f32 v104, v104, v100
    v_add_f32 v105, v105, v101
    v_add_f32 v106, v106, v102
    v_add_f32 v107, v107, v103
    v_add_f32 v104, v104, v105
    v_add_f32 v106, v106, v107
    v_add_f32 v104, v104, v106
    v_mov_b32 v105, v104
    s_nop 1
    v_permlane32_swap_b32 v104, v105
    v_add_f32 v104, v104, v105
    v_mov_b32 v105, v104
    s_nop 1
    v_permlane16_swap_b32 v104, v105
    v_add_f32 v104, v104, v105
    v_rcp_f32 v104, v104
    s_nop 0
    v_mul_f32 v92, v92, v104
    v_mul_f32 v93, v93, v104
    v_mul_f32 v94, v94, v104
    v_mul_f32 v95, v95, v104
    v_mul_f32 v96, v96, v104
    v_mul_f32 v97, v97, v104
    v_mul_f32 v98, v98, v104
    v_mul_f32 v99, v99, v104
    v_mul_f32 v100, v100, v104
    v_mul_f32 v101, v101, v104
    v_mul_f32 v102, v102, v104
    v_mul_f32 v103, v103, v104
    v_cvt_pk_bf16_f32 v40, v92, v93
    v_cvt_pk_bf16_f32 v41, v94, v95
    v_cvt_pk_bf16_f32 v44, v96, v97
    v_cvt_pk_bf16_f32 v45, v98, v99
    v_cvt_pk_bf16_f32 v46, v100, v101
    v_cvt_pk_bf16_f32 v47, v102, v103
    ds_read_b128 v[12:15], v10 offset:0
    ds_read_b128 v[16:19], v10 offset:1024
    ds_read_b128 v[20:23], v10 offset:2048
    ds_read_b128 v[24:27], v10 offset:3072
    ds_read_b128 v[28:31], v10 offset:4096
    v_cvt_pk_bf16_f32 v88, v56, v57
    v_cvt_pk_bf16_f32 v89, v58, v59
    v_cvt_pk_bf16_f32 v90, v60, v61
    v_cvt_pk_bf16_f32 v91, v62, v63
    s_cmp_lg_u32 s17, 0
    s_cbranch_scc1 K4_NOSAVE
    buffer_store_dwordx4 v[84:87], v1, s[4:7], s27 offen
    buffer_store_dwordx2 v[88:89], v11, s[4:7], s28 offen
    buffer_store_dwordx2 v[90:91], v11, s[4:7], s28 offen offset:512
K4_NOSAVE:
    s_add_u32 s27, s27, 131072
    s_add_u32 s28, s28, 131072
    s_cmp_eq_u32 s35, 63
    s_cbranch_scc1 K4_END
    v_mfma_f32_16x16x32_bf16 v[48:51], v[72:75], v[44:47], 0
    v_mfma_f32_16x16x32_bf16 v[52:55], v[76:79], v[44:47], 0
    v_mfma_f32_16x16x16_bf16 v[48:51], v[88:89], v[40:41], v[48:51]
    v_mfma_f32_16x16x16_bf16 v[52:55], v[90:91], v[40:41], v[52:55]
    s_nop 6
    v_cvt_pk_bf16_f32 v56, v48, v49
    v_cvt_pk_bf16_f32 v57, v50, v51
    v_cvt_pk_bf16_f32 v58, v52, v53
    v_cvt_pk_bf16_f32 v59, v54, v55
    buffer_load_dwordx4 v[64:67], v1, s[4:7], s25 offen
    s_add_u32 s21, s25, 131072
    buffer_load_dwordx4 v[68:71], v1, s[4:7], s21 offen
    buffer_load_dwordx4 v[72:75], v1, s[4:7], s26 offen
    buffer_load_dwordx4 v[76:79], v1, s[4:7], s26 offen offset:1024
    s_add_u32 s25, s25, 262144
    s_add_u32 s26, s26, 262144
    s_waitcnt lgkmcnt(0)
    v_mfma_f32_16x16x32_bf16 v[32:35], v[56:59], v[12:15], 0
    v_mfma_f32_16x16x32_bf16 v[36:39], v[56:59], v[16:19], 0
    v_mfma_f32_16x16x32_bf16 v[40:43], v[56:59], v[20:23], 0
    v_mfma_f32_16x16x32_bf16 v[44:47], v[56:59], v[24:27], 0
    v_mfma_f32_16x16x32_bf16 v[48:51], v[56:59], v[28:31], 0
    s_mul_i32 s21, s3, 5120
    v_add_u32 v104, s21, v1
    s_nop 1
    ds_write_b128 v104, v[32:35] offset:32768
    ds_write_b128 v104, v[36:39] offset:33792
    ds_write_b128 v104, v[40:43] offset:34816
    ds_write_b128 v104, v[44:47] offset:35840
    ds_write_b128 v104, v[48:51] offset:36864
    s_waitcnt lgkmcnt(0)
    s_barrier
    ds_read_b32 v40, v8 offset:0
    ds_read_b32 v41, v8 offset:5120
    ds_read_b32 v42, v8 offset:10240
    ds_read_b32 v43, v8 offset:15360
    ds_read_b32 v44, v109 offset:0
    ds_read_b32 v45, v109 offset:5120
    ds_read_b32 v46, v109 offset:10240
    ds_read_b32 v47, v109 offset:15360
    ds_read_b32 v48, v0 offset:0
    ds_read_b32 v49, v0 offset:5120
    ds_read_b32 v50, v0 offset:10240
    ds_read_b32 v51, v0 offset:15360
    v_mov_b32 v104, 1.0
    s_waitcnt lgkmcnt(10)
    v_add_f32 v40, v40, v41
    s_waitcnt lgkmcnt(8)
    v_add_f32 v42, v42, v43
    v_add_f32 v40, v40, v42
    v_cndmask_b32 v40, 0, v40, s[54:55]
    v_cndmask_b32 v40, v40, v104, s[60:61]
    buffer_atomic_add_f32 v40, v108, s[4:7], s29 offen offset:0
    s_waitcnt lgkmcnt(6)
    v_add_f32 v44, v44, v45
    s_waitcnt lgkmcnt(4)
    v_add_f32 v46, v46, v47
    v_add_f32 v44, v44, v46
    v_cndmask_b32 v44, 0, v44, s[56:57]
    v_cndmask_b32 v44, v44, v104, s[60:61]
    buffer_atomic_add_f32 v44, v108, s[4:7], s29 offen offset:1024
    s_waitcnt lgkmcnt(2)
    v_add_f32 v48, v48, v49
    s_waitcnt lgkmcnt(0)
    v_add_f32 v50, v50, v51
    v_add_f32 v48, v48, v50
    v_cndmask_b32 v48, 0, v48, s[58:59]
    v_cndmask_b32 v48, v48, v104, s[60:61]
    buffer_atomic_add_f32 v48, v108, s[4:7], s29 offen offset:2048
    s_add_u32 s29, s29, 24576
    s_add_u32 s35, s35, 1
    s_nop 7
    s_branch K4_STEP
K4_END:
    s_endpgm
.text
.globl k5a_kernel
.p2align 8
.type k5a_kernel,@function
k5a_kernel:
    s_load_dwordx2 s[4:5], s[0:1], 112
    s_cmp_ge_u32 s2, 522
    s_cbranch_scc1 K5A_END
    s_cmp_ge_u32 s2, 10
    s_cbranch_scc1 K5A_ATT
    v_lshrrev_b32 v1, 6, v0
    s_nop 0
    v_readfirstlane_b32 s3, v1
    v_and_b32 v2, 63, v0
    s_mov_b32 s6, 268435456
    s_mov_b32 s7, 0x00020000
    v_lshlrev_b32 v1, 4, v2
    v_and_b32 v4, 7, v2
    v_mul_u32_u24 v4, 3456, v4
    v_lshrrev_b32 v5, 4, v2
    v_lshl_add_u32 v4, v5, 4, v4
    s_lshl_b32 s20, s2, 2
    s_add_u32 s20, s20, s3
    s_mul_i32 s21, s20, 55296
    s_add_u32 s21, s21, 32505856
    s_mov_b32 s23, 5373952
    s_waitcnt lgkmcnt(0)
    v_lshlrev_b32 v6, 4, v5
    s_mov_b32 s19, 5308448
    buffer_load_dwordx4 v[24:27], v6, s[4:7], s19 offen
    buffer_load_dwordx4 v[32:35], v4, s[4:7], s23 offen offset:0
    s_add_u32 s22, s21, 0
    buffer_load_dwordx4 v[36:39], v1, s[4:7], s22 offen
    buffer_load_dwordx4 v[40:43], v4, s[4:7], s23 offen offset:64
    s_add_u32 s22, s21, 1024
    buffer_load_dwordx4 v[44:47], v1, s[4:7], s22 offen
    buffer_load_dwordx4 v[48:51], v4, s[4:7], s23 offen offset:128
    s_add_u32 s22, s21, 2048
    buffer_load_dwordx4 v[52:55], v1, s[4:7], s22 offen
    buffer_load_dwordx4 v[56:59], v4, s[4:7], s23 offen offset:192
    s_add_u32 s22, s21, 3072
    buffer_load_dwordx4 v[60:63], v1, s[4:7], s22 offen
    buffer_load_dwordx4 v[64:67], v4, s[4:7], s23 offen offset:256
    s_add_u32 s22, s21, 4096
    buffer_load_dwordx4 v[68:71], v1, s[4:7], s22 offen
    buffer_load_dwordx4 v[72:75], v4, s[4:7], s23 offen offset:320
    s_add_u32 s22, s21, 5120
    buffer_load_dwordx4 v[76:79], v1, s[4:7], s22 offen
    buffer_load_dwordx4 v[80:83], v4, s[4:7], s23 offen offset:384
    s_add_u32 s22, s21, 6144
    buffer_load_dwordx4 v[84:87], v1, s[4:7], s22 offen
    buffer_load_dwordx4 v[88:91], v4, s[4:7], s23 offen offset:448
    s_add_u32 s22, s21, 7168
    buffer_load_dwordx4 v[92:95], v1, s[4:7], s22 offen
    buffer_load_dwordx4 v[96:99], v4, s[4:7], s23 offen offset:512
    s_add_u32 s22, s21, 8192
    buffer_load_dwordx4 v[100:103], v1, s[4:7], s22 offen
    buffer_load_dwordx4 v[104:107], v4, s[4:7], s23 offen offset:576
    s_add_u32 s22, s21, 9216
    buffer_load_dwordx4 v[108:111], v1, s[4:7], s22 offen
    buffer_load_dwordx4 v[112:115], v4, s[4:7], s23 offen offset:640
    s_add_u32 s22, s21, 10240
    buffer_load_dwordx4 v[116:119], v1, s[4:7], s22 offen
    buffer_load_dwordx4 v[120:123], v4, s[4:7], s23 offen offset:704
    s_add_u32 s22, s21, 11264
    buffer_load_dwordx4 v[124:127], v1, s[4:7], s22 offen
    buffer_load_dwordx4 v[128:131], v4, s[4:7], s23 offen offset:768
    s_add_u32 s22, s21, 12288
    buffer_load_dwordx4 v[132:135], v1, s[4:7], s22 offen
    buffer_load_dwordx4 v[136:139], v4, s[4:7], s23 offen offset:832
    s_add_u32 s22, s21, 13312
    buffer_load_dwordx4 v[140:143], v1, s[4:7], s22 offen
    buffer_load_dwordx4 v[144:147], v4, s[4:7], s23 offen offset:896
    s_add_u32 s22, s21, 14336
    buffer_load_dwordx4 v[148:151], v1, s[4:7], s22 offen
    buffer_load_dwordx4 v[152:155], v4, s[4:7], s23 offen offset:960
    s_add_u32 s22, s21, 15360
    buffer_load_dwordx4 v[156:159], v1, s[4:7], s22 offen
    buffer_load_dwordx4 v[160:163], v4, s[4:7], s23 offen offset:1024
    s_add_u32 s22, s21, 16384
    buffer_load_dwordx4 v[164:167], v1, s[4:7], s22 offen
    buffer_load_dwordx4 v[168:171], v4, s[4:7], s23 offen offset:1088
    s_add_u32 s22, s21, 17408
    buffer_load_dwordx4 v[172:175], v1, s[4:7], s22 offen
    s_waitcnt vmcnt(0)
    v_mfma_f32_16x16x32_bf16 v[8:11], v[32:35], v[36:39], 0
    v_mfma_f32_16x16x32_bf16 v[8:11], v[40:43], v[44:47], v[8:11]
    v_mfma_f32_16x16x32_bf16 v[8:11], v[48:51], v[52:55], v[8:11]
    v_mfma_f32_16x16x32_bf16 v[8:11], v[56:59], v[60:63], v[8:11]
    v_mfma_f32_16x16x32_bf16 v[8:11], v[64:67], v[68:71], v[8:11]
    v_mfma_f32_16x16x32_bf16 v[8:11], v[72:75], v[76:79], v[8:11]
    v_mfma_f32_16x16x32_bf16 v[8:11], v[80:83], v[84:87], v[8:11]
    v_mfma_f32_16x16x32_bf16 v[8:11], v[88:91], v[92:95], v[8:11]
    v_mfma_f32_16x16x32_bf16 v[8:11], v[96:99], v[100:103], v[8:11]
    v_mfma_f32_16x16x32_bf16 v[8:11], v[104:107], v[108:111], v[8:11]
    v_mfma_f32_16x16x32_bf16 v[8:11], v[112:115], v[116:119], v[8:11]
    v_mfma_f32_16x16x32_bf16 v[8:11], v[120:123], v[124:127], v[8:11]
    v_mfma_f32_16x16x32_bf16 v[8:11], v[128:131], v[132:135], v[8:11]
    v_mfma_f32_16x16x32_bf16 v[8:11], v[136:139], v[140:143], v[8:11]
    v_mfma_f32_16x16x32_bf16 v[8:11], v[144:147], v[148:151], v[8:11]
    v_mfma_f32_16x16x32_bf16 v[8:11], v[152:155], v[156:159], v[8:11]
    v_mfma_f32_16x16x32_bf16 v[8:11], v[160:163], v[164:167], v[8:11]
    v_mfma_f32_16x16x32_bf16 v[8:11], v[168:171], v[172:175], v[8:11]
    s_nop 7
    buffer_load_dwordx4 v[32:35], v4, s[4:7], s23 offen offset:1152
    s_add_u32 s22, s21, 18432
    buffer_load_dwordx4 v[36:39], v1, s[4:7], s22 offen
    buffer_load_dwordx4 v[40:43], v4, s[4:7], s23 offen offset:1216
    s_add_u32 s22, s21, 19456
    buffer_load_dwordx4 v[44:47], v1, s[4:7], s22 offen
    buffer_load_dwordx4 v[48:51], v4, s[4:7], s23 offen offset:1280
    s_add_u32 s22, s21, 20480
    buffer_load_dwordx4 v[52:55], v1, s[4:7], s22 offen
    buffer_load_dwordx4 v[56:59], v4, s[4:7], s23 offen offset:1344
    s_add_u32 s22, s21, 21504
    buffer_load_dwordx4 v[60:63], v1, s[4:7], s22 offen
    buffer_load_dwordx4 v[64:67], v4, s[4:7], s23 offen offset:1408
    s_add_u32 s22, s21, 22528
    buffer_load_dwordx4 v[68:71], v1, s[4:7], s22 offen
    buffer_load_dwordx4 v[72:75], v4, s[4:7], s23 offen offset:1472
    s_add_u32 s22, s21, 23552
    buffer_load_dwordx4 v[76:79], v1, s[4:7], s22 offen
    buffer_load_dwordx4 v[80:83], v4, s[4:7], s23 offen offset:1536
    s_add_u32 s22, s21, 24576
    buffer_load_dwordx4 v[84:87], v1, s[4:7], s22 offen
    buffer_load_dwordx4 v[88:91], v4, s[4:7], s23 offen offset:1600
    s_add_u32 s22, s21, 25600
    buffer_load_dwordx4 v[92:95], v1, s[4:7], s22 offen
    buffer_load_dwordx4 v[96:99], v4, s[4:7], s23 offen offset:1664
    s_add_u32 s22, s21, 26624
    buffer_load_dwordx4 v[100:103], v1, s[4:7], s22 offen
    buffer_load_dwordx4 v[104:107], v4, s[4:7], s23 offen offset:1728
    s_add_u32 s22, s21, 27648
    buffer_load_dwordx4 v[108:111], v1, s[4:7], s22 offen
    buffer_load_dwordx4 v[112:115], v4, s[4:7], s23 offen offset:1792
    s_add_u32 s22, s21, 28672
    buffer_load_dwordx4 v[116:119], v1, s[4:7], s22 offen
    buffer_load_dwordx4 v[120:123], v4, s[4:7], s23 offen offset:1856
    s_add_u32 s22, s21, 29696
    buffer_load_dwordx4 v[124:127], v1, s[4:7], s22 offen
    buffer_load_dwordx4 v[128:131], v4, s[4:7], s23 offen offset:1920
    s_add_u32 s22, s21, 30720
    buffer_load_dwordx4 v[132:135], v1, s[4:7], s22 offen
    buffer_load_dwordx4 v[136:139], v4, s[4:7], s23 offen offset:1984
    s_add_u32 s22, s21, 31744
    buffer_load_dwordx4 v[140:143], v1, s[4:7], s22 offen
    buffer_load_dwordx4 v[144:147], v4, s[4:7], s23 offen offset:2048
    s_add_u32 s22, s21, 32768
    buffer_load_dwordx4 v[148:151], v1, s[4:7], s22 offen
    buffer_load_dwordx4 v[152:155], v4, s[4:7], s23 offen offset:2112
    s_add_u32 s22, s21, 33792
    buffer_load_dwordx4 v[156:159], v1, s[4:7], s22 offen
    buffer_load_dwordx4 v[160:163], v4, s[4:7], s23 offen offset:2176
    s_add_u32 s22, s21, 34816
    buffer_load_dwordx4 v[164:167], v1, s[4:7], s22 offen
    buffer_load_dwordx4 v[168:171], v4, s[4:7], s23 offen offset:2240
    s_add_u32 s22, s21, 35840
    buffer_load_dwordx4 v[172:175], v1, s[4:7], s22 offen
    s_waitcnt vmcnt(0)
    v_mfma_f32_16x16x32_bf16 v[8:11], v[32:35], v[36:39], v[8:11]
    v_mfma_f32_16x16x32_bf16 v[8:11], v[40:43], v[44:47], v[8:11]
    v_mfma_f32_16x16x32_bf16 v[8:11], v[48:51], v[52:55], v[8:11]
    v_mfma_f32_16x16x32_bf16 v[8:11], v[56:59], v[60:63], v[8:11]
    v_mfma_f32_16x16x32_bf16 v[8:11], v[64:67], v[68:71], v[8:11]
    v_mfma_f32_16x16x32_bf16 v[8:11], v[72:75], v[76:79], v[8:11]
    v_mfma_f32_16x16x32_bf16 v[8:11], v[80:83], v[84:87], v[8:11]
    v_mfma_f32_16x16x32_bf16 v[8:11], v[88:91], v[92:95], v[8:11]
    v_mfma_f32_16x16x32_bf16 v[8:11], v[96:99], v[100:103], v[8:11]
    v_mfma_f32_16x16x32_bf16 v[8:11], v[104:107], v[108:111], v[8:11]
    v_mfma_f32_16x16x32_bf16 v[8:11], v[112:115], v[116:119], v[8:11]
    v_mfma_f32_16x16x32_bf16 v[8:11], v[120:123], v[124:127], v[8:11]
    v_mfma_f32_16x16x32_bf16 v[8:11], v[128:131], v[132:135], v[8:11]
    v_mfma_f32_16x16x32_bf16 v[8:11], v[136:139], v[140:143], v[8:11]
    v_mfma_f32_16x16x32_bf16 v[8:11], v[144:147], v[148:151], v[8:11]
    v_mfma_f32_16x16x32_bf16 v[8:11], v[152:155], v[156:159], v[8:11]
    v_mfma_f32_16x16x32_bf16 v[8:11], v[160:163], v[164:167], v[8:11]
    v_mfma_f32_16x16x32_bf16 v[8:11], v[168:171], v[172:175], v[8:11]
    s_nop 7
    buffer_load_dwordx4 v[32:35], v4, s[4:7], s23 offen offset:2304
    s_add_u32 s22, s21, 36864
    buffer_load_dwordx4 v[36:39], v1, s[4:7], s22 offen
    buffer_load_dwordx4 v[40:43], v4, s[4:7], s23 offen offset:2368
    s_add_u32 s22, s21, 37888
    buffer_load_dwordx4 v[44:47], v1, s[4:7], s22 offen
    buffer_load_dwordx4 v[48:51], v4, s[4:7], s23 offen offset:2432
    s_add_u32 s22, s21, 38912
    buffer_load_dwordx4 v[52:55], v1, s[4:7], s22 offen
    buffer_load_dwordx4 v[56:59], v4, s[4:7], s23 offen offset:2496
    s_add_u32 s22, s21, 39936
    buffer_load_dwordx4 v[60:63], v1, s[4:7], s22 offen
    buffer_load_dwordx4 v[64:67], v4, s[4:7], s23 offen offset:2560
    s_add_u32 s22, s21, 40960
    buffer_load_dwordx4 v[68:71], v1, s[4:7], s22 offen
    buffer_load_dwordx4 v[72:75], v4, s[4:7], s23 offen offset:2624
    s_add_u32 s22, s21, 41984
    buffer_load_dwordx4 v[76:79], v1, s[4:7], s22 offen
    buffer_load_dwordx4 v[80:83], v4, s[4:7], s23 offen offset:2688
    s_add_u32 s22, s21, 43008
    buffer_load_dwordx4 v[84:87], v1, s[4:7], s22 offen
    buffer_load_dwordx4 v[88:91], v4, s[4:7], s23 offen offset:2752
    s_add_u32 s22, s21, 44032
    buffer_load_dwordx4 v[92:95], v1, s[4:7], s22 offen
    buffer_load_dwordx4 v[96:99], v4, s[4:7], s23 offen offset:2816
    s_add_u32 s22, s21, 45056
    buffer_load_dwordx4 v[100:103], v1, s[4:7], s22 offen
    buffer_load_dwordx4 v[104:107], v4, s[4:7], s23 offen offset:2880
    s_add_u32 s22, s21, 46080
    buffer_load_dwordx4 v[108:111], v1, s[4:7], s22 offen
    buffer_load_dwordx4 v[112:115], v4, s[4:7], s23 offen offset:2944
    s_add_u32 s22, s21, 47104
    buffer_load_dwordx4 v[116:119], v1, s[4:7], s22 offen
    buffer_load_dwordx4 v[120:123], v4, s[4:7], s23 offen offset:3008
    s_add_u32 s22, s21, 48128
    buffer_load_dwordx4 v[124:127], v1, s[4:7], s22 offen
    buffer_load_dwordx4 v[128:131], v4, s[4:7], s23 offen offset:3072
    s_add_u32 s22, s21, 49152
    buffer_load_dwordx4 v[132:135], v1, s[4:7], s22 offen
    buffer_load_dwordx4 v[136:139], v4, s[4:7], s23 offen offset:3136
    s_add_u32 s22, s21, 50176
    buffer_load_dwordx4 v[140:143], v1, s[4:7], s22 offen
    buffer_load_dwordx4 v[144:147], v4, s[4:7], s23 offen offset:3200
    s_add_u32 s22, s21, 51200
    buffer_load_dwordx4 v[148:151], v1, s[4:7], s22 offen
    buffer_load_dwordx4 v[152:155], v4, s[4:7], s23 offen offset:3264
    s_add_u32 s22, s21, 52224
    buffer_load_dwordx4 v[156:159], v1, s[4:7], s22 offen
    buffer_load_dwordx4 v[160:163], v4, s[4:7], s23 offen offset:3328
    s_add_u32 s22, s21, 53248
    buffer_load_dwordx4 v[164:167], v1, s[4:7], s22 offen
    buffer_load_dwordx4 v[168:171], v4, s[4:7], s23 offen offset:3392
    s_add_u32 s22, s21, 54272
    buffer_load_dwordx4 v[172:175], v1, s[4:7], s22 offen
    s_waitcnt vmcnt(0)
    v_mfma_f32_16x16x32_bf16 v[8:11], v[32:35], v[36:39], v[8:11]
    v_mfma_f32_16x16x32_bf16 v[8:11], v[40:43], v[44:47], v[8:11]
    v_mfma_f32_16x16x32_bf16 v[8:11], v[48:51], v[52:55], v[8:11]
    v_mfma_f32_16x16x32_bf16 v[8:11], v[56:59], v[60:63], v[8:11]
    v_mfma_f32_16x16x32_bf16 v[8:11], v[64:67], v[68:71], v[8:11]
    v_mfma_f32_16x16x32_bf16 v[8:11], v[72:75], v[76:79], v[8:11]
    v_mfma_f32_16x16x32_bf16 v[8:11], v[80:83], v[84:87], v[8:11]
    v_mfma_f32_16x16x32_bf16 v[8:11], v[88:91], v[92:95], v[8:11]
    v_mfma_f32_16x16x32_bf16 v[8:11], v[96:99], v[100:103], v[8:11]
    v_mfma_f32_16x16x32_bf16 v[8:11], v[104:107], v[108:111], v[8:11]
    v_mfma_f32_16x16x32_bf16 v[8:11], v[112:115], v[116:119], v[8:11]
    v_mfma_f32_16x16x32_bf16 v[8:11], v[120:123], v[124:127], v[8:11]
    v_mfma_f32_16x16x32_bf16 v[8:11], v[128:131], v[132:135], v[8:11]
    v_mfma_f32_16x16x32_bf16 v[8:11], v[136:139], v[140:143], v[8:11]
    v_mfma_f32_16x16x32_bf16 v[8:11], v[144:147], v[148:151], v[8:11]
    v_mfma_f32_16x16x32_bf16 v[8:11], v[152:155], v[156:159], v[8:11]
    v_mfma_f32_16x16x32_bf16 v[8:11], v[160:163], v[164:167], v[8:11]
    v_mfma_f32_16x16x32_bf16 v[8:11], v[168:171], v[172:175], v[8:11]
    s_nop 7
    s_mov_b32 s19, 0xbfb8aa3b
    v_cvt_pk_bf16_f32 v8, v8, v8
    v_and_b32 v8, 0xffff0000, v8
    v_mul_f32 v16, s19, v24
    v_exp_f32 v16, v16
    s_nop 0
    v_add_f32 v16, 1.0, v16
    v_rcp_f32 v16, v16
    s_nop 0
    v_cvt_pk_bf16_f32 v16, v16, v16
    v_and_b32 v16, 0xffff0000, v16
    v_mul_f32 v8, v8, v16
    v_cvt_pk_bf16_f32 v8, v8, v8
    v_and_b32 v8, 0xffff0000, v8
    v_cvt_pk_bf16_f32 v9, v9, v9
    v_and_b32 v9, 0xffff0000, v9
    v_mul_f32 v16, s19, v25
    v_exp_f32 v16, v16
    s_nop 0
    v_add_f32 v16, 1.0, v16
    v_rcp_f32 v16, v16
    s_nop 0
    v_cvt_pk_bf16_f32 v16, v16, v16
    v_and_b32 v16, 0xffff0000, v16
    v_mul_f32 v9, v9, v16
    v_cvt_pk_bf16_f32 v9, v9, v9
    v_and_b32 v9, 0xffff0000, v9
    v_cvt_pk_bf16_f32 v10, v10, v10
    v_and_b32 v10, 0xffff0000, v10
    v_mul_f32 v16, s19, v26
    v_exp_f32 v16, v16
    s_nop 0
    v_add_f32 v16, 1.0, v16
    v_rcp_f32 v16, v16
    s_nop 0
    v_cvt_pk_bf16_f32 v16, v16, v16
    v_and_b32 v16, 0xffff0000, v16
    v_mul_f32 v10, v10, v16
    v_cvt_pk_bf16_f32 v10, v10, v10
    v_and_b32 v10, 0xffff0000, v10
    v_cvt_pk_bf16_f32 v11, v11, v11
    v_and_b32 v11, 0xffff0000, v11
    v_mul_f32 v16, s19, v27
    v_exp_f32 v16, v16
    s_nop 0
    v_add_f32 v16, 1.0, v16
    v_rcp_f32 v16, v16
    s_nop 0
    v_cvt_pk_bf16_f32 v16, v16, v16
    v_and_b32 v16, 0xffff0000, v16
    v_mul_f32 v11, v11, v16
    v_cvt_pk_bf16_f32 v11, v11, v11
    v_and_b32 v11, 0xffff0000, v11
    v_mul_u32_u24 v4, 10240, v5
    v_and_b32 v6, 15, v2
    v_lshl_add_u32 v4, v6, 2, v4
    s_lshl_b32 s21, s20, 6
    s_add_u32 s21, s21, 5505024
    s_mov_b64 exec, 0xffffffff
    s_add_u32 s22, s21, 0
    buffer_store_dword v8, v4, s[4:7], s22 offen
    s_add_u32 s22, s21, 2560
    buffer_store_dword v9, v4, s[4:7], s22 offen
    s_add_u32 s22, s21, 5120
    buffer_store_dword v10, v4, s[4:7], s22 offen
    s_add_u32 s22, s21, 7680
    buffer_store_dword v11, v4, s[4:7], s22 offen
    s_mov_b64 exec, -1
    s_branch K5A_END
K5A_ATT:
    s_sub_u32 s2, s2, 10
    v_lshrrev_b32 v1, 6, v0
    s_nop 0
    v_readfirstlane_b32 s3, v1
    v_and_b32 v2, 63, v0
    s_mov_b32 s6, 268435456
    s_mov_b32 s7, 0x00020000
    v_lshlrev_b32 v1, 4, v2
    v_lshlrev_b32 v3, 3, v2
    s_lshr_b32 s16, s2, 3
    s_and_b32 s17, s2, 7
    s_lshl_b32 s17, s17, 2
    s_add_u32 s17, s17, s3
    s_lshl_b32 s18, s16, 6
    s_add_u32 s18, s18, s17
    s_lshl_b32 s18, s18, 12
    s_lshl_b32 s19, s16, 5
    s_add_u32 s19, s19, s17
    s_lshl_b32 s20, s19, 12
    s_lshl_b32 s21, s19, 13
    s_waitcnt lgkmcnt(0)
    s_add_u32 s22, s18, 35651584
    buffer_load_dwordx4 v[16:19], v1, s[4:7], s22 offen offset:0
    buffer_load_dwordx4 v[20:23], v1, s[4:7], s22 offen offset:1024
    buffer_load_dwordx4 v[24:27], v1, s[4:7], s22 offen offset:2048
    buffer_load_dwordx4 v[28:31], v1, s[4:7], s22 offen offset:3072
    s_add_u32 s22, s18, 35782656
    buffer_load_dwordx4 v[32:35], v1, s[4:7], s22 offen offset:0
    buffer_load_dwordx4 v[36:39], v1, s[4:7], s22 offen offset:1024
    buffer_load_dwordx4 v[40:43], v1, s[4:7], s22 offen offset:2048
    buffer_load_dwordx4 v[44:47], v1, s[4:7], s22 offen offset:3072
    s_add_u32 s22, s18, 52428800
    buffer_load_dwordx4 v[48:51], v1, s[4:7], s22 offen offset:0
    buffer_load_dwordx4 v[52:55], v1, s[4:7], s22 offen offset:1024
    buffer_load_dwordx4 v[56:59], v1, s[4:7], s22 offen offset:2048
    buffer_load_dwordx4 v[60:63], v1, s[4:7], s22 offen offset:3072
    s_add_u32 s22, s18, 52559872
    buffer_load_dwordx4 v[64:67], v1, s[4:7], s22 offen offset:0
    buffer_load_dwordx4 v[68:71], v1, s[4:7], s22 offen offset:1024
    buffer_load_dwordx4 v[72:75], v1, s[4:7], s22 offen offset:2048
    buffer_load_dwordx4 v[76:79], v1, s[4:7], s22 offen offset:3072
    s_add_u32 s22, s20, 102760448
    buffer_load_dwordx4 v[80:83], v1, s[4:7], s22 offen offset:0
    buffer_load_dwordx4 v[84:87], v1, s[4:7], s22 offen offset:1024
    buffer_load_dwordx4 v[88:91], v1, s[4:7], s22 offen offset:2048
    buffer_load_dwordx4 v[92:95], v1, s[4:7], s22 offen offset:3072
    s_add_u32 s22, s21, 69206016
    buffer_load_dwordx4 v[96:99], v1, s[4:7], s22 offen
    s_add_u32 s22, s21, 69207040
    buffer_load_dwordx4 v[100:103], v1, s[4:7], s22 offen
    s_add_u32 s22, s21, 69208064
    buffer_load_dwordx4 v[104:107], v1, s[4:7], s22 offen
    s_add_u32 s22, s21, 69209088
    buffer_load_dwordx4 v[108:111], v1, s[4:7], s22 offen
    s_add_u32 s22, s21, 69210112
    buffer_load_dwordx4 v[112:115], v1, s[4:7], s22 offen
    s_add_u32 s22, s21, 69211136
    buffer_load_dwordx4 v[116:119], v1, s[4:7], s22 offen
    s_add_u32 s22, s21, 69212160
    buffer_load_dwordx4 v[120:123], v1, s[4:7], s22 offen
    s_add_u32 s22, s21, 69213184
    buffer_load_dwordx4 v[124:127], v1, s[4:7], s22 offen
    s_add_u32 s22, s20, 111149056
    buffer_load_dwordx2 v[128:129], v3, s[4:7], s22 offen offset:0
    buffer_load_dwordx2 v[130:131], v3, s[4:7], s22 offen offset:512
    buffer_load_dwordx2 v[132:133], v3, s[4:7], s22 offen offset:1024
    buffer_load_dwordx2 v[134:135], v3, s[4:7], s22 offen offset:1536
    buffer_load_dwordx2 v[136:137], v3, s[4:7], s22 offen offset:2048
    buffer_load_dwordx2 v[138:139], v3, s[4:7], s22 offen offset:2560
    buffer_load_dwordx2 v[140:141], v3, s[4:7], s22 offen offset:3072
    buffer_load_dwordx2 v[142:143], v3, s[4:7], s22 offen offset:3584
    v_lshrrev_b32 v4, 4, v2
    v_lshlrev_b32 v4, 2, v4
    v_and_b32 v5, 15, v2
    v_add_u32 v6, 0, v4
    v_cmp_le_u32 s[30:31], v6, v5
    v_add_u32 v6, 1, v4
    v_cmp_le_u32 s[32:33], v6, v5
    v_add_u32 v6, 2, v4
    v_cmp_le_u32 s[34:35], v6, v5
    v_add_u32 v6, 3, v4
    v_cmp_le_u32 s[36:37], v6, v5
    s_mov_b32 s38, -1
    s_mov_b32 s39, 0
    s_mov_b32 s40, 0x3db50000
    s_mov_b32 s41, 0x3fb8aa3b
    s_waitcnt vmcnt(16)
    v_mfma_f32_16x16x32_bf16 v[144:147], v[80:83], v[16:19], 0
    v_mfma_f32_16x16x32_bf16 v[144:147], v[84:87], v[20:23], v[144:147]
    v_mfma_f32_16x16x32_bf16 v[144:147], v[88:91], v[24:27], v[144:147]
    v_mfma_f32_16x16x32_bf16 v[144:147], v[92:95], v[28:31], v[144:147]
    v_mfma_f32_16x16x32_bf16 v[148:151], v[48:51], v[16:19], 0
    v_mfma_f32_16x16x32_bf16 v[148:151], v[52:55], v[20:23], v[148:151]
    v_mfma_f32_16x16x32_bf16 v[148:151], v[56:59], v[24:27], v[148:151]
    v_mfma_f32_16x16x32_bf16 v[148:151], v[60:63], v[28:31], v[148:151]
    v_mfma_f32_16x16x32_bf16 v[156:159], v[80:83], v[32:35], 0
    v_mfma_f32_16x16x32_bf16 v[156:159], v[84:87], v[36:39], v[156:159]
    v_mfma_f32_16x16x32_bf16 v[156:159], v[88:91], v[40:43], v[156:159]
    v_mfma_f32_16x16x32_bf16 v[156:159], v[92:95], v[44:47], v[156:159]
    v_mfma_f32_16x16x32_bf16 v[160:163], v[48:51], v[32:35], 0
    v_mfma_f32_16x16x32_bf16 v[160:163], v[52:55], v[36:39], v[160:163]
    v_mfma_f32_16x16x32_bf16 v[160:163], v[56:59], v[40:43], v[160:163]
    v_mfma_f32_16x16x32_bf16 v[160:163], v[60:63], v[44:47], v[160:163]
    v_mfma_f32_16x16x32_bf16 v[164:167], v[64:67], v[32:35], 0
    v_mfma_f32_16x16x32_bf16 v[164:167], v[68:71], v[36:39], v[164:167]
    v_mfma_f32_16x16x32_bf16 v[164:167], v[72:75], v[40:43], v[164:167]
    v_mfma_f32_16x16x32_bf16 v[164:167], v[76:79], v[44:47], v[164:167]
    v_mov_b32 v8, 0xce6e6b28
    v_cvt_pk_bf16_f32 v9, v144, v145
    v_lshlrev_b32 v144, 16, v9
    v_and_b32 v145, 0xffff0000, v9
    v_mul_f32 v144, s40, v144
    v_mul_f32 v145, s40, v145
    v_cvt_pk_bf16_f32 v9, v144, v145
    v_lshlrev_b32 v144, 16, v9
    v_and_b32 v145, 0xffff0000, v9
    v_cvt_pk_bf16_f32 v9, v146, v147
    v_lshlrev_b32 v146, 16, v9
    v_and_b32 v147, 0xffff0000, v9
    v_mul_f32 v146, s40, v146
    v_mul_f32 v147, s40, v147
    v_cvt_pk_bf16_f32 v9, v146, v147
    v_lshlrev_b32 v146, 16, v9
    v_and_b32 v147, 0xffff0000, v9
    v_cvt_pk_bf16_f32 v9, v148, v149
    v_lshlrev_b32 v148, 16, v9
    v_and_b32 v149, 0xffff0000, v9
    v_mul_f32 v148, s40, v148
    v_mul_f32 v149, s40, v149
    v_cvt_pk_bf16_f32 v9, v148, v149
    v_lshlrev_b32 v148, 16, v9
    v_and_b32 v149, 0xffff0000, v9
    v_cvt_pk_bf16_f32 v9, v150, v151
    v_lshlrev_b32 v150, 16, v9
    v_and_b32 v151, 0xffff0000, v9
    v_mul_f32 v150, s40, v150
    v_mul_f32 v151, s40, v151
    v_cvt_pk_bf16_f32 v9, v150, v151
    v_lshlrev_b32 v150, 16, v9
    v_and_b32 v151, 0xffff0000, v9
    v_cndmask_b32 v144, v8, v144, s[38:39]
    v_cndmask_b32 v145, v8, v145, s[38:39]
    v_cndmask_b32 v146, v8, v146, s[38:39]
    v_cndmask_b32 v147, v8, v147, s[38:39]
    v_cndmask_b32 v148, v8, v148, s[30:31]
    v_cndmask_b32 v149, v8, v149, s[32:33]
    v_cndmask_b32 v150, v8, v150, s[34:35]
    v_cndmask_b32 v151, v8, v151, s[36:37]
    v_max_f32 v10, v144, v145
    v_max3_f32 v10, v10, v146, v147
    v_max3_f32 v10, v10, v148, v149
    v_max3_f32 v10, v10, v150, v151
    v_mov_b32 v11, v10
    s_nop 1
    v_permlane32_swap_b32 v10, v11
    v_max_f32 v10, v10, v11
    v_mov_b32 v11, v10
    s_nop 1
    v_permlane16_swap_b32 v10, v11
    v_max_f32 v10, v10, v11
    v_sub_f32 v144, v144, v10
    v_mul_f32 v144, s41, v144
    v_exp_f32 v144, v144
    v_sub_f32 v145, v145, v10
    v_mul_f32 v145, s41, v145
    v_exp_f32 v145, v145
    v_sub_f32 v146, v146, v10
    v_mul_f32 v146, s41, v146
    v_exp_f32 v146, v146
    v_sub_f32 v147, v147, v10
    v_mul_f32 v147, s41, v147
    v_exp_f32 v147, v147
    v_sub_f32 v148, v148, v10
    v_mul_f32 v148, s41, v148
    v_exp_f32 v148, v148
    v_sub_f32 v149, v149, v10
    v_mul_f32 v149, s41, v149
    v_exp_f32 v149, v149
    v_sub_f32 v150, v150, v10
    v_mul_f32 v150, s41, v150
    v_exp_f32 v150, v150
    v_sub_f32 v151, v151, v10
    v_mul_f32 v151, s41, v151
    v_exp_f32 v151, v151
    v_add_f32 v10, v144, v145
    v_add_f32 v10, v10, v146
    v_add_f32 v10, v10, v147
    v_add_f32 v10, v10, v148
    v_add_f32 v10, v10, v149
    v_add_f32 v10, v10, v150
    v_add_f32 v10, v10, v151
    v_mov_b32 v11, v10
    s_nop 1
    v_permlane32_swap_b32 v10, v11
    v_add_f32 v10, v10, v11
    v_mov_b32 v11, v10
    s_nop 1
    v_permlane16_swap_b32 v10, v11
    v_add_f32 v10, v10, v11
    v_rcp_f32 v10, v10
    s_nop 0
    v_mul_f32 v144, v144, v10
    v_mul_f32 v145, v145, v10
    v_mul_f32 v146, v146, v10
    v_mul_f32 v147, v147, v10
    v_mul_f32 v148, v148, v10
    v_mul_f32 v149, v149, v10
    v_mul_f32 v150, v150, v10
    v_mul_f32 v151, v151, v10
    v_cvt_pk_bf16_f32 v168, v144, v145
    v_cvt_pk_bf16_f32 v169, v146, v147
    v_cvt_pk_bf16_f32 v172, v148, v149
    v_cvt_pk_bf16_f32 v173, v150, v151
    v_mov_b32 v174, 0
    v_mov_b32 v175, 0
    v_cvt_pk_bf16_f32 v9, v156, v157
    v_lshlrev_b32 v156, 16, v9
    v_and_b32 v157, 0xffff0000, v9
    v_mul_f32 v156, s40, v156
    v_mul_f32 v157, s40, v157
    v_cvt_pk_bf16_f32 v9, v156, v157
    v_lshlrev_b32 v156, 16, v9
    v_and_b32 v157, 0xffff0000, v9
    v_cvt_pk_bf16_f32 v9, v158, v159
    v_lshlrev_b32 v158, 16, v9
    v_and_b32 v159, 0xffff0000, v9
    v_mul_f32 v158, s40, v158
    v_mul_f32 v159, s40, v159
    v_cvt_pk_bf16_f32 v9, v158, v159
    v_lshlrev_b32 v158, 16, v9
    v_and_b32 v159, 0xffff0000, v9
    v_cvt_pk_bf16_f32 v9, v160, v161
    v_lshlrev_b32 v160, 16, v9
    v_and_b32 v161, 0xffff0000, v9
    v_mul_f32 v160, s40, v160
    v_mul_f32 v161, s40, v161
    v_cvt_pk_bf16_f32 v9, v160, v161
    v_lshlrev_b32 v160, 16, v9
    v_and_b32 v161, 0xffff0000, v9
    v_cvt_pk_bf16_f32 v9, v162, v163
    v_lshlrev_b32 v162, 16, v9
    v_and_b32 v163, 0xffff0000, v9
    v_mul_f32 v162, s40, v162
    v_mul_f32 v163, s40, v163
    v_cvt_pk_bf16_f32 v9, v162, v163
    v_lshlrev_b32 v162, 16, v9
    v_and_b32 v163, 0xffff0000, v9
    v_cvt_pk_bf16_f32 v9, v164, v165
    v_lshlrev_b32 v164, 16, v9
    v_and_b32 v165, 0xffff0000, v9
    v_mul_f32 v164, s40, v164
    v_mul_f32 v165, s40, v165
    v_cvt_pk_bf16_f32 v9, v164, v165
    v_lshlrev_b32 v164, 16, v9
    v_and_b32 v165, 0xffff0000, v9
    v_cvt_pk_bf16_f32 v9, v166, v167
    v_lshlrev_b32 v166, 16, v9
    v_and_b32 v167, 0xffff0000, v9
    v_mul_f32 v166, s40, v166
    v_mul_f32 v167, s40, v167
    v_cvt_pk_bf16_f32 v9, v166, v167
    v_lshlrev_b32 v166, 16, v9
    v_and_b32 v167, 0xffff0000, v9
    v_cndmask_b32 v156, v8, v156, s[38:39]
    v_cndmask_b32 v157, v8, v157, s[38:39]
    v_cndmask_b32 v158, v8, v158, s[38:39]
    v_cndmask_b32 v159, v8, v159, s[38:39]
    v_cndmask_b32 v164, v8, v164, s[30:31]
    v_cndmask_b32 v165, v8, v165, s[32:33]
    v_cndmask_b32 v166, v8, v166, s[34:35]
    v_cndmask_b32 v167, v8, v167, s[36:37]
    v_max_f32 v10, v156, v157
    v_max3_f32 v10, v10, v158, v159
    v_max3_f32 v10, v10, v160, v161
    v_max3_f32 v10, v10, v162, v163
    v_max3_f32 v10, v10, v164, v165
    v_max3_f32 v10, v10, v166, v167
    v_mov_b32 v11, v10
    s_nop 1
    v_permlane32_swap_b32 v10, v11
    v_max_f32 v10, v10, v11
    v_mov_b32 v11, v10
    s_nop 1
    v_permlane16_swap_b32 v10, v11
    v_max_f32 v10, v10, v11
    v_sub_f32 v156, v156, v10
    v_mul_f32 v156, s41, v156
    v_exp_f32 v156, v156
    v_sub_f32 v157, v157, v10
    v_mul_f32 v157, s41, v157
    v_exp_f32 v157, v157
    v_sub_f32 v158, v158, v10
    v_mul_f32 v158, s41, v158
    v_exp_f32 v158, v158
    v_sub_f32 v159, v159, v10
    v_mul_f32 v159, s41, v159
    v_exp_f32 v159, v159
    v_sub_f32 v160, v160, v10
    v_mul_f32 v160, s41, v160
    v_exp_f32 v160, v160
    v_sub_f32 v161, v161, v10
    v_mul_f32 v161, s41, v161
    v_exp_f32 v161, v161
    v_sub_f32 v162, v162, v10
    v_mul_f32 v162, s41, v162
    v_exp_f32 v162, v162
    v_sub_f32 v163, v163, v10
    v_mul_f32 v163, s41, v163
    v_exp_f32 v163, v163
    v_sub_f32 v164, v164, v10
    v_mul_f32 v164, s41, v164
    v_exp_f32 v164, v164
    v_sub_f32 v165, v165, v10
    v_mul_f32 v165, s41, v165
    v_exp_f32 v165, v165
    v_sub_f32 v166, v166, v10
    v_mul_f32 v166, s41, v166
    v_exp_f32 v166, v166
    v_sub_f32 v167, v167, v10
    v_mul_f32 v167, s41, v167
    v_exp_f32 v167, v167
    v_add_f32 v10, v156, v157
    v_add_f32 v10, v10, v158
    v_add_f32 v10, v10, v159
    v_add_f32 v10, v10, v160
    v_add_f32 v10, v10, v161
    v_add_f32 v10, v10, v162
    v_add_f32 v10, v10, v163
    v_add_f32 v10, v10, v164
    v_add_f32 v10, v10, v165
    v_add_f32 v10, v10, v166
    v_add_f32 v10, v10, v167
    v_mov_b32 v11, v10
    s_nop 1
    v_permlane32_swap_b32 v10, v11
    v_add_f32 v10, v10, v11
    v_mov_b32 v11, v10
    s_nop 1
    v_permlane16_swap_b32 v10, v11
    v_add_f32 v10, v10, v11
    v_rcp_f32 v10, v10
    s_nop 0
    v_mul_f32 v156, v156, v10
    v_mul_f32 v157, v157, v10
    v_mul_f32 v158, v158, v10
    v_mul_f32 v159, v159, v10
    v_mul_f32 v160, v160, v10
    v_mul_f32 v161, v161, v10
    v_mul_f32 v162, v162, v10
    v_mul_f32 v163, v163, v10
    v_mul_f32 v164, v164, v10
    v_mul_f32 v165, v165, v10
    v_mul_f32 v166, v166, v10
    v_mul_f32 v167, v167, v10
    v_cvt_pk_bf16_f32 v176, v156, v157
    v_cvt_pk_bf16_f32 v177, v158, v159
    v_cvt_pk_bf16_f32 v180, v160, v161
    v_cvt_pk_bf16_f32 v181, v162, v163
    v_cvt_pk_bf16_f32 v182, v164, v165
    v_cvt_pk_bf16_f32 v183, v166, v167
    s_waitcnt vmcnt(0)
    v_mfma_f32_16x16x32_bf16 v[184:187], v[96:99], v[172:175], 0
    v_mfma_f32_16x16x32_bf16 v[188:191], v[100:103], v[172:175], 0
    v_mfma_f32_16x16x32_bf16 v[192:195], v[104:107], v[172:175], 0
    v_mfma_f32_16x16x32_bf16 v[196:199], v[108:111], v[172:175], 0
    v_mfma_f32_16x16x32_bf16 v[200:203], v[112:115], v[172:175], 0
    v_mfma_f32_16x16x32_bf16 v[204:207], v[116:119], v[172:175], 0
    v_mfma_f32_16x16x32_bf16 v[208:211], v[120:123], v[172:175], 0
    v_mfma_f32_16x16x32_bf16 v[212:215], v[124:127], v[172:175], 0
    v_mfma_f32_16x16x16_bf16 v[184:187], v[128:129], v[168:169], v[184:187]
    v_mfma_f32_16x16x16_bf16 v[188:191], v[130:131], v[168:169], v[188:191]
    v_mfma_f32_16x16x16_bf16 v[192:195], v[132:133], v[168:169], v[192:195]
    v_mfma_f32_16x16x16_bf16 v[196:199], v[134:135], v[168:169], v[196:199]
    v_mfma_f32_16x16x16_bf16 v[200:203], v[136:137], v[168:169], v[200:203]
    v_mfma_f32_16x16x16_bf16 v[204:207], v[138:139], v[168:169], v[204:207]
    v_mfma_f32_16x16x16_bf16 v[208:211], v[140:141], v[168:169], v[208:211]
    v_mfma_f32_16x16x16_bf16 v[212:215], v[142:143], v[168:169], v[212:215]
    v_mfma_f32_16x16x32_bf16 v[216:219], v[96:99], v[180:183], 0
    v_mfma_f32_16x16x32_bf16 v[220:223], v[100:103], v[180:183], 0
    v_mfma_f32_16x16x32_bf16 v[224:227], v[104:107], v[180:183], 0
    v_mfma_f32_16x16x32_bf16 v[228:231], v[108:111], v[180:183], 0
    v_mfma_f32_16x16x32_bf16 v[232:235], v[112:115], v[180:183], 0
    v_mfma_f32_16x16x32_bf16 v[236:239], v[116:119], v[180:183], 0
    v_mfma_f32_16x16x32_bf16 v[240:243], v[120:123], v[180:183], 0
    v_mfma_f32_16x16x32_bf16 v[244:247], v[124:127], v[180:183], 0
    v_mfma_f32_16x16x16_bf16 v[216:219], v[128:129], v[176:177], v[216:219]
    v_mfma_f32_16x16x16_bf16 v[220:223], v[130:131], v[176:177], v[220:223]
    v_mfma_f32_16x16x16_bf16 v[224:227], v[132:133], v[176:177], v[224:227]
    v_mfma_f32_16x16x16_bf16 v[228:231], v[134:135], v[176:177], v[228:231]
    v_mfma_f32_16x16x16_bf16 v[232:235], v[136:137], v[176:177], v[232:235]
    v_mfma_f32_16x16x16_bf16 v[236:239], v[138:139], v[176:177], v[236:239]
    v_mfma_f32_16x16x16_bf16 v[240:243], v[140:141], v[176:177], v[240:243]
    v_mfma_f32_16x16x16_bf16 v[244:247], v[142:143], v[176:177], v[244:247]
    s_lshl_b32 s22, s16, 8
    s_lshl_b32 s23, s17, 2
    s_add_u32 s22, s22, s23
    s_lshl_b32 s22, s22, 10
    s_add_u32 s22, s22, 85983232
    v_cvt_pk_bf16_f32 v16, v184, v185
    v_cvt_pk_bf16_f32 v17, v186, v187
    v_cvt_pk_bf16_f32 v18, v188, v189
    v_cvt_pk_bf16_f32 v19, v190, v191
    s_add_u32 s23, s22, 0
    buffer_store_dwordx4 v[16:19], v1, s[4:7], s23 offen
    v_cvt_pk_bf16_f32 v20, v192, v193
    v_cvt_pk_bf16_f32 v21, v194, v195
    v_cvt_pk_bf16_f32 v22, v196, v197
    v_cvt_pk_bf16_f32 v23, v198, v199
    s_add_u32 s23, s22, 1024
    buffer_store_dwordx4 v[20:23], v1, s[4:7], s23 offen
    v_cvt_pk_bf16_f32 v24, v200, v201
    v_cvt_pk_bf16_f32 v25, v202, v203
    v_cvt_pk_bf16_f32 v26, v204, v205
    v_cvt_pk_bf16_f32 v27, v206, v207
    s_add_u32 s23, s22, 2048
    buffer_store_dwordx4 v[24:27], v1, s[4:7], s23 offen
    v_cvt_pk_bf16_f32 v28, v208, v209
    v_cvt_pk_bf16_f32 v29, v210, v211
    v_cvt_pk_bf16_f32 v30, v212, v213
    v_cvt_pk_bf16_f32 v31, v214, v215
    s_add_u32 s23, s22, 3072
    buffer_store_dwordx4 v[28:31], v1, s[4:7], s23 offen
    v_cvt_pk_bf16_f32 v32, v216, v217
    v_cvt_pk_bf16_f32 v33, v218, v219
    v_cvt_pk_bf16_f32 v34, v220, v221
    v_cvt_pk_bf16_f32 v35, v222, v223
    s_add_u32 s23, s22, 131072
    buffer_store_dwordx4 v[32:35], v1, s[4:7], s23 offen
    v_cvt_pk_bf16_f32 v36, v224, v225
    v_cvt_pk_bf16_f32 v37, v226, v227
    v_cvt_pk_bf16_f32 v38, v228, v229
    v_cvt_pk_bf16_f32 v39, v230, v231
    s_add_u32 s23, s22, 132096
    buffer_store_dwordx4 v[36:39], v1, s[4:7], s23 offen
    v_cvt_pk_bf16_f32 v40, v232, v233
    v_cvt_pk_bf16_f32 v41, v234, v235
    v_cvt_pk_bf16_f32 v42, v236, v237
    v_cvt_pk_bf16_f32 v43, v238, v239
    s_add_u32 s23, s22, 133120
    buffer_store_dwordx4 v[40:43], v1, s[4:7], s23 offen
    v_cvt_pk_bf16_f32 v44, v240, v241
    v_cvt_pk_bf16_f32 v45, v242, v243
    v_cvt_pk_bf16_f32 v46, v244, v245
    v_cvt_pk_bf16_f32 v47, v246, v247
    s_add_u32 s23, s22, 134144
    buffer_store_dwordx4 v[44:47], v1, s[4:7], s23 offen
K5A_END:
    s_endpgm
.text
.globl k5b_kernel
.p2align 8
.type k5b_kernel,@function
k5b_kernel:
    s_load_dwordx2 s[4:5], s[0:1], 112
    s_load_dwordx2 s[8:9], s[0:1], 0
    s_load_dwordx2 s[12:13], s[0:1], 96
    s_cmp_ge_u32 s2, 256
    s_cbranch_scc1 K5B_END
    v_lshrrev_b32 v1, 6, v0
    v_and_b32 v2, 63, v0
    v_readfirstlane_b32 s3, v1
    s_mov_b32 s6, 268435456
    s_mov_b32 s7, 0x00020000
    s_mov_b32 s10, 2621440
    s_mov_b32 s11, 0x00020000
    s_mov_b32 s14, 2621440
    s_mov_b32 s15, 0x00020000
    s_and_b32 s19, s2, 7
    s_lshr_b32 s18, s2, 3
    v_lshlrev_b32 v3, 4, v2
    s_lshl_b32 s20, s18, 19
    s_lshl_b32 s21, s3, 10
    s_add_u32 s20, s20, s21
    s_add_u32 s20, s20, 85983232
    s_mul_i32 s22, s19, 655360
    s_add_u32 s22, s22, s21
    s_add_u32 s22, s22, 22020096
    v_mov_b32 v80, 0
    v_mov_b32 v81, 0
    v_mov_b32 v82, 0
    v_mov_b32 v83, 0
    v_mov_b32 v84, 0
    v_mov_b32 v85, 0
    v_mov_b32 v86, 0
    v_mov_b32 v87, 0
    v_mov_b32 v88, 0
    v_mov_b32 v89, 0
    v_mov_b32 v90, 0
    v_mov_b32 v91, 0
    v_mov_b32 v92, 0
    v_mov_b32 v93, 0
    v_mov_b32 v94, 0
    v_mov_b32 v95, 0
    v_mov_b32 v96, 0
    v_mov_b32 v97, 0
    v_mov_b32 v98, 0
    v_mov_b32 v99, 0
    v_mov_b32 v100, 0
    v_mov_b32 v101, 0
    v_mov_b32 v102, 0
    v_mov_b32 v103, 0
    v_mov_b32 v104, 0
    v_mov_b32 v105, 0
    v_mov_b32 v106, 0
    v_mov_b32 v107, 0
    v_mov_b32 v108, 0
    v_mov_b32 v109, 0
    v_mov_b32 v110, 0
    v_mov_b32 v111, 0
    v_mov_b32 v112, 0
    v_mov_b32 v113, 0
    v_mov_b32 v114, 0
    v_mov_b32 v115, 0
    v_mov_b32 v116, 0
    v_mov_b32 v117, 0
    v_mov_b32 v118, 0
    v_mov_b32 v119, 0
    v_mov_b32 v120, 0
    v_mov_b32 v121, 0
    v_mov_b32 v122, 0
    v_mov_b32 v123, 0
    v_mov_b32 v124, 0
    v_mov_b32 v125, 0
    v_mov_b32 v126, 0
    v_mov_b32 v127, 0
    v_mov_b32 v128, 0
    v_mov_b32 v129, 0
    v_mov_b32 v130, 0
    v_mov_b32 v131, 0
    v_mov_b32 v132, 0
    v_mov_b32 v133, 0
    v_mov_b32 v134, 0
    v_mov_b32 v135, 0
    v_mov_b32 v136, 0
    v_mov_b32 v137, 0
    v_mov_b32 v138, 0
    v_mov_b32 v139, 0
    v_mov_b32 v140, 0
    v_mov_b32 v141, 0
    v_mov_b32 v142, 0
    v_mov_b32 v143, 0
    v_mov_b32 v144, 0
    v_mov_b32 v145, 0
    v_mov_b32 v146, 0
    v_mov_b32 v147, 0
    v_mov_b32 v148, 0
    v_mov_b32 v149, 0
    v_mov_b32 v150, 0
    v_mov_b32 v151, 0
    v_mov_b32 v152, 0
    v_mov_b32 v153, 0
    v_mov_b32 v154, 0
    v_mov_b32 v155, 0
    v_mov_b32 v156, 0
    v_mov_b32 v157, 0
    v_mov_b32 v158, 0
    v_mov_b32 v159, 0
    s_waitcnt lgkmcnt(0)
    s_add_u32 s23, s20, 0
    buffer_load_dwordx4 v[8:11], v3, s[4:7], s23 offen
    s_add_u32 s23, s20, 131072
    buffer_load_dwordx4 v[12:15], v3, s[4:7], s23 offen
    s_add_u32 s23, s20, 262144
    buffer_load_dwordx4 v[16:19], v3, s[4:7], s23 offen
    s_add_u32 s23, s20, 393216
    buffer_load_dwordx4 v[20:23], v3, s[4:7], s23 offen
    s_add_u32 s23, s22, 0
    buffer_load_dwordx4 v[24:27], v3, s[4:7], s23 offen
    s_add_u32 s23, s22, 131072
    buffer_load_dwordx4 v[28:31], v3, s[4:7], s23 offen
    s_add_u32 s23, s22, 262144
    buffer_load_dwordx4 v[32:35], v3, s[4:7], s23 offen
    s_add_u32 s23, s22, 393216
    buffer_load_dwordx4 v[36:39], v3, s[4:7], s23 offen
    s_add_u32 s23, s22, 524288
    buffer_load_dwordx4 v[40:43], v3, s[4:7], s23 offen
    s_add_u32 s20, s20, 4096
    s_add_u32 s22, s22, 4096
    s_mov_b32 s29, 0
K5B_LOOP:
    s_add_u32 s23, s20, 0
    buffer_load_dwordx4 v[44:47], v3, s[4:7], s23 offen
    s_add_u32 s23, s20, 131072
    buffer_load_dwordx4 v[48:51], v3, s[4:7], s23 offen
    s_add_u32 s23, s20, 262144
    buffer_load_dwordx4 v[52:55], v3, s[4:7], s23 offen
    s_add_u32 s23, s20, 393216
    buffer_load_dwordx4 v[56:59], v3, s[4:7], s23 offen
    s_add_u32 s23, s22, 0
    buffer_load_dwordx4 v[60:63], v3, s[4:7], s23 offen
    s_add_u32 s23, s22, 131072
    buffer_load_dwordx4 v[64:67], v3, s[4:7], s23 offen
    s_add_u32 s23, s22, 262144
    buffer_load_dwordx4 v[68:71], v3, s[4:7], s23 offen
    s_add_u32 s23, s22, 393216
    buffer_load_dwordx4 v[72:75], v3, s[4:7], s23 offen
    s_add_u32 s23, s22, 524288
    buffer_load_dwordx4 v[76:79], v3, s[4:7], s23 offen
    s_add_u32 s20, s20, 4096
    s_add_u32 s22, s22, 4096
    s_waitcnt vmcnt(9)
    v_mfma_f32_16x16x32_bf16 v[80:83], v[24:27], v[8:11], v[80:83]
    v_mfma_f32_16x16x32_bf16 v[84:87], v[24:27], v[12:15], v[84:87]
    v_mfma_f32_16x16x32_bf16 v[88:91], v[24:27], v[16:19], v[88:91]
    v_mfma_f32_16x16x32_bf16 v[92:95], v[24:27], v[20:23], v[92:95]
    v_mfma_f32_16x16x32_bf16 v[96:99], v[28:31], v[8:11], v[96:99]
    v_mfma_f32_16x16x32_bf16 v[100:103], v[28:31], v[12:15], v[100:103]
    v_mfma_f32_16x16x32_bf16 v[104:107], v[28:31], v[16:19], v[104:107]
    v_mfma_f32_16x16x32_bf16 v[108:111], v[28:31], v[20:23], v[108:111]
    v_mfma_f32_16x16x32_bf16 v[112:115], v[32:35], v[8:11], v[112:115]
    v_mfma_f32_16x16x32_bf16 v[116:119], v[32:35], v[12:15], v[116:119]
    v_mfma_f32_16x16x32_bf16 v[120:123], v[32:35], v[16:19], v[120:123]
    v_mfma_f32_16x16x32_bf16 v[124:127], v[32:35], v[20:23], v[124:127]
    v_mfma_f32_16x16x32_bf16 v[128:131], v[36:39], v[8:11], v[128:131]
    v_mfma_f32_16x16x32_bf16 v[132:135], v[36:39], v[12:15], v[132:135]
    v_mfma_f32_16x16x32_bf16 v[136:139], v[36:39], v[16:19], v[136:139]
    v_mfma_f32_16x16x32_bf16 v[140:143], v[36:39], v[20:23], v[140:143]
    v_mfma_f32_16x16x32_bf16 v[144:147], v[40:43], v[8:11], v[144:147]
    v_mfma_f32_16x16x32_bf16 v[148:151], v[40:43], v[12:15], v[148:151]
    v_mfma_f32_16x16x32_bf16 v[152:155], v[40:43], v[16:19], v[152:155]
    v_mfma_f32_16x16x32_bf16 v[156:159], v[40:43], v[20:23], v[156:159]
    s_add_u32 s23, s20, 0
    buffer_load_dwordx4 v[8:11], v3, s[4:7], s23 offen
    s_add_u32 s23, s20, 131072
    buffer_load_dwordx4 v[12:15], v3, s[4:7], s23 offen
    s_add_u32 s23, s20, 262144
    buffer_load_dwordx4 v[16:19], v3, s[4:7], s23 offen
    s_add_u32 s23, s20, 393216
    buffer_load_dwordx4 v[20:23], v3, s[4:7], s23 offen
    s_add_u32 s23, s22, 0
    buffer_load_dwordx4 v[24:27], v3, s[4:7], s23 offen
    s_add_u32 s23, s22, 131072
    buffer_load_dwordx4 v[28:31], v3, s[4:7], s23 offen
    s_add_u32 s23, s22, 262144
    buffer_load_dwordx4 v[32:35], v3, s[4:7], s23 offen
    s_add_u32 s23, s22, 393216
    buffer_load_dwordx4 v[36:39], v3, s[4:7], s23 offen
    s_add_u32 s23, s22, 524288
    buffer_load_dwordx4 v[40:43], v3, s[4:7], s23 offen
    s_add_u32 s20, s20, 4096
    s_add_u32 s22, s22, 4096
    s_waitcnt vmcnt(9)
    v_mfma_f32_16x16x32_bf16 v[80:83], v[60:63], v[44:47], v[80:83]
    v_mfma_f32_16x16x32_bf16 v[84:87], v[60:63], v[48:51], v[84:87]
    v_mfma_f32_16x16x32_bf16 v[88:91], v[60:63], v[52:55], v[88:91]
    v_mfma_f32_16x16x32_bf16 v[92:95], v[60:63], v[56:59], v[92:95]
    v_mfma_f32_16x16x32_bf16 v[96:99], v[64:67], v[44:47], v[96:99]
    v_mfma_f32_16x16x32_bf16 v[100:103], v[64:67], v[48:51], v[100:103]
    v_mfma_f32_16x16x32_bf16 v[104:107], v[64:67], v[52:55], v[104:107]
    v_mfma_f32_16x16x32_bf16 v[108:111], v[64:67], v[56:59], v[108:111]
    v_mfma_f32_16x16x32_bf16 v[112:115], v[68:71], v[44:47], v[112:115]
    v_mfma_f32_16x16x32_bf16 v[116:119], v[68:71], v[48:51], v[116:119]
    v_mfma_f32_16x16x32_bf16 v[120:123], v[68:71], v[52:55], v[120:123]
    v_mfma_f32_16x16x32_bf16 v[124:127], v[68:71], v[56:59], v[124:127]
    v_mfma_f32_16x16x32_bf16 v[128:131], v[72:75], v[44:47], v[128:131]
    v_mfma_f32_16x16x32_bf16 v[132:135], v[72:75], v[48:51], v[132:135]
    v_mfma_f32_16x16x32_bf16 v[136:139], v[72:75], v[52:55], v[136:139]
    v_mfma_f32_16x16x32_bf16 v[140:143], v[72:75], v[56:59], v[140:143]
    v_mfma_f32_16x16x32_bf16 v[144:147], v[76:79], v[44:47], v[144:147]
    v_mfma_f32_16x16x32_bf16 v[148:151], v[76:79], v[48:51], v[148:151]
    v_mfma_f32_16x16x32_bf16 v[152:155], v[76:79], v[52:55], v[152:155]
    v_mfma_f32_16x16x32_bf16 v[156:159], v[76:79], v[56:59], v[156:159]
    s_add_u32 s29, s29, 1
    s_cmp_lt_u32 s29, 16
    s_cbranch_scc1 K5B_LOOP
    s_waitcnt vmcnt(0)
    s_nop 7
    s_mul_i32 s23, s3, 20480
    v_add_u32 v4, s23, v3
    ds_write_b128 v4, v[80:83] offset:0
    ds_write_b128 v4, v[84:87] offset:1024
    ds_write_b128 v4, v[88:91] offset:2048
    ds_write_b128 v4, v[92:95] offset:3072
    ds_write_b128 v4, v[96:99] offset:4096
    ds_write_b128 v4, v[100:103] offset:5120
    ds_write_b128 v4, v[104:107] offset:6144
    ds_write_b128 v4, v[108:111] offset:7168
    ds_write_b128 v4, v[112:115] offset:8192
    ds_write_b128 v4, v[116:119] offset:9216
    ds_write_b128 v4, v[120:123] offset:10240
    ds_write_b128 v4, v[124:127] offset:11264
    ds_write_b128 v4, v[128:131] offset:12288
    ds_write_b128 v4, v[132:135] offset:13312
    ds_write_b128 v4, v[136:139] offset:14336
    ds_write_b128 v4, v[140:143] offset:15360
    ds_write_b128 v4, v[144:147] offset:16384
    ds_write_b128 v4, v[148:151] offset:17408
    ds_write_b128 v4, v[152:155] offset:18432
    ds_write_b128 v4, v[156:159] offset:19456
    s_waitcnt lgkmcnt(0)
    s_barrier
    s_lshl_b32 s23, s3, 10
    v_add_u32 v4, s23, v3
    v_add_u32 v5, 40960, v4
    ds_read_b128 v[8:11], v4 offset:0
    ds_read_b128 v[12:15], v4 offset:20480
    ds_read_b128 v[16:19], v5 offset:0
    ds_read_b128 v[20:23], v5 offset:20480
    s_waitcnt lgkmcnt(2)
    v_add_f32 v8, v8, v12
    s_waitcnt lgkmcnt(0)
    v_add_f32 v16, v16, v20
    v_add_f32 v80, v8, v16
    v_add_f32 v9, v9, v13
    v_add_f32 v17, v17, v21
    v_add_f32 v81, v9, v17
    v_add_f32 v10, v10, v14
    v_add_f32 v18, v18, v22
    v_add_f32 v82, v10, v18
    v_add_f32 v11, v11, v15
    v_add_f32 v19, v19, v23
    v_add_f32 v83, v11, v19
    ds_read_b128 v[8:11], v4 offset:4096
    ds_read_b128 v[12:15], v4 offset:24576
    ds_read_b128 v[16:19], v5 offset:4096
    ds_read_b128 v[20:23], v5 offset:24576
    s_waitcnt lgkmcnt(2)
    v_add_f32 v8, v8, v12
    s_waitcnt lgkmcnt(0)
    v_add_f32 v16, v16, v20
    v_add_f32 v84, v8, v16
    v_add_f32 v9, v9, v13
    v_add_f32 v17, v17, v21
    v_add_f32 v85, v9, v17
    v_add_f32 v10, v10, v14
    v_add_f32 v18, v18, v22
    v_add_f32 v86, v10, v18
    v_add_f32 v11, v11, v15
    v_add_f32 v19, v19, v23
    v_add_f32 v87, v11, v19
    ds_read_b128 v[8:11], v4 offset:8192
    ds_read_b128 v[12:15], v4 offset:28672
    ds_read_b128 v[16:19], v5 offset:8192
    ds_read_b128 v[20:23], v5 offset:28672
    s_waitcnt lgkmcnt(2)
    v_add_f32 v8, v8, v12
    s_waitcnt lgkmcnt(0)
    v_add_f32 v16, v16, v20
    v_add_f32 v88, v8, v16
    v_add_f32 v9, v9, v13
    v_add_f32 v17, v17, v21
    v_add_f32 v89, v9, v17
    v_add_f32 v10, v10, v14
    v_add_f32 v18, v18, v22
    v_add_f32 v90, v10, v18
    v_add_f32 v11, v11, v15
    v_add_f32 v19, v19, v23
    v_add_f32 v91, v11, v19
    ds_read_b128 v[8:11], v4 offset:12288
    ds_read_b128 v[12:15], v4 offset:32768
    ds_read_b128 v[16:19], v5 offset:12288
    ds_read_b128 v[20:23], v5 offset:32768
    s_waitcnt lgkmcnt(2)
    v_add_f32 v8, v8, v12
    s_waitcnt lgkmcnt(0)
    v_add_f32 v16, v16, v20
    v_add_f32 v92, v8, v16
    v_add_f32 v9, v9, v13
    v_add_f32 v17, v17, v21
    v_add_f32 v93, v9, v17
    v_add_f32 v10, v10, v14
    v_add_f32 v18, v18, v22
    v_add_f32 v94, v10, v18
    v_add_f32 v11, v11, v15
    v_add_f32 v19, v19, v23
    v_add_f32 v95, v11, v19
    ds_read_b128 v[8:11], v4 offset:16384
    ds_read_b128 v[12:15], v4 offset:36864
    ds_read_b128 v[16:19], v5 offset:16384
    ds_read_b128 v[20:23], v5 offset:36864
    s_waitcnt lgkmcnt(2)
    v_add_f32 v8, v8, v12
    s_waitcnt lgkmcnt(0)
    v_add_f32 v16, v16, v20
    v_add_f32 v96, v8, v16
    v_add_f32 v9, v9, v13
    v_add_f32 v17, v17, v21
    v_add_f32 v97, v9, v17
    v_add_f32 v10, v10, v14
    v_add_f32 v18, v18, v22
    v_add_f32 v98, v10, v18
    v_add_f32 v11, v11, v15
    v_add_f32 v19, v19, v23
    v_add_f32 v99, v11, v19
    s_load_dwordx2 s[16:17], s[0:1], 112
    s_waitcnt lgkmcnt(0)
    s_add_u32 s16, s16, 5308416
    s_addc_u32 s17, s17, 0
    s_load_dwordx8 s[48:55], s[16:17], 0
    s_waitcnt lgkmcnt(0)
    s_lshl_b32 s23, s18, 6
    s_lshl_b32 s24, s3, 4
    s_add_u32 s23, s23, s24
    v_and_b32 v6, 15, v2
    v_add_u32 v8, s23, v6
    s_mul_i32 s23, s19, 80
    v_lshrrev_b32 v7, 4, v2
    v_lshlrev_b32 v7, 2, v7
    v_add_u32 v7, s23, v7
    v_mul_u32_u24 v9, 1280, v8
    v_lshl_add_u32 v9, v7, 1, v9
    v_mov_b32 v10, 0x7ffffff0
    v_cmp_eq_u32 vcc, s48, v8
    v_mov_b32 v11, 0
    s_nop 0
    v_cndmask_b32 v10, v10, v11, vcc
    v_cmp_eq_u32 vcc, s49, v8
    v_mov_b32 v11, 2560
    s_nop 0
    v_cndmask_b32 v10, v10, v11, vcc
    v_cmp_eq_u32 vcc, s50, v8
    v_mov_b32 v11, 5120
    s_nop 0
    v_cndmask_b32 v10, v10, v11, vcc
    v_cmp_eq_u32 vcc, s51, v8
    v_mov_b32 v11, 7680
    s_nop 0
    v_cndmask_b32 v10, v10, v11, vcc
    v_cmp_eq_u32 vcc, s52, v8
    v_mov_b32 v11, 10240
    s_nop 0
    v_cndmask_b32 v10, v10, v11, vcc
    v_cmp_eq_u32 vcc, s53, v8
    v_mov_b32 v11, 12800
    s_nop 0
    v_cndmask_b32 v10, v10, v11, vcc
    v_cmp_eq_u32 vcc, s54, v8
    v_mov_b32 v11, 15360
    s_nop 0
    v_cndmask_b32 v10, v10, v11, vcc
    v_cmp_eq_u32 vcc, s55, v8
    v_mov_b32 v11, 17920
    s_nop 0
    v_cndmask_b32 v10, v10, v11, vcc
    v_lshl_add_u32 v10, v7, 2, v10
    s_mov_b32 s23, 0
    s_mov_b32 s24, 5505024
    buffer_load_dwordx2 v[16:17], v9, s[8:11], 0 offen offset:0
    buffer_load_dwordx2 v[28:29], v9, s[4:7], s23 offen offset:0
    buffer_load_dwordx4 v[40:43], v10, s[4:7], s24 offen offset:0
    buffer_load_dwordx2 v[18:19], v9, s[8:11], 0 offen offset:32
    buffer_load_dwordx2 v[30:31], v9, s[4:7], s23 offen offset:32
    buffer_load_dwordx4 v[44:47], v10, s[4:7], s24 offen offset:64
    buffer_load_dwordx2 v[20:21], v9, s[8:11], 0 offen offset:64
    buffer_load_dwordx2 v[32:33], v9, s[4:7], s23 offen offset:64
    buffer_load_dwordx4 v[48:51], v10, s[4:7], s24 offen offset:128
    buffer_load_dwordx2 v[22:23], v9, s[8:11], 0 offen offset:96
    buffer_load_dwordx2 v[34:35], v9, s[4:7], s23 offen offset:96
    buffer_load_dwordx4 v[52:55], v10, s[4:7], s24 offen offset:192
    buffer_load_dwordx2 v[24:25], v9, s[8:11], 0 offen offset:128
    buffer_load_dwordx2 v[36:37], v9, s[4:7], s23 offen offset:128
    buffer_load_dwordx4 v[56:59], v10, s[4:7], s24 offen offset:256
    s_waitcnt vmcnt(0)
    v_lshlrev_b32 v12, 16, v16
    v_lshlrev_b32 v13, 16, v28
    v_cvt_pk_bf16_f32 v80, v80, v80
    v_and_b32 v80, 0xffff0000, v80
    v_add_f32 v80, v12, v80
    v_cvt_pk_bf16_f32 v80, v80, v80
    v_and_b32 v80, 0xffff0000, v80
    v_add_f32 v13, v13, v40
    v_cvt_pk_bf16_f32 v13, v13, v13
    v_and_b32 v13, 0xffff0000, v13
    v_add_f32 v80, v80, v13
    v_and_b32 v12, 0xffff0000, v16
    v_and_b32 v13, 0xffff0000, v28
    v_cvt_pk_bf16_f32 v81, v81, v81
    v_and_b32 v81, 0xffff0000, v81
    v_add_f32 v81, v12, v81
    v_cvt_pk_bf16_f32 v81, v81, v81
    v_and_b32 v81, 0xffff0000, v81
    v_add_f32 v13, v13, v41
    v_cvt_pk_bf16_f32 v13, v13, v13
    v_and_b32 v13, 0xffff0000, v13
    v_add_f32 v81, v81, v13
    v_lshlrev_b32 v12, 16, v17
    v_lshlrev_b32 v13, 16, v29
    v_cvt_pk_bf16_f32 v82, v82, v82
    v_and_b32 v82, 0xffff0000, v82
    v_add_f32 v82, v12, v82
    v_cvt_pk_bf16_f32 v82, v82, v82
    v_and_b32 v82, 0xffff0000, v82
    v_add_f32 v13, v13, v42
    v_cvt_pk_bf16_f32 v13, v13, v13
    v_and_b32 v13, 0xffff0000, v13
    v_add_f32 v82, v82, v13
    v_and_b32 v12, 0xffff0000, v17
    v_and_b32 v13, 0xffff0000, v29
    v_cvt_pk_bf16_f32 v83, v83, v83
    v_and_b32 v83, 0xffff0000, v83
    v_add_f32 v83, v12, v83
    v_cvt_pk_bf16_f32 v83, v83, v83
    v_and_b32 v83, 0xffff0000, v83
    v_add_f32 v13, v13, v43
    v_cvt_pk_bf16_f32 v13, v13, v13
    v_and_b32 v13, 0xffff0000, v13
    v_add_f32 v83, v83, v13
    v_cvt_pk_bf16_f32 v14, v80, v81
    v_cvt_pk_bf16_f32 v15, v82, v83
    buffer_store_dwordx2 v[14:15], v9, s[12:15], 0 offen offset:0
    v_lshlrev_b32 v12, 16, v18
    v_lshlrev_b32 v13, 16, v30
    v_cvt_pk_bf16_f32 v84, v84, v84
    v_and_b32 v84, 0xffff0000, v84
    v_add_f32 v84, v12, v84
    v_cvt_pk_bf16_f32 v84, v84, v84
    v_and_b32 v84, 0xffff0000, v84
    v_add_f32 v13, v13, v44
    v_cvt_pk_bf16_f32 v13, v13, v13
    v_and_b32 v13, 0xffff0000, v13
    v_add_f32 v84, v84, v13
    v_and_b32 v12, 0xffff0000, v18
    v_and_b32 v13, 0xffff0000, v30
    v_cvt_pk_bf16_f32 v85, v85, v85
    v_and_b32 v85, 0xffff0000, v85
    v_add_f32 v85, v12, v85
    v_cvt_pk_bf16_f32 v85, v85, v85
    v_and_b32 v85, 0xffff0000, v85
    v_add_f32 v13, v13, v45
    v_cvt_pk_bf16_f32 v13, v13, v13
    v_and_b32 v13, 0xffff0000, v13
    v_add_f32 v85, v85, v13
    v_lshlrev_b32 v12, 16, v19
    v_lshlrev_b32 v13, 16, v31
    v_cvt_pk_bf16_f32 v86, v86, v86
    v_and_b32 v86, 0xffff0000, v86
    v_add_f32 v86, v12, v86
    v_cvt_pk_bf16_f32 v86, v86, v86
    v_and_b32 v86, 0xffff0000, v86
    v_add_f32 v13, v13, v46
    v_cvt_pk_bf16_f32 v13, v13, v13
    v_and_b32 v13, 0xffff0000, v13
    v_add_f32 v86, v86, v13
    v_and_b32 v12, 0xffff0000, v19
    v_and_b32 v13, 0xffff0000, v31
    v_cvt_pk_bf16_f32 v87, v87, v87
    v_and_b32 v87, 0xffff0000, v87
    v_add_f32 v87, v12, v87
    v_cvt_pk_bf16_f32 v87, v87, v87
    v_and_b32 v87, 0xffff0000, v87
    v_add_f32 v13, v13, v47
    v_cvt_pk_bf16_f32 v13, v13, v13
    v_and_b32 v13, 0xffff0000, v13
    v_add_f32 v87, v87, v13
    v_cvt_pk_bf16_f32 v14, v84, v85
    v_cvt_pk_bf16_f32 v15, v86, v87
    buffer_store_dwordx2 v[14:15], v9, s[12:15], 0 offen offset:32
    v_lshlrev_b32 v12, 16, v20
    v_lshlrev_b32 v13, 16, v32
    v_cvt_pk_bf16_f32 v88, v88, v88
    v_and_b32 v88, 0xffff0000, v88
    v_add_f32 v88, v12, v88
    v_cvt_pk_bf16_f32 v88, v88, v88
    v_and_b32 v88, 0xffff0000, v88
    v_add_f32 v13, v13, v48
    v_cvt_pk_bf16_f32 v13, v13, v13
    v_and_b32 v13, 0xffff0000, v13
    v_add_f32 v88, v88, v13
    v_and_b32 v12, 0xffff0000, v20
    v_and_b32 v13, 0xffff0000, v32
    v_cvt_pk_bf16_f32 v89, v89, v89
    v_and_b32 v89, 0xffff0000, v89
    v_add_f32 v89, v12, v89
    v_cvt_pk_bf16_f32 v89, v89, v89
    v_and_b32 v89, 0xffff0000, v89
    v_add_f32 v13, v13, v49
    v_cvt_pk_bf16_f32 v13, v13, v13
    v_and_b32 v13, 0xffff0000, v13
    v_add_f32 v89, v89, v13
    v_lshlrev_b32 v12, 16, v21
    v_lshlrev_b32 v13, 16, v33
    v_cvt_pk_bf16_f32 v90, v90, v90
    v_and_b32 v90, 0xffff0000, v90
    v_add_f32 v90, v12, v90
    v_cvt_pk_bf16_f32 v90, v90, v90
    v_and_b32 v90, 0xffff0000, v90
    v_add_f32 v13, v13, v50
    v_cvt_pk_bf16_f32 v13, v13, v13
    v_and_b32 v13, 0xffff0000, v13
    v_add_f32 v90, v90, v13
    v_and_b32 v12, 0xffff0000, v21
    v_and_b32 v13, 0xffff0000, v33
    v_cvt_pk_bf16_f32 v91, v91, v91
    v_and_b32 v91, 0xffff0000, v91
    v_add_f32 v91, v12, v91
    v_cvt_pk_bf16_f32 v91, v91, v91
    v_and_b32 v91, 0xffff0000, v91
    v_add_f32 v13, v13, v51
    v_cvt_pk_bf16_f32 v13, v13, v13
    v_and_b32 v13, 0xffff0000, v13
    v_add_f32 v91, v91, v13
    v_cvt_pk_bf16_f32 v14, v88, v89
    v_cvt_pk_bf16_f32 v15, v90, v91
    buffer_store_dwordx2 v[14:15], v9, s[12:15], 0 offen offset:64
    v_lshlrev_b32 v12, 16, v22
    v_lshlrev_b32 v13, 16, v34
    v_cvt_pk_bf16_f32 v92, v92, v92
    v_and_b32 v92, 0xffff0000, v92
    v_add_f32 v92, v12, v92
    v_cvt_pk_bf16_f32 v92, v92, v92
    v_and_b32 v92, 0xffff0000, v92
    v_add_f32 v13, v13, v52
    v_cvt_pk_bf16_f32 v13, v13, v13
    v_and_b32 v13, 0xffff0000, v13
    v_add_f32 v92, v92, v13
    v_and_b32 v12, 0xffff0000, v22
    v_and_b32 v13, 0xffff0000, v34
    v_cvt_pk_bf16_f32 v93, v93, v93
    v_and_b32 v93, 0xffff0000, v93
    v_add_f32 v93, v12, v93
    v_cvt_pk_bf16_f32 v93, v93, v93
    v_and_b32 v93, 0xffff0000, v93
    v_add_f32 v13, v13, v53
    v_cvt_pk_bf16_f32 v13, v13, v13
    v_and_b32 v13, 0xffff0000, v13
    v_add_f32 v93, v93, v13
    v_lshlrev_b32 v12, 16, v23
    v_lshlrev_b32 v13, 16, v35
    v_cvt_pk_bf16_f32 v94, v94, v94
    v_and_b32 v94, 0xffff0000, v94
    v_add_f32 v94, v12, v94
    v_cvt_pk_bf16_f32 v94, v94, v94
    v_and_b32 v94, 0xffff0000, v94
    v_add_f32 v13, v13, v54
    v_cvt_pk_bf16_f32 v13, v13, v13
    v_and_b32 v13, 0xffff0000, v13
    v_add_f32 v94, v94, v13
    v_and_b32 v12, 0xffff0000, v23
    v_and_b32 v13, 0xffff0000, v35
    v_cvt_pk_bf16_f32 v95, v95, v95
    v_and_b32 v95, 0xffff0000, v95
    v_add_f32 v95, v12, v95
    v_cvt_pk_bf16_f32 v95, v95, v95
    v_and_b32 v95, 0xffff0000, v95
    v_add_f32 v13, v13, v55
    v_cvt_pk_bf16_f32 v13, v13, v13
    v_and_b32 v13, 0xffff0000, v13
    v_add_f32 v95, v95, v13
    v_cvt_pk_bf16_f32 v14, v92, v93
    v_cvt_pk_bf16_f32 v15, v94, v95
    buffer_store_dwordx2 v[14:15], v9, s[12:15], 0 offen offset:96
    v_lshlrev_b32 v12, 16, v24
    v_lshlrev_b32 v13, 16, v36
    v_cvt_pk_bf16_f32 v96, v96, v96
    v_and_b32 v96, 0xffff0000, v96
    v_add_f32 v96, v12, v96
    v_cvt_pk_bf16_f32 v96, v96, v96
    v_and_b32 v96, 0xffff0000, v96
    v_add_f32 v13, v13, v56
    v_cvt_pk_bf16_f32 v13, v13, v13
    v_and_b32 v13, 0xffff0000, v13
    v_add_f32 v96, v96, v13
    v_and_b32 v12, 0xffff0000, v24
    v_and_b32 v13, 0xffff0000, v36
    v_cvt_pk_bf16_f32 v97, v97, v97
    v_and_b32 v97, 0xffff0000, v97
    v_add_f32 v97, v12, v97
    v_cvt_pk_bf16_f32 v97, v97, v97
    v_and_b32 v97, 0xffff0000, v97
    v_add_f32 v13, v13, v57
    v_cvt_pk_bf16_f32 v13, v13, v13
    v_and_b32 v13, 0xffff0000, v13
    v_add_f32 v97, v97, v13
    v_lshlrev_b32 v12, 16, v25
    v_lshlrev_b32 v13, 16, v37
    v_cvt_pk_bf16_f32 v98, v98, v98
    v_and_b32 v98, 0xffff0000, v98
    v_add_f32 v98, v12, v98
    v_cvt_pk_bf16_f32 v98, v98, v98
    v_and_b32 v98, 0xffff0000, v98
    v_add_f32 v13, v13, v58
    v_cvt_pk_bf16_f32 v13, v13, v13
    v_and_b32 v13, 0xffff0000, v13
    v_add_f32 v98, v98, v13
    v_and_b32 v12, 0xffff0000, v25
    v_and_b32 v13, 0xffff0000, v37
    v_cvt_pk_bf16_f32 v99, v99, v99
    v_and_b32 v99, 0xffff0000, v99
    v_add_f32 v99, v12, v99
    v_cvt_pk_bf16_f32 v99, v99, v99
    v_and_b32 v99, 0xffff0000, v99
    v_add_f32 v13, v13, v59
    v_cvt_pk_bf16_f32 v13, v13, v13
    v_and_b32 v13, 0xffff0000, v13
    v_add_f32 v99, v99, v13
    v_cvt_pk_bf16_f32 v14, v96, v97
    v_cvt_pk_bf16_f32 v15, v98, v99
    buffer_store_dwordx2 v[14:15], v9, s[12:15], 0 offen offset:128
K5B_END:
    s_endpgm
.section .rodata,"a"
.p2align 6
.amdhsa_kernel k1_kernel
  .amdhsa_next_free_vgpr 96
  .amdhsa_next_free_sgpr 40
  .amdhsa_accum_offset 96
  .amdhsa_group_segment_fixed_size 0
  .amdhsa_kernarg_size 120
  .amdhsa_user_sgpr_count 2
  .amdhsa_user_sgpr_kernarg_segment_ptr 1
  .amdhsa_system_sgpr_workgroup_id_x 1
.end_amdhsa_kernel
.section .rodata,"a"
.p2align 6
.amdhsa_kernel k3_kernel
  .amdhsa_next_free_vgpr 176
  .amdhsa_next_free_sgpr 72
  .amdhsa_accum_offset 176
  .amdhsa_group_segment_fixed_size 0
  .amdhsa_kernarg_size 120
  .amdhsa_user_sgpr_count 2
  .amdhsa_user_sgpr_kernarg_segment_ptr 1
  .amdhsa_system_sgpr_workgroup_id_x 1
.end_amdhsa_kernel
.section .rodata,"a"
.p2align 6
.amdhsa_kernel k4_kernel
  .amdhsa_next_free_vgpr 512
  .amdhsa_next_free_sgpr 64
  .amdhsa_accum_offset 256
  .amdhsa_group_segment_fixed_size 0
  .amdhsa_kernarg_size 120
  .amdhsa_user_sgpr_count 2
  .amdhsa_user_sgpr_kernarg_segment_ptr 1
  .amdhsa_system_sgpr_workgroup_id_x 1
.end_amdhsa_kernel
.section .rodata,"a"
.p2align 6
.amdhsa_kernel k5a_kernel
  .amdhsa_next_free_vgpr 248
  .amdhsa_next_free_sgpr 48
  .amdhsa_accum_offset 248
  .amdhsa_group_segment_fixed_size 0
  .amdhsa_kernarg_size 120
  .amdhsa_user_sgpr_count 2
  .amdhsa_user_sgpr_kernarg_segment_ptr 1
  .amdhsa_system_sgpr_workgroup_id_x 1
.end_amdhsa_kernel
.section .rodata,"a"
.p2align 6
.amdhsa_kernel k5b_kernel
  .amdhsa_next_free_vgpr 160
  .amdhsa_next_free_sgpr 64
  .amdhsa_accum_offset 160
  .amdhsa_group_segment_fixed_size 0
  .amdhsa_kernarg_size 120
  .amdhsa_user_sgpr_count 2
  .amdhsa_user_sgpr_kernarg_segment_ptr 1
  .amdhsa_system_sgpr_workgroup_id_x 1
.end_amdhsa_kernel
```
